```python
import torch

def _softmax(x, axis=-1):
    return torch.softmax(x, dim=axis)
def _gelu(x):
    return torch.nn.functional.gelu(x, approximate="tanh")
def _silu(x):
    return torch.nn.functional.silu(x)
def _sigmoid(x):
    return torch.sigmoid(x)
def _layernorm(x, axis=-1, eps=1e-5):
    m = x.mean(dim=axis, keepdim=True)
    v = x.var(dim=axis, keepdim=True, unbiased=False)
    return (x - m) / torch.sqrt(v + eps)
def _scatter_add(tgt, idx, src, axis=0):
    return tgt.clone().index_add_(axis, idx, src)
def _segment_sum(src, seg, n):
    out = torch.zeros((n,) + src.shape[1:], dtype=src.dtype)
    return out.index_add_(0, seg, src)
def _pad(x, pw):
    flat = tuple(v for pair in reversed(pw) for v in pair)
    return torch.nn.functional.pad(x, flat)

kernel_name = 'interleave_layers__sliding_block__dense_activation_relu__prompt'

def setup_inputs():

    _w = (lambda a: (lambda t: t.to(torch.bfloat16) if t.is_floating_point() else t)(torch.as_tensor(a)))
    def _A_setup():
        B, S, D = 1, 2048, 448
        return {
            "x": _w((lambda *s: torch.randn(*s, dtype=torch.bfloat16) * 0.05)(B, S, D)),
            "wqkv": _w((lambda *s: torch.randn(*s, dtype=torch.bfloat16) * 0.05)(D, 3 * D)),
            "wo": _w((lambda *s: torch.randn(*s, dtype=torch.bfloat16) * 0.05)(D, D)),
        }
    _A_in = _A_setup()

    def _B_setup():
        B, S, D, Dff = 1, 2048, 448, 1792
        return {
            "x": _w((lambda *s: torch.randn(*s, dtype=torch.bfloat16) * 0.05)(B, S, D)),
            "w1": _w((lambda *s: torch.randn(*s, dtype=torch.bfloat16) * 0.05)(D, Dff)),
            "w2": _w((lambda *s: torch.randn(*s, dtype=torch.bfloat16) * 0.05)(Dff, D)),
        }
    _B_in = _B_setup()

    return {
        "A_x": _A_in["x"],
        "A_wqkv": _A_in["wqkv"],
        "A_wo": _A_in["wo"],
        "B_x": _B_in["x"],
        "B_w1": _B_in["w1"],
        "B_w2": _B_in["w2"],
    }

def reference(A_x, A_wqkv, A_wo, B_x, B_w1, B_w2):
    def _A_ref(x, wqkv, wo):
        B, S, D = x.shape
        H = 16; Dh = D // H; W = 256
        qkv = (lambda x, *d: x.permute(*d))((x @ wqkv).reshape(B, S, 3, H, Dh), 2, 0, 3, 1, 4)
        q, k, v = qkv[0], qkv[1], qkv[2]
        scores = torch.einsum("bhqd,bhkd->bhqk", q, k) * (Dh ** -0.5)
        idx = torch.arange(S)
        mask = (idx[:, None] - idx[None, :] >= 0) & (idx[:, None] - idx[None, :] < W)
        scores = torch.where(mask[None, None], scores, -1e9)
        p = _softmax(scores, axis=-1)
        o = torch.einsum("bhqk,bhkd->bhqd", p, v)
        return (lambda x, *d: x.permute(*d))(o, 0, 2, 1, 3).reshape(B, S, D) @ wo

    def _B_ref(x, w1, w2):
        h = torch.einsum("bsd,df->bsf", x, w1)
        zero = torch.zeros_like(h)
        h = torch.maximum(h, zero)
        return torch.einsum("bsf,fd->bsd", h, w2)

    x = A_x
    x = x + _A_ref(_layernorm(x, axis=-1), A_wqkv, A_wo)
    x = x + _B_ref(_layernorm(x, axis=-1), B_w1, B_w2)
    x = x + _A_ref(_layernorm(x, axis=-1), A_wqkv, A_wo)
    x = x + _B_ref(_layernorm(x, axis=-1), B_w1, B_w2)
    return x
```

```asm
; @launch grid=(256,1,1) block=(256,1,1) lds=163840
.amdgcn_target "amdgcn-amd-amdhsa--gfx950"
.text
.globl interleave_layers__sliding_block__dense_activation_relu__prompt_kernel
.p2align 8
.type interleave_layers__sliding_block__dense_activation_relu__prompt_kernel,@function
interleave_layers__sliding_block__dense_activation_relu__prompt_kernel:
L_code_start:
s_getpc_b64 s[46:47]
s_cmp_ge_u32 s2, 256
s_cbranch_scc1 L_end
s_load_dwordx2 s[4:5], s[0:1], 0
s_load_dwordx2 s[8:9], s[0:1], 8
s_load_dwordx2 s[28:29], s[0:1], 64
s_load_dwordx2 s[12:13], s[0:1], 16
s_load_dwordx2 s[16:17], s[0:1], 32
s_load_dwordx2 s[20:21], s[0:1], 40
s_load_dwordx2 s[24:25], s[0:1], 48
s_load_dwordx2 s[32:33], s[0:1], 56
s_lshr_b32 s49, s2, 3
s_lshl_b32 s49, s49, 4
v_add_u32 v2, s49, v0
v_subrev_u32 v2, 192, v2
v_lshlrev_b32 v2, 7, v2
s_mov_b32 s48, L_code_end-L_code_start-8
v_min_u32 v3, s48, v2
v_lshrrev_b32 v4, 4, v0
v_cmp_eq_u32 vcc, 12, v4
s_nop 0
s_mov_b64 exec, vcc
s_cbranch_execz L_nocode
global_load_dword v14, v3, s[46:47]
L_nocode:
s_mov_b64 exec, -1
v_lshrrev_b32 v6, 6, v0
v_and_b32 v0, 63, v0
v_readfirstlane_b32 s38, v6
v_lshlrev_b32 v1, 4, v0
s_mov_b32 s6, 1835008
s_mov_b32 s7, 0x20000
s_mov_b32 s10, 1204224
s_mov_b32 s11, 0x20000
s_mov_b32 s30, 42991616
s_mov_b32 s31, 0x20000
s_mov_b32 s14, 401408
s_mov_b32 s15, 0x20000
s_mov_b32 s18, 1605632
s_mov_b32 s19, 0x20000
s_mov_b32 s22, 1605632
s_mov_b32 s23, 0x20000
s_mov_b32 s26, 1835008
s_mov_b32 s27, 0x20000
s_mov_b32 s34, 256
s_mov_b32 s35, 0x20000
s_and_b32 s36, s2, 7
s_lshl_b32 s36, s36, 1
s_lshr_b32 s37, s2, 7
s_add_u32 s36, s36, s37
s_lshr_b32 s37, s2, 3
s_and_b32 s37, s37, 15
s_lshl_b32 s42, s36, 2
s_add_u32 s42, s42, s38
v_lshrrev_b32 v6, 3, v0
v_mul_u32_u24 v8, 896, v6
v_lshrrev_b32 v6, 1, v6
v_and_b32 v7, 7, v0
v_xor_b32 v6, v6, v7
v_lshl_add_u32 v8, v6, 4, v8
v_xor_b32 v9, 64, v8
v_lshlrev_b32 v10, 3, v1
s_mul_i32 s50, s42, 28672
s_mul_i32 s51, s38, 24576
s_add_u32 s51, s51, 57344
s_mul_i32 s52, s37, 1792
s_add_u32 s52, s52, s50
s_lshr_b32 s53, s2, 3
s_lshl_b32 s53, s53, 2
s_add_u32 s53, s53, s38
s_mul_i32 s53, s53, 49
s_waitcnt lgkmcnt(0)
s_load_dwordx2 s[44:45], s[28:29], 0
s_cmp_lg_u32 s38, 0
s_cbranch_scc1 L_w0_1
s_mov_b32 s49, 0
s_cmp_ge_u32 s2, 192
s_cbranch_scc1 L_rp0o_3
v_lshrrev_b32 v11, 2, v0
v_mul_u32_u24 v11, 2688, v11
v_and_b32 v3, 3, v0
v_lshl_add_u32 v11, v3, 4, v11
s_bfe_u32 s46, s2, 0x20004
s_mul_i32 s46, s46, 301056
s_lshr_b32 s47, s2, 6
s_mul_i32 s47, s47, 896
s_add_u32 s46, s46, s47
s_and_b32 s47, s2, 15
s_mul_i32 s47, s47, 56
s_add_u32 s46, s46, s47
s_add_u32 s57, s46, 0
s_add_u32 m0, s49, 0
s_nop 0
buffer_load_dwordx4 v11, s[8:11], s57 offen lds
s_add_u32 s57, s46, 43008
s_add_u32 m0, s49, 1024
s_nop 0
buffer_load_dwordx4 v11, s[8:11], s57 offen lds
s_add_u32 s57, s46, 86016
s_add_u32 m0, s49, 2048
s_nop 0
buffer_load_dwordx4 v11, s[8:11], s57 offen lds
s_add_u32 s57, s46, 129024
s_add_u32 m0, s49, 3072
s_nop 0
buffer_load_dwordx4 v11, s[8:11], s57 offen lds
s_add_u32 s57, s46, 172032
s_add_u32 m0, s49, 4096
s_nop 0
buffer_load_dwordx4 v11, s[8:11], s57 offen lds
s_add_u32 s57, s46, 215040
s_add_u32 m0, s49, 5120
s_nop 0
buffer_load_dwordx4 v11, s[8:11], s57 offen lds
s_add_u32 s57, s46, 258048
s_add_u32 m0, s49, 6144
s_nop 0
buffer_load_dwordx4 v11, s[8:11], s57 offen lds
s_branch L_rp0d_4
L_rp0o_3:
v_lshrrev_b32 v11, 2, v0
v_mul_u32_u24 v11, 896, v11
v_and_b32 v3, 3, v0
v_lshl_add_u32 v11, v3, 4, v11
s_bfe_u32 s46, s2, 0x20004
s_mul_i32 s46, s46, 100352
s_bfe_u32 s47, s2, 0x30001
s_mul_i32 s47, s47, 112
s_add_u32 s46, s46, s47
s_and_b32 s47, s2, 1
s_lshl_b32 s47, s47, 6
s_add_u32 s46, s46, s47
s_add_u32 s57, s46, 0
s_add_u32 m0, s49, 0
s_nop 0
buffer_load_dwordx4 v11, s[12:15], s57 offen lds
s_add_u32 s57, s46, 14336
s_add_u32 m0, s49, 1024
s_nop 0
buffer_load_dwordx4 v11, s[12:15], s57 offen lds
s_add_u32 s57, s46, 28672
s_add_u32 m0, s49, 2048
s_nop 0
buffer_load_dwordx4 v11, s[12:15], s57 offen lds
s_add_u32 s57, s46, 43008
s_add_u32 m0, s49, 3072
s_nop 0
buffer_load_dwordx4 v11, s[12:15], s57 offen lds
s_add_u32 s57, s46, 57344
s_add_u32 m0, s49, 4096
s_nop 0
buffer_load_dwordx4 v11, s[12:15], s57 offen lds
s_add_u32 s57, s46, 71680
s_add_u32 m0, s49, 5120
s_nop 0
buffer_load_dwordx4 v11, s[12:15], s57 offen lds
s_add_u32 s57, s46, 86016
s_add_u32 m0, s49, 6144
s_nop 0
buffer_load_dwordx4 v11, s[12:15], s57 offen lds
L_rp0d_4:
s_mov_b64 exec, 0x3fff
buffer_load_dword v14, v10, s[4:7], s52 offen
s_mov_b64 exec, -1
s_add_u32 s57, s50, 0
s_add_u32 m0, s51, 0
s_nop 0
buffer_load_dwordx4 v8, s[4:7], s57 offen lds
s_add_u32 s57, s50, 7168
s_add_u32 m0, s51, 1024
s_nop 0
buffer_load_dwordx4 v9, s[4:7], s57 offen lds
s_add_u32 s57, s50, 14336
s_add_u32 m0, s51, 2048
s_nop 0
buffer_load_dwordx4 v8, s[4:7], s57 offen lds
s_add_u32 s57, s50, 21504
s_add_u32 m0, s51, 3072
s_nop 0
buffer_load_dwordx4 v9, s[4:7], s57 offen lds
s_add_u32 s57, s50, 128
s_add_u32 m0, s51, 4096
s_nop 0
buffer_load_dwordx4 v8, s[4:7], s57 offen lds
s_add_u32 s57, s50, 7296
s_add_u32 m0, s51, 5120
s_nop 0
buffer_load_dwordx4 v9, s[4:7], s57 offen lds
s_add_u32 s57, s50, 14464
s_add_u32 m0, s51, 6144
s_nop 0
buffer_load_dwordx4 v8, s[4:7], s57 offen lds
s_add_u32 s57, s50, 21632
s_add_u32 m0, s51, 7168
s_nop 0
buffer_load_dwordx4 v9, s[4:7], s57 offen lds
s_add_u32 s57, s50, 256
s_add_u32 m0, s51, 8192
s_nop 0
buffer_load_dwordx4 v8, s[4:7], s57 offen lds
s_add_u32 s57, s50, 7424
s_add_u32 m0, s51, 9216
s_nop 0
buffer_load_dwordx4 v9, s[4:7], s57 offen lds
s_add_u32 s57, s50, 14592
s_add_u32 m0, s51, 10240
s_nop 0
buffer_load_dwordx4 v8, s[4:7], s57 offen lds
s_add_u32 s57, s50, 21760
s_add_u32 m0, s51, 11264
s_nop 0
buffer_load_dwordx4 v9, s[4:7], s57 offen lds
s_add_u32 s57, s50, 384
s_add_u32 m0, s51, 12288
s_nop 0
buffer_load_dwordx4 v8, s[4:7], s57 offen lds
s_add_u32 s57, s50, 7552
s_add_u32 m0, s51, 13312
s_nop 0
buffer_load_dwordx4 v9, s[4:7], s57 offen lds
s_add_u32 s57, s50, 14720
s_add_u32 m0, s51, 14336
s_nop 0
buffer_load_dwordx4 v8, s[4:7], s57 offen lds
s_add_u32 s57, s50, 21888
s_add_u32 m0, s51, 15360
s_nop 0
buffer_load_dwordx4 v9, s[4:7], s57 offen lds
s_add_u32 s57, s50, 512
s_add_u32 m0, s51, 16384
s_nop 0
buffer_load_dwordx4 v8, s[4:7], s57 offen lds
s_add_u32 s57, s50, 7680
s_add_u32 m0, s51, 17408
s_nop 0
buffer_load_dwordx4 v9, s[4:7], s57 offen lds
s_add_u32 s57, s50, 14848
s_add_u32 m0, s51, 18432
s_nop 0
buffer_load_dwordx4 v8, s[4:7], s57 offen lds
s_add_u32 s57, s50, 22016
s_add_u32 m0, s51, 19456
s_nop 0
buffer_load_dwordx4 v9, s[4:7], s57 offen lds
s_add_u32 s57, s50, 640
s_add_u32 m0, s51, 20480
s_nop 0
buffer_load_dwordx4 v8, s[4:7], s57 offen lds
s_add_u32 s57, s50, 7808
s_add_u32 m0, s51, 21504
s_nop 0
buffer_load_dwordx4 v9, s[4:7], s57 offen lds
s_add_u32 s57, s50, 14976
s_add_u32 m0, s51, 22528
s_nop 0
buffer_load_dwordx4 v8, s[4:7], s57 offen lds
s_add_u32 s57, s50, 22144
s_add_u32 m0, s51, 23552
s_nop 0
buffer_load_dwordx4 v9, s[4:7], s57 offen lds
s_add_u32 s57, s50, 768
buffer_load_dwordx4 v[152:155], v8, s[4:7], s57 offen
s_add_u32 s57, s50, 7936
buffer_load_dwordx4 v[156:159], v9, s[4:7], s57 offen
s_add_u32 s57, s50, 15104
buffer_load_dwordx4 v[160:163], v8, s[4:7], s57 offen
s_add_u32 s57, s50, 22272
buffer_load_dwordx4 v[164:167], v9, s[4:7], s57 offen
v_bfe_u32 v2, v0, 3, 2
v_lshlrev_b32 v2, 10, v2
v_and_b32 v3, 7, v0
v_lshl_add_u32 v2, v3, 7, v2
v_add_u32 v2, s51, v2
v_bfe_u32 v3, v0, 1, 3
v_lshrrev_b32 v12, 5, v0
v_xor_b32 v3, v3, v12
v_xor_b32 v4, 0, v3
v_lshl_add_u32 v4, v4, 4, v2
v_xor_b32 v5, 2, v3
v_lshl_add_u32 v5, v5, 4, v2
v_xor_b32 v6, 4, v3
v_lshl_add_u32 v6, v6, 4, v2
v_xor_b32 v7, 6, v3
v_lshl_add_u32 v7, v7, 4, v2
v_add_u32 v13, s51, v1
v_mov_b32 v240, 0
v_mov_b32 v241, 0
v_mov_b32 v242, 0
v_mov_b32 v243, 0
v_mov_b32 v244, 0
v_mov_b32 v245, 0
v_mov_b32 v246, 0
v_mov_b32 v247, 0
v_and_b32 v2, 31, v0
v_lshlrev_b32 v12, 2, v12
v_sub_u32 v2, v2, v12
v_cmp_le_i32 s[64:65], 0, v2
v_cmp_le_i32 s[66:67], 1, v2
v_cmp_le_i32 s[68:69], 2, v2
v_cmp_le_i32 s[70:71], 3, v2
v_cmp_le_i32 s[72:73], 8, v2
v_cmp_le_i32 s[74:75], 9, v2
v_cmp_le_i32 s[76:77], 10, v2
v_cmp_le_i32 s[78:79], 11, v2
v_cmp_le_i32 s[80:81], 16, v2
v_cmp_le_i32 s[82:83], 17, v2
v_cmp_le_i32 s[84:85], 18, v2
v_cmp_le_i32 s[86:87], 19, v2
v_cmp_le_i32 s[88:89], 24, v2
v_cmp_le_i32 s[90:91], 25, v2
v_cmp_le_i32 s[92:93], 26, v2
v_cmp_le_i32 s[94:95], 27, v2
s_mov_b32 s62, 0
s_mov_b32 s63, -1
s_mov_b32 s60, -1
s_mov_b32 s61, 0x00ffffff
s_lshr_b32 s40, s37, 3
s_and_b32 s41, s37, 7
s_lshl_b32 s98, s36, 2
s_lshl_b32 s49, s40, 1
s_add_u32 s98, s98, s49
s_lshr_b32 s49, s38, 1
s_add_u32 s98, s98, s49
s_and_b32 s99, s38, 1
s_mov_b32 s58, 0x3f803f80
s_mov_b32 s59, 0x100000
s_waitcnt lgkmcnt(0)
s_add_u32 s44, s44, 1
s_addc_u32 s45, s45, 0
s_waitcnt vmcnt(29)
v_lshrrev_b32 v11, 5, v0
v_mul_u32_u24 v11, 8, v11
v_bfe_u32 v3, v0, 2, 2
v_add_u32 v11, v11, v3
v_lshlrev_b32 v11, 6, v11
v_bfe_u32 v3, v0, 4, 1
v_lshl_add_u32 v11, v3, 5, v11
v_and_b32 v3, 3, v0
v_lshl_add_u32 v11, v3, 3, v11
ds_read_b64_tr_b16 v[168:169], v11 offset:0
ds_read_b64_tr_b16 v[170:171], v11 offset:256
ds_read_b64_tr_b16 v[172:173], v11 offset:1024
ds_read_b64_tr_b16 v[174:175], v11 offset:1280
ds_read_b64_tr_b16 v[176:177], v11 offset:2048
ds_read_b64_tr_b16 v[178:179], v11 offset:2304
ds_read_b64_tr_b16 v[180:181], v11 offset:3072
ds_read_b64_tr_b16 v[182:183], v11 offset:3328
ds_read_b64_tr_b16 v[184:185], v11 offset:4096
ds_read_b64_tr_b16 v[186:187], v11 offset:4352
ds_read_b64_tr_b16 v[188:189], v11 offset:5120
ds_read_b64_tr_b16 v[190:191], v11 offset:5376
ds_read_b64_tr_b16 v[192:193], v11 offset:6144
ds_read_b64_tr_b16 v[194:195], v11 offset:6400
s_bfe_u32 s46, s2, 0x20004
s_cmp_ge_u32 s2, 192
s_cbranch_scc1 L_rs0o_5
s_and_b32 s47, s2, 15
s_lshr_b32 s48, s2, 6
s_lshl_b32 s49, s46, 4
s_add_u32 s49, s49, s47
s_mul_i32 s49, s49, 384
s_lshl_b32 s54, s48, 7
s_add_u32 s49, s49, s54
s_add_u32 s49, s49, 29753344
s_mul_i32 s46, s46, 7168
s_mul_i32 s47, s47, 86016
s_mul_i32 s48, s48, 28672
s_add_u32 s46, s46, s47
s_add_u32 s46, s46, s48
s_add_u32 s46, s46, 28311552
s_add_u32 s47, s46, 4096
v_mov_b32 v196, 0x3f803f80
v_mov_b32 v197, 0x3f803f80
v_mov_b32 v198, 0x3f803f80
v_mov_b32 v199, 0x3f803f80
s_waitcnt lgkmcnt(12)
buffer_store_dwordx4 v[168:171], v1, s[28:31], s46 offen offset:0 sc1
v_mfma_f32_32x32x16_bf16 v[200:215], v[196:199], v[168:171], 0
s_waitcnt lgkmcnt(10)
buffer_store_dwordx4 v[172:175], v1, s[28:31], s46 offen offset:1024 sc1
v_mfma_f32_32x32x16_bf16 v[200:215], v[196:199], v[172:175], v[200:215]
s_waitcnt lgkmcnt(8)
buffer_store_dwordx4 v[176:179], v1, s[28:31], s46 offen offset:2048 sc1
v_mfma_f32_32x32x16_bf16 v[200:215], v[196:199], v[176:179], v[200:215]
s_waitcnt lgkmcnt(6)
buffer_store_dwordx4 v[180:183], v1, s[28:31], s46 offen offset:3072 sc1
v_mfma_f32_32x32x16_bf16 v[200:215], v[196:199], v[180:183], v[200:215]
s_waitcnt lgkmcnt(4)
buffer_store_dwordx4 v[184:187], v1, s[28:31], s47 offen offset:0 sc1
v_mfma_f32_32x32x16_bf16 v[200:215], v[196:199], v[184:187], v[200:215]
s_waitcnt lgkmcnt(2)
buffer_store_dwordx4 v[188:191], v1, s[28:31], s47 offen offset:1024 sc1
v_mfma_f32_32x32x16_bf16 v[200:215], v[196:199], v[188:191], v[200:215]
s_waitcnt lgkmcnt(0)
buffer_store_dwordx4 v[192:195], v1, s[28:31], s47 offen offset:2048 sc1
v_mfma_f32_32x32x16_bf16 v[200:215], v[196:199], v[192:195], v[200:215]
v_lshlrev_b32 v11, 2, v0
s_mov_b32 exec_hi, 0
s_nop 9
buffer_store_dword v200, v11, s[28:31], s49 offen sc1
s_mov_b64 exec, -1
s_branch L_rs0d_6
L_rs0o_5:
s_mul_i32 s46, s46, 14336
s_and_b32 s47, s2, 1
s_lshl_b32 s47, s47, 10
s_add_u32 s46, s46, s47
s_bfe_u32 s47, s2, 0x30001
s_mul_i32 s47, s47, 57344
s_add_u32 s46, s46, s47
s_add_u32 s46, s46, 24117248
s_waitcnt lgkmcnt(12)
buffer_store_dwordx4 v[168:171], v1, s[28:31], s46 offen offset:0 sc1
s_waitcnt lgkmcnt(10)
buffer_store_dwordx4 v[172:175], v1, s[28:31], s46 offen offset:2048 sc1
s_add_u32 s46, s46, 4096
s_waitcnt lgkmcnt(8)
buffer_store_dwordx4 v[176:179], v1, s[28:31], s46 offen offset:0 sc1
s_waitcnt lgkmcnt(6)
buffer_store_dwordx4 v[180:183], v1, s[28:31], s46 offen offset:2048 sc1
s_add_u32 s46, s46, 4096
s_waitcnt lgkmcnt(4)
buffer_store_dwordx4 v[184:187], v1, s[28:31], s46 offen offset:0 sc1
s_waitcnt lgkmcnt(2)
buffer_store_dwordx4 v[188:191], v1, s[28:31], s46 offen offset:2048 sc1
s_add_u32 s46, s46, 4096
s_waitcnt lgkmcnt(0)
buffer_store_dwordx4 v[192:195], v1, s[28:31], s46 offen offset:0 sc1
L_rs0d_6:
s_barrier
v_mov_b32 v10, v4
v_mov_b32 v11, v5
s_waitcnt vmcnt(0)
s_lshl_b32 s46, s38, 8
s_add_u32 s46, s46, s2
s_lshl_b32 s46, s46, 7
s_add_u32 s46, s46, 851968
v_mov_b32 v2, s44
v_mov_b32 v3, s45
v_mov_b32 v4, s44
v_mov_b32 v5, s45
s_mov_b64 exec, 0xff
buffer_store_dwordx4 v[2:5], v1, s[28:31], s46 offen sc1
s_mov_b64 exec, -1
s_nop 0
v_mov_b32 v4, v10
v_mov_b32 v5, v11
s_branch L_xjoin_2
L_w0_1:
s_mov_b64 exec, 0x3fff
buffer_load_dword v14, v10, s[4:7], s52 offen
s_mov_b64 exec, -1
s_add_u32 s57, s50, 0
s_add_u32 m0, s51, 0
s_nop 0
buffer_load_dwordx4 v8, s[4:7], s57 offen lds
s_add_u32 s57, s50, 7168
s_add_u32 m0, s51, 1024
s_nop 0
buffer_load_dwordx4 v9, s[4:7], s57 offen lds
s_add_u32 s57, s50, 14336
s_add_u32 m0, s51, 2048
s_nop 0
buffer_load_dwordx4 v8, s[4:7], s57 offen lds
s_add_u32 s57, s50, 21504
s_add_u32 m0, s51, 3072
s_nop 0
buffer_load_dwordx4 v9, s[4:7], s57 offen lds
s_add_u32 s57, s50, 128
s_add_u32 m0, s51, 4096
s_nop 0
buffer_load_dwordx4 v8, s[4:7], s57 offen lds
s_add_u32 s57, s50, 7296
s_add_u32 m0, s51, 5120
s_nop 0
buffer_load_dwordx4 v9, s[4:7], s57 offen lds
s_add_u32 s57, s50, 14464
s_add_u32 m0, s51, 6144
s_nop 0
buffer_load_dwordx4 v8, s[4:7], s57 offen lds
s_add_u32 s57, s50, 21632
s_add_u32 m0, s51, 7168
s_nop 0
buffer_load_dwordx4 v9, s[4:7], s57 offen lds
v_bfe_u32 v2, v0, 3, 2
v_lshlrev_b32 v2, 10, v2
v_and_b32 v3, 7, v0
v_lshl_add_u32 v2, v3, 7, v2
v_add_u32 v2, s51, v2
v_bfe_u32 v3, v0, 1, 3
v_lshrrev_b32 v12, 5, v0
v_xor_b32 v3, v3, v12
v_xor_b32 v4, 0, v3
v_lshl_add_u32 v4, v4, 4, v2
v_xor_b32 v5, 2, v3
v_lshl_add_u32 v5, v5, 4, v2
v_xor_b32 v6, 4, v3
v_lshl_add_u32 v6, v6, 4, v2
v_xor_b32 v7, 6, v3
v_lshl_add_u32 v7, v7, 4, v2
v_add_u32 v13, s51, v1
v_mov_b32 v240, 0
v_mov_b32 v241, 0
v_mov_b32 v242, 0
v_mov_b32 v243, 0
v_mov_b32 v244, 0
v_mov_b32 v245, 0
v_mov_b32 v246, 0
v_mov_b32 v247, 0
v_and_b32 v2, 31, v0
v_lshlrev_b32 v12, 2, v12
v_sub_u32 v2, v2, v12
v_cmp_le_i32 s[64:65], 0, v2
v_cmp_le_i32 s[66:67], 1, v2
v_cmp_le_i32 s[68:69], 2, v2
v_cmp_le_i32 s[70:71], 3, v2
v_cmp_le_i32 s[72:73], 8, v2
v_cmp_le_i32 s[74:75], 9, v2
v_cmp_le_i32 s[76:77], 10, v2
v_cmp_le_i32 s[78:79], 11, v2
v_cmp_le_i32 s[80:81], 16, v2
v_cmp_le_i32 s[82:83], 17, v2
v_cmp_le_i32 s[84:85], 18, v2
v_cmp_le_i32 s[86:87], 19, v2
v_cmp_le_i32 s[88:89], 24, v2
v_cmp_le_i32 s[90:91], 25, v2
v_cmp_le_i32 s[92:93], 26, v2
v_cmp_le_i32 s[94:95], 27, v2
s_mov_b32 s62, 0
s_mov_b32 s63, -1
s_mov_b32 s60, -1
s_mov_b32 s61, 0x00ffffff
s_lshr_b32 s40, s37, 3
s_and_b32 s41, s37, 7
s_lshl_b32 s98, s36, 2
s_lshl_b32 s49, s40, 1
s_add_u32 s98, s98, s49
s_lshr_b32 s49, s38, 1
s_add_u32 s98, s98, s49
s_and_b32 s99, s38, 1
s_mov_b32 s58, 0x3f803f80
s_mov_b32 s59, 0x100000
s_lshl_b32 s56, s42, 7
s_add_u32 s56, s56, 8192
v_mul_u32_u24 v14, 8192, v0
s_mov_b32 exec_lo, 0x1f
s_mov_b32 exec_hi, 0x0
buffer_load_dword v14, v14, s[28:31], s56 offen
s_mov_b64 exec, -1
s_cmp_lg_u32 s38, 3
s_cbranch_scc1 L_net_7
s_sub_u32 s42, s42, 3
s_lshl_b32 s56, s42, 7
s_add_u32 s56, s56, 8192
v_mul_u32_u24 v14, 8192, v0
s_mov_b32 exec_lo, 0x1f
s_mov_b32 exec_hi, 0x0
buffer_load_dword v14, v14, s[28:31], s56 offen
s_mov_b64 exec, -1
s_add_u32 s42, s42, 3
L_net_7:
s_waitcnt lgkmcnt(0)
s_add_u32 s44, s44, 1
s_addc_u32 s45, s45, 0
s_barrier
s_add_u32 s57, s50, 256
s_add_u32 m0, s51, 8192
s_nop 0
buffer_load_dwordx4 v8, s[4:7], s57 offen lds
s_add_u32 s57, s50, 7424
s_add_u32 m0, s51, 9216
s_nop 0
buffer_load_dwordx4 v9, s[4:7], s57 offen lds
s_add_u32 s57, s50, 14592
s_add_u32 m0, s51, 10240
s_nop 0
buffer_load_dwordx4 v8, s[4:7], s57 offen lds
s_add_u32 s57, s50, 21760
s_add_u32 m0, s51, 11264
s_nop 0
buffer_load_dwordx4 v9, s[4:7], s57 offen lds
s_add_u32 s57, s50, 384
s_add_u32 m0, s51, 12288
s_nop 0
buffer_load_dwordx4 v8, s[4:7], s57 offen lds
s_add_u32 s57, s50, 7552
s_add_u32 m0, s51, 13312
s_nop 0
buffer_load_dwordx4 v9, s[4:7], s57 offen lds
s_add_u32 s57, s50, 14720
s_add_u32 m0, s51, 14336
s_nop 0
buffer_load_dwordx4 v8, s[4:7], s57 offen lds
s_add_u32 s57, s50, 21888
s_add_u32 m0, s51, 15360
s_nop 0
buffer_load_dwordx4 v9, s[4:7], s57 offen lds
s_add_u32 s57, s50, 512
s_add_u32 m0, s51, 16384
s_nop 0
buffer_load_dwordx4 v8, s[4:7], s57 offen lds
s_add_u32 s57, s50, 7680
s_add_u32 m0, s51, 17408
s_nop 0
buffer_load_dwordx4 v9, s[4:7], s57 offen lds
s_add_u32 s57, s50, 14848
s_add_u32 m0, s51, 18432
s_nop 0
buffer_load_dwordx4 v8, s[4:7], s57 offen lds
s_add_u32 s57, s50, 22016
s_add_u32 m0, s51, 19456
s_nop 0
buffer_load_dwordx4 v9, s[4:7], s57 offen lds
s_add_u32 s57, s50, 640
s_add_u32 m0, s51, 20480
s_nop 0
buffer_load_dwordx4 v8, s[4:7], s57 offen lds
s_add_u32 s57, s50, 7808
s_add_u32 m0, s51, 21504
s_nop 0
buffer_load_dwordx4 v9, s[4:7], s57 offen lds
s_add_u32 s57, s50, 14976
s_add_u32 m0, s51, 22528
s_nop 0
buffer_load_dwordx4 v8, s[4:7], s57 offen lds
s_add_u32 s57, s50, 22144
s_add_u32 m0, s51, 23552
s_nop 0
buffer_load_dwordx4 v9, s[4:7], s57 offen lds
s_add_u32 s57, s50, 768
buffer_load_dwordx4 v[152:155], v8, s[4:7], s57 offen
s_add_u32 s57, s50, 7936
buffer_load_dwordx4 v[156:159], v9, s[4:7], s57 offen
s_add_u32 s57, s50, 15104
buffer_load_dwordx4 v[160:163], v8, s[4:7], s57 offen
s_add_u32 s57, s50, 22272
buffer_load_dwordx4 v[164:167], v9, s[4:7], s57 offen
s_cmp_eq_u32 s38, 1
s_cbranch_scc1 L_rp1_8
s_cmp_lg_u32 s38, 2
s_cbranch_scc1 L_rps_9
s_cmp_ge_u32 s2, 224
s_cbranch_scc1 L_rps_9
v_mul_u32_u24 v3, 4682, v0
v_lshrrev_b32 v3, 16, v3
v_mul_u32_u24 v11, 14, v3
v_sub_u32 v11, v0, v11
v_lshlrev_b32 v11, 4, v11
v_mul_u32_u24 v3, 3584, v3
v_add_u32 v11, v11, v3
s_lshr_b32 s46, s2, 4
s_mul_i32 s46, s46, 114688
s_and_b32 s47, s2, 15
s_mul_i32 s47, s47, 224
s_add_u32 s46, s46, s47
s_mov_b32 s49, 35840
s_mov_b64 exec, s[60:61]
s_add_u32 s47, s46, 0
buffer_load_dwordx4 v[168:171], v11, s[16:19], s47 offen
s_add_u32 s47, s46, 14336
buffer_load_dwordx4 v[172:175], v11, s[16:19], s47 offen
s_add_u32 s47, s46, 28672
buffer_load_dwordx4 v[176:179], v11, s[16:19], s47 offen
s_add_u32 s47, s46, 43008
buffer_load_dwordx4 v[180:183], v11, s[16:19], s47 offen
s_add_u32 s47, s46, 57344
buffer_load_dwordx4 v[184:187], v11, s[16:19], s47 offen
s_add_u32 s47, s46, 71680
buffer_load_dwordx4 v[188:191], v11, s[16:19], s47 offen
s_add_u32 s47, s46, 86016
buffer_load_dwordx4 v[192:195], v11, s[16:19], s47 offen
s_add_u32 s47, s46, 100352
buffer_load_dwordx4 v[196:199], v11, s[16:19], s47 offen
s_mov_b64 exec, -1
s_branch L_rps_9
L_rp1_8:
v_mul_u32_u24 v3, 4682, v0
v_lshrrev_b32 v3, 16, v3
v_mul_u32_u24 v11, 672, v3
v_add_u32 v11, v11, v1
s_lshr_b32 s46, s2, 4
s_mul_i32 s46, s46, 100352
s_bfe_u32 s47, s2, 0x20002
s_mul_i32 s47, s47, 28672
s_add_u32 s46, s46, s47
s_and_b32 s47, s2, 3
s_mul_i32 s47, s47, 224
s_add_u32 s46, s46, s47
s_mov_b64 exec, s[60:61]
s_add_u32 s47, s46, 0
buffer_load_dwordx4 v[168:171], v11, s[20:23], s47 offen
s_add_u32 s47, s46, 3584
buffer_load_dwordx4 v[172:175], v11, s[20:23], s47 offen
s_add_u32 s47, s46, 7168
buffer_load_dwordx4 v[176:179], v11, s[20:23], s47 offen
s_add_u32 s47, s46, 10752
buffer_load_dwordx4 v[180:183], v11, s[20:23], s47 offen
s_add_u32 s47, s46, 14336
buffer_load_dwordx4 v[184:187], v11, s[20:23], s47 offen
s_add_u32 s47, s46, 17920
buffer_load_dwordx4 v[188:191], v11, s[20:23], s47 offen
s_add_u32 s47, s46, 21504
buffer_load_dwordx4 v[192:195], v11, s[20:23], s47 offen
s_add_u32 s47, s46, 25088
buffer_load_dwordx4 v[196:199], v11, s[20:23], s47 offen
s_mov_b64 exec, -1
L_rps_9:
L_xjoin_2:
s_cmp_lt_u32 s38, 2
s_cbranch_scc1 L_xw1_10
s_cmp_eq_u32 s38, 2
s_cbranch_scc0 L_xw0_11
s_cmp_lt_u32 s2, 224
s_cbranch_scc1 L_xw1_10
L_xw0_11:
s_waitcnt vmcnt(24)
L_xw1_10:
s_waitcnt vmcnt(32)
ds_read_b128 v[56:59], v4 offset:0
ds_read_b128 v[60:63], v5 offset:0
ds_read_b128 v[64:67], v6 offset:0
ds_read_b128 v[68:71], v7 offset:0
s_cmp_lt_u32 s38, 2
s_cbranch_scc1 L_xw1_12
s_cmp_eq_u32 s38, 2
s_cbranch_scc0 L_xw0_13
s_cmp_lt_u32 s2, 224
s_cbranch_scc1 L_xw1_12
L_xw0_13:
s_waitcnt vmcnt(20)
L_xw1_12:
s_waitcnt vmcnt(28)
ds_read_b128 v[72:75], v4 offset:4096
ds_read_b128 v[76:79], v5 offset:4096
ds_read_b128 v[80:83], v6 offset:4096
ds_read_b128 v[84:87], v7 offset:4096
s_cmp_lt_u32 s38, 2
s_cbranch_scc1 L_xw1_14
s_cmp_eq_u32 s38, 2
s_cbranch_scc0 L_xw0_15
s_cmp_lt_u32 s2, 224
s_cbranch_scc1 L_xw1_14
L_xw0_15:
s_waitcnt vmcnt(16)
L_xw1_14:
s_waitcnt vmcnt(24)
ds_read_b128 v[88:91], v4 offset:8192
ds_read_b128 v[92:95], v5 offset:8192
ds_read_b128 v[96:99], v6 offset:8192
ds_read_b128 v[100:103], v7 offset:8192
s_waitcnt lgkmcnt(4)
s_cmp_lt_u32 s38, 2
s_cbranch_scc1 L_xw1_16
s_cmp_eq_u32 s38, 2
s_cbranch_scc0 L_xw0_17
s_cmp_lt_u32 s2, 224
s_cbranch_scc1 L_xw1_16
L_xw0_17:
s_waitcnt vmcnt(12)
L_xw1_16:
s_waitcnt vmcnt(20)
ds_read_b128 v[104:107], v4 offset:12288
ds_read_b128 v[108:111], v5 offset:12288
ds_read_b128 v[112:115], v6 offset:12288
ds_read_b128 v[116:119], v7 offset:12288
s_cmp_lt_u32 s38, 2
s_cbranch_scc1 L_xw1_18
s_cmp_eq_u32 s38, 2
s_cbranch_scc0 L_xw0_19
s_cmp_lt_u32 s2, 224
s_cbranch_scc1 L_xw1_18
L_xw0_19:
s_waitcnt vmcnt(8)
L_xw1_18:
s_waitcnt vmcnt(16)
ds_read_b128 v[120:123], v4 offset:16384
ds_read_b128 v[124:127], v5 offset:16384
ds_read_b128 v[128:131], v6 offset:16384
ds_read_b128 v[132:135], v7 offset:16384
s_cmp_lt_u32 s38, 2
s_cbranch_scc1 L_xw1_20
s_cmp_eq_u32 s38, 2
s_cbranch_scc0 L_xw0_21
s_cmp_lt_u32 s2, 224
s_cbranch_scc1 L_xw1_20
L_xw0_21:
s_waitcnt vmcnt(4)
L_xw1_20:
s_waitcnt vmcnt(12)
ds_read_b128 v[136:139], v4 offset:20480
ds_read_b128 v[140:143], v5 offset:20480
ds_read_b128 v[144:147], v6 offset:20480
ds_read_b128 v[148:151], v7 offset:20480
s_waitcnt lgkmcnt(4)
s_cmp_lt_u32 s38, 2
s_cbranch_scc1 L_xw1_22
s_cmp_eq_u32 s38, 2
s_cbranch_scc0 L_xw0_23
s_cmp_lt_u32 s2, 224
s_cbranch_scc1 L_xw1_22
L_xw0_23:
s_waitcnt vmcnt(0)
L_xw1_22:
s_waitcnt vmcnt(8)
ds_write_b128 v13, v[152:155] offset:0
ds_write_b128 v13, v[156:159] offset:1024
ds_write_b128 v13, v[160:163] offset:2048
ds_write_b128 v13, v[164:167] offset:3072
ds_read_b128 v[152:155], v4 offset:0
ds_read_b128 v[156:159], v5 offset:0
ds_read_b128 v[160:163], v6 offset:0
ds_read_b128 v[164:167], v7 offset:0
s_mul_i32 s100, s37, 86016
s_lshl_b32 s101, s38, 10
s_add_u32 s100, s100, s101
s_mul_i32 s100, s37, 86016
s_lshl_b32 s101, s38, 10
s_add_u32 s100, s100, s101
v_lshl_add_u32 v6, v0, 4, s37
v_lshlrev_b32 v6, 7, v6
s_mov_b32 s53, 851968
s_mov_b64 exec, 0xfff
buffer_load_dwordx2 v[4:5], v6, s[28:31], s53 offen sc1
s_mov_b64 exec, -1
s_waitcnt lgkmcnt(0)
v_dot2c_f32_bf16 v240, s58, v56
v_dot2c_f32_bf16 v244, v56, v56
v_dot2c_f32_bf16 v241, s58, v57
v_dot2c_f32_bf16 v245, v57, v57
v_dot2c_f32_bf16 v242, s58, v58
v_dot2c_f32_bf16 v246, v58, v58
v_dot2c_f32_bf16 v243, s58, v59
v_dot2c_f32_bf16 v247, v59, v59
v_dot2c_f32_bf16 v240, s58, v60
v_dot2c_f32_bf16 v244, v60, v60
v_dot2c_f32_bf16 v241, s58, v61
v_dot2c_f32_bf16 v245, v61, v61
v_dot2c_f32_bf16 v242, s58, v62
v_dot2c_f32_bf16 v246, v62, v62
v_dot2c_f32_bf16 v243, s58, v63
v_dot2c_f32_bf16 v247, v63, v63
v_dot2c_f32_bf16 v240, s58, v64
v_dot2c_f32_bf16 v244, v64, v64
v_dot2c_f32_bf16 v241, s58, v65
v_dot2c_f32_bf16 v245, v65, v65
v_dot2c_f32_bf16 v242, s58, v66
v_dot2c_f32_bf16 v246, v66, v66
v_dot2c_f32_bf16 v243, s58, v67
v_dot2c_f32_bf16 v247, v67, v67
v_dot2c_f32_bf16 v240, s58, v68
v_dot2c_f32_bf16 v244, v68, v68
v_dot2c_f32_bf16 v241, s58, v69
v_dot2c_f32_bf16 v245, v69, v69
v_dot2c_f32_bf16 v242, s58, v70
v_dot2c_f32_bf16 v246, v70, v70
v_dot2c_f32_bf16 v243, s58, v71
v_dot2c_f32_bf16 v247, v71, v71
v_dot2c_f32_bf16 v240, s58, v72
v_dot2c_f32_bf16 v244, v72, v72
v_dot2c_f32_bf16 v241, s58, v73
v_dot2c_f32_bf16 v245, v73, v73
v_dot2c_f32_bf16 v242, s58, v74
v_dot2c_f32_bf16 v246, v74, v74
v_dot2c_f32_bf16 v243, s58, v75
v_dot2c_f32_bf16 v247, v75, v75
v_dot2c_f32_bf16 v240, s58, v76
v_dot2c_f32_bf16 v244, v76, v76
v_dot2c_f32_bf16 v241, s58, v77
v_dot2c_f32_bf16 v245, v77, v77
v_dot2c_f32_bf16 v242, s58, v78
v_dot2c_f32_bf16 v246, v78, v78
v_dot2c_f32_bf16 v243, s58, v79
v_dot2c_f32_bf16 v247, v79, v79
v_dot2c_f32_bf16 v240, s58, v80
v_dot2c_f32_bf16 v244, v80, v80
v_dot2c_f32_bf16 v241, s58, v81
v_dot2c_f32_bf16 v245, v81, v81
v_dot2c_f32_bf16 v242, s58, v82
v_dot2c_f32_bf16 v246, v82, v82
v_dot2c_f32_bf16 v243, s58, v83
v_dot2c_f32_bf16 v247, v83, v83
v_dot2c_f32_bf16 v240, s58, v84
v_dot2c_f32_bf16 v244, v84, v84
v_dot2c_f32_bf16 v241, s58, v85
v_dot2c_f32_bf16 v245, v85, v85
v_dot2c_f32_bf16 v242, s58, v86
v_dot2c_f32_bf16 v246, v86, v86
v_dot2c_f32_bf16 v243, s58, v87
v_dot2c_f32_bf16 v247, v87, v87
v_dot2c_f32_bf16 v240, s58, v88
v_dot2c_f32_bf16 v244, v88, v88
v_dot2c_f32_bf16 v241, s58, v89
v_dot2c_f32_bf16 v245, v89, v89
v_dot2c_f32_bf16 v242, s58, v90
v_dot2c_f32_bf16 v246, v90, v90
v_dot2c_f32_bf16 v243, s58, v91
v_dot2c_f32_bf16 v247, v91, v91
v_dot2c_f32_bf16 v240, s58, v92
v_dot2c_f32_bf16 v244, v92, v92
v_dot2c_f32_bf16 v241, s58, v93
v_dot2c_f32_bf16 v245, v93, v93
v_dot2c_f32_bf16 v242, s58, v94
v_dot2c_f32_bf16 v246, v94, v94
v_dot2c_f32_bf16 v243, s58, v95
v_dot2c_f32_bf16 v247, v95, v95
v_dot2c_f32_bf16 v240, s58, v96
v_dot2c_f32_bf16 v244, v96, v96
v_dot2c_f32_bf16 v241, s58, v97
v_dot2c_f32_bf16 v245, v97, v97
v_dot2c_f32_bf16 v242, s58, v98
v_dot2c_f32_bf16 v246, v98, v98
v_dot2c_f32_bf16 v243, s58, v99
v_dot2c_f32_bf16 v247, v99, v99
v_dot2c_f32_bf16 v240, s58, v100
v_dot2c_f32_bf16 v244, v100, v100
v_dot2c_f32_bf16 v241, s58, v101
v_dot2c_f32_bf16 v245, v101, v101
v_dot2c_f32_bf16 v242, s58, v102
v_dot2c_f32_bf16 v246, v102, v102
v_dot2c_f32_bf16 v243, s58, v103
v_dot2c_f32_bf16 v247, v103, v103
v_dot2c_f32_bf16 v240, s58, v104
v_dot2c_f32_bf16 v244, v104, v104
v_dot2c_f32_bf16 v241, s58, v105
v_dot2c_f32_bf16 v245, v105, v105
v_dot2c_f32_bf16 v242, s58, v106
v_dot2c_f32_bf16 v246, v106, v106
v_dot2c_f32_bf16 v243, s58, v107
v_dot2c_f32_bf16 v247, v107, v107
v_dot2c_f32_bf16 v240, s58, v108
v_dot2c_f32_bf16 v244, v108, v108
v_dot2c_f32_bf16 v241, s58, v109
v_dot2c_f32_bf16 v245, v109, v109
v_dot2c_f32_bf16 v242, s58, v110
v_dot2c_f32_bf16 v246, v110, v110
v_dot2c_f32_bf16 v243, s58, v111
v_dot2c_f32_bf16 v247, v111, v111
v_dot2c_f32_bf16 v240, s58, v112
v_dot2c_f32_bf16 v244, v112, v112
v_dot2c_f32_bf16 v241, s58, v113
v_dot2c_f32_bf16 v245, v113, v113
v_dot2c_f32_bf16 v242, s58, v114
v_dot2c_f32_bf16 v246, v114, v114
v_dot2c_f32_bf16 v243, s58, v115
v_dot2c_f32_bf16 v247, v115, v115
v_dot2c_f32_bf16 v240, s58, v116
v_dot2c_f32_bf16 v244, v116, v116
v_dot2c_f32_bf16 v241, s58, v117
v_dot2c_f32_bf16 v245, v117, v117
v_dot2c_f32_bf16 v242, s58, v118
v_dot2c_f32_bf16 v246, v118, v118
v_dot2c_f32_bf16 v243, s58, v119
v_dot2c_f32_bf16 v247, v119, v119
v_dot2c_f32_bf16 v240, s58, v120
v_dot2c_f32_bf16 v244, v120, v120
v_dot2c_f32_bf16 v241, s58, v121
v_dot2c_f32_bf16 v245, v121, v121
v_dot2c_f32_bf16 v242, s58, v122
v_dot2c_f32_bf16 v246, v122, v122
v_dot2c_f32_bf16 v243, s58, v123
v_dot2c_f32_bf16 v247, v123, v123
v_dot2c_f32_bf16 v240, s58, v124
v_dot2c_f32_bf16 v244, v124, v124
v_dot2c_f32_bf16 v241, s58, v125
v_dot2c_f32_bf16 v245, v125, v125
v_dot2c_f32_bf16 v242, s58, v126
v_dot2c_f32_bf16 v246, v126, v126
v_dot2c_f32_bf16 v243, s58, v127
v_dot2c_f32_bf16 v247, v127, v127
v_dot2c_f32_bf16 v240, s58, v128
v_dot2c_f32_bf16 v244, v128, v128
v_dot2c_f32_bf16 v241, s58, v129
v_dot2c_f32_bf16 v245, v129, v129
v_dot2c_f32_bf16 v242, s58, v130
v_dot2c_f32_bf16 v246, v130, v130
v_dot2c_f32_bf16 v243, s58, v131
v_dot2c_f32_bf16 v247, v131, v131
v_dot2c_f32_bf16 v240, s58, v132
v_dot2c_f32_bf16 v244, v132, v132
v_dot2c_f32_bf16 v241, s58, v133
v_dot2c_f32_bf16 v245, v133, v133
v_dot2c_f32_bf16 v242, s58, v134
v_dot2c_f32_bf16 v246, v134, v134
v_dot2c_f32_bf16 v243, s58, v135
v_dot2c_f32_bf16 v247, v135, v135
v_dot2c_f32_bf16 v240, s58, v136
v_dot2c_f32_bf16 v244, v136, v136
v_dot2c_f32_bf16 v241, s58, v137
v_dot2c_f32_bf16 v245, v137, v137
v_dot2c_f32_bf16 v242, s58, v138
v_dot2c_f32_bf16 v246, v138, v138
v_dot2c_f32_bf16 v243, s58, v139
v_dot2c_f32_bf16 v247, v139, v139
v_dot2c_f32_bf16 v240, s58, v140
v_dot2c_f32_bf16 v244, v140, v140
v_dot2c_f32_bf16 v241, s58, v141
v_dot2c_f32_bf16 v245, v141, v141
v_dot2c_f32_bf16 v242, s58, v142
v_dot2c_f32_bf16 v246, v142, v142
v_dot2c_f32_bf16 v243, s58, v143
v_dot2c_f32_bf16 v247, v143, v143
v_dot2c_f32_bf16 v240, s58, v144
v_dot2c_f32_bf16 v244, v144, v144
v_dot2c_f32_bf16 v241, s58, v145
v_dot2c_f32_bf16 v245, v145, v145
v_dot2c_f32_bf16 v242, s58, v146
v_dot2c_f32_bf16 v246, v146, v146
v_dot2c_f32_bf16 v243, s58, v147
v_dot2c_f32_bf16 v247, v147, v147
v_dot2c_f32_bf16 v240, s58, v148
v_dot2c_f32_bf16 v244, v148, v148
v_dot2c_f32_bf16 v241, s58, v149
v_dot2c_f32_bf16 v245, v149, v149
v_dot2c_f32_bf16 v242, s58, v150
v_dot2c_f32_bf16 v246, v150, v150
v_dot2c_f32_bf16 v243, s58, v151
v_dot2c_f32_bf16 v247, v151, v151
v_dot2c_f32_bf16 v240, s58, v152
v_dot2c_f32_bf16 v244, v152, v152
v_dot2c_f32_bf16 v241, s58, v153
v_dot2c_f32_bf16 v245, v153, v153
v_dot2c_f32_bf16 v242, s58, v154
v_dot2c_f32_bf16 v246, v154, v154
v_dot2c_f32_bf16 v243, s58, v155
v_dot2c_f32_bf16 v247, v155, v155
v_dot2c_f32_bf16 v240, s58, v156
v_dot2c_f32_bf16 v244, v156, v156
v_dot2c_f32_bf16 v241, s58, v157
v_dot2c_f32_bf16 v245, v157, v157
v_dot2c_f32_bf16 v242, s58, v158
v_dot2c_f32_bf16 v246, v158, v158
v_dot2c_f32_bf16 v243, s58, v159
v_dot2c_f32_bf16 v247, v159, v159
v_dot2c_f32_bf16 v240, s58, v160
v_dot2c_f32_bf16 v244, v160, v160
v_dot2c_f32_bf16 v241, s58, v161
v_dot2c_f32_bf16 v245, v161, v161
v_dot2c_f32_bf16 v242, s58, v162
v_dot2c_f32_bf16 v246, v162, v162
v_dot2c_f32_bf16 v243, s58, v163
v_dot2c_f32_bf16 v247, v163, v163
v_dot2c_f32_bf16 v240, s58, v164
v_dot2c_f32_bf16 v244, v164, v164
v_dot2c_f32_bf16 v241, s58, v165
v_dot2c_f32_bf16 v245, v165, v165
v_dot2c_f32_bf16 v242, s58, v166
v_dot2c_f32_bf16 v246, v166, v166
v_dot2c_f32_bf16 v243, s58, v167
v_dot2c_f32_bf16 v247, v167, v167
v_add_f32 v240, v240, v241
s_nop 0
v_add_f32 v242, v242, v243
v_add_f32 v240, v240, v242
v_mov_b32 v241, v240
s_nop 1
v_permlane32_swap_b32 v240, v241
v_add_f32 v240, v240, v241
v_add_f32 v244, v244, v245
v_add_f32 v246, v246, v247
v_add_f32 v244, v244, v246
v_mov_b32 v245, v244
s_nop 1
v_permlane32_swap_b32 v244, v245
v_add_f32 v244, v244, v245
v_mul_f32 v240, 0xbb124925, v240
v_mul_f32 v244, 0x3b124925, v244
v_fma_f32 v244, -v240, v240, v244
v_max_f32 v244, 0, v244
v_add_f32 v244, 0x3727c5ac, v244
v_rsq_f32 v12, v244
s_nop 0
v_mul_f32 v13, v240, v12
s_waitcnt vmcnt(0)
s_mov_b64 exec, 0xfff
v_cmp_ne_u64 vcc, s[44:45], v[4:5]
s_cbranch_vccnz L_chk_24
L_chkok_25:
s_mov_b64 exec, -1
s_waitcnt lgkmcnt(0)
s_barrier
s_add_u32 s57, s100, 28340224
s_add_u32 m0, s101, 0
s_nop 0
buffer_load_dwordx4 v1, s[28:31], s57 offen lds
s_add_u32 s57, s100, 28368896
s_add_u32 m0, s101, 28672
s_nop 0
buffer_load_dwordx4 v1, s[28:31], s57 offen lds
s_add_u32 s57, s100, 28344320
s_add_u32 m0, s101, 4096
s_nop 0
buffer_load_dwordx4 v1, s[28:31], s57 offen lds
s_add_u32 s57, s100, 28372992
s_add_u32 m0, s101, 32768
s_nop 0
buffer_load_dwordx4 v1, s[28:31], s57 offen lds
s_add_u32 s57, s100, 28348416
s_add_u32 m0, s101, 8192
s_nop 0
buffer_load_dwordx4 v1, s[28:31], s57 offen lds
s_add_u32 s57, s100, 28377088
s_add_u32 m0, s101, 36864
s_nop 0
buffer_load_dwordx4 v1, s[28:31], s57 offen lds
s_add_u32 s57, s100, 28352512
s_add_u32 m0, s101, 12288
s_nop 0
buffer_load_dwordx4 v1, s[28:31], s57 offen lds
s_add_u32 s57, s100, 28381184
s_add_u32 m0, s101, 40960
s_nop 0
buffer_load_dwordx4 v1, s[28:31], s57 offen lds
s_mul_i32 s51, s38, 8192
s_add_u32 s51, s51, 57344
v_add_u32 v9, s51, v1
s_cmp_eq_u32 s38, 1
s_cbranch_scc1 L_rs1_26
s_cmp_lg_u32 s38, 2
s_cbranch_scc1 L_rss2_28
s_cmp_ge_u32 s2, 224
s_cbranch_scc1 L_rss2_28
v_lshrrev_b32 v10, 4, v0
v_lshlrev_b32 v10, 3, v10
v_bfe_u32 v3, v0, 2, 2
v_add_u32 v10, v10, v3
v_mul_u32_u24 v10, 224, v10
v_and_b32 v3, 3, v0
v_lshl_add_u32 v10, v3, 3, v10
v_add_u32 v10, s51, v10
s_mov_b64 exec, s[60:61]
ds_write_b128 v9, v[168:171] offset:0
ds_write_b128 v9, v[172:175] offset:896
ds_write_b128 v9, v[176:179] offset:1792
ds_write_b128 v9, v[180:183] offset:2688
ds_write_b128 v9, v[184:187] offset:3584
ds_write_b128 v9, v[188:191] offset:4480
ds_write_b128 v9, v[192:195] offset:5376
ds_write_b128 v9, v[196:199] offset:6272
s_mov_b64 exec, -1
s_waitcnt lgkmcnt(0)
ds_read_b64_tr_b16 v[168:169], v10 offset:0
ds_read_b64_tr_b16 v[170:171], v10 offset:896
ds_read_b64_tr_b16 v[172:173], v10 offset:32
ds_read_b64_tr_b16 v[174:175], v10 offset:928
ds_read_b64_tr_b16 v[176:177], v10 offset:64
ds_read_b64_tr_b16 v[178:179], v10 offset:960
ds_read_b64_tr_b16 v[180:181], v10 offset:96
ds_read_b64_tr_b16 v[182:183], v10 offset:992
ds_read_b64_tr_b16 v[184:185], v10 offset:128
ds_read_b64_tr_b16 v[186:187], v10 offset:1024
ds_read_b64_tr_b16 v[188:189], v10 offset:160
ds_read_b64_tr_b16 v[190:191], v10 offset:1056
ds_read_b64_tr_b16 v[192:193], v10 offset:192
ds_read_b64_tr_b16 v[194:195], v10 offset:1088
s_lshr_b32 s48, s2, 4
s_and_b32 s47, s2, 15
s_mul_i32 s46, s47, 100352
s_add_u32 s46, s46, 24641536
s_mul_i32 s49, s48, 3072
s_add_u32 s49, s49, s46
s_add_u32 s49, s49, 57344
s_lshl_b32 s50, s48, 12
s_add_u32 s46, s46, s50
s_lshl_b32 s48, s2, 9
s_add_u32 s48, s48, 26279936
v_mov_b32 v196, s58
v_mov_b32 v197, s58
v_mov_b32 v198, s58
v_mov_b32 v199, s58
s_waitcnt lgkmcnt(12)
buffer_store_dwordx4 v[168:171], v1, s[28:31], s46 offen offset:0 sc1
v_mfma_f32_16x16x32_bf16 v[200:203], v[196:199], v[168:171], 0
s_waitcnt lgkmcnt(10)
buffer_store_dwordx4 v[172:175], v1, s[28:31], s46 offen offset:1024 sc1
v_mfma_f32_16x16x32_bf16 v[204:207], v[196:199], v[172:175], 0
s_waitcnt lgkmcnt(8)
buffer_store_dwordx4 v[176:179], v1, s[28:31], s46 offen offset:2048 sc1
v_mfma_f32_16x16x32_bf16 v[208:211], v[196:199], v[176:179], 0
s_waitcnt lgkmcnt(6)
buffer_store_dwordx4 v[180:183], v1, s[28:31], s46 offen offset:3072 sc1
v_mfma_f32_16x16x32_bf16 v[212:215], v[196:199], v[180:183], 0
s_waitcnt lgkmcnt(4)
buffer_store_dwordx4 v[184:187], v1, s[28:31], s49 offen offset:0 sc1
v_mfma_f32_16x16x32_bf16 v[216:219], v[196:199], v[184:187], 0
s_waitcnt lgkmcnt(2)
buffer_store_dwordx4 v[188:191], v1, s[28:31], s49 offen offset:1024 sc1
v_mfma_f32_16x16x32_bf16 v[220:223], v[196:199], v[188:191], 0
s_waitcnt lgkmcnt(0)
buffer_store_dwordx4 v[192:195], v1, s[28:31], s49 offen offset:2048 sc1
v_mfma_f32_16x16x32_bf16 v[224:227], v[196:199], v[192:195], 0
v_lshlrev_b32 v3, 2, v0
s_mov_b32 exec_lo, 0xffff0000
s_mov_b32 exec_hi, 0x0
v_mov_b32 v200, v204
s_nop 0
v_mov_b32 v216, v220
s_mov_b32 exec_lo, 0x0
s_mov_b32 exec_hi, 0xffff
v_mov_b32 v200, v208
v_mov_b32 v216, v224
s_mov_b32 exec_lo, 0x0
s_mov_b32 exec_hi, 0xffff0000
v_mov_b32 v200, v212
v_mov_b32 v216, v224
s_mov_b64 exec, -1
buffer_store_dword v200, v3, s[28:31], s48 offen offset:0 sc1
buffer_store_dword v216, v3, s[28:31], s48 offen offset:256 sc1
s_mov_b64 exec, -1
s_branch L_rss_27
L_rs1_26:
v_lshrrev_b32 v10, 5, v0
v_mul_u32_u24 v10, 4, v10
v_bfe_u32 v3, v0, 2, 2
v_add_u32 v10, v10, v3
v_mul_u32_u24 v10, 224, v10
v_bfe_u32 v3, v0, 4, 1
v_lshl_add_u32 v10, v3, 5, v10
v_and_b32 v3, 3, v0
v_lshl_add_u32 v10, v3, 3, v10
v_lshrrev_b32 v11, 5, v0
v_mul_u32_u24 v11, 8, v11
v_bfe_u32 v3, v0, 2, 2
v_add_u32 v11, v11, v3
v_mul_u32_u24 v11, 224, v11
v_bfe_u32 v3, v0, 4, 1
v_lshl_add_u32 v11, v3, 5, v11
v_and_b32 v3, 3, v0
v_lshl_add_u32 v11, v3, 3, v11
v_add_u32 v10, s51, v10
v_add_u32 v11, s51, v11
s_mov_b64 exec, s[60:61]
ds_write_b128 v9, v[168:171] offset:0
ds_write_b128 v9, v[172:175] offset:896
ds_write_b128 v9, v[176:179] offset:1792
ds_write_b128 v9, v[180:183] offset:2688
ds_write_b128 v9, v[184:187] offset:3584
ds_write_b128 v9, v[188:191] offset:4480
ds_write_b128 v9, v[192:195] offset:5376
ds_write_b128 v9, v[196:199] offset:6272
s_mov_b64 exec, -1
s_bfe_u32 s48, s2, 0x20002
s_cmp_eq_u32 s48, 3
s_waitcnt lgkmcnt(0)
s_cbranch_scc1 L_rs6_29
ds_read_b64_tr_b16 v[168:169], v10 offset:0
ds_read_b64_tr_b16 v[170:171], v10 offset:3584
ds_read_b64_tr_b16 v[172:173], v10 offset:64
ds_read_b64_tr_b16 v[174:175], v10 offset:3648
ds_read_b64_tr_b16 v[176:177], v10 offset:112
ds_read_b64_tr_b16 v[178:179], v10 offset:3696
ds_read_b64_tr_b16 v[180:181], v10 offset:176
ds_read_b64_tr_b16 v[182:183], v10 offset:3760
ds_read_b64_tr_b16 v[184:185], v10 offset:1792
ds_read_b64_tr_b16 v[186:187], v10 offset:5376
ds_read_b64_tr_b16 v[188:189], v10 offset:1856
ds_read_b64_tr_b16 v[190:191], v10 offset:5440
ds_read_b64_tr_b16 v[192:193], v10 offset:1904
ds_read_b64_tr_b16 v[194:195], v10 offset:5488
s_waitcnt lgkmcnt(12)
ds_read_b64_tr_b16 v[196:197], v10 offset:1968
ds_read_b64_tr_b16 v[198:199], v10 offset:5552
s_waitcnt lgkmcnt(0)
s_branch L_rsgo_30
L_rs6_29:
ds_read_b64_tr_b16 v[168:169], v11 offset:0
ds_read_b64_tr_b16 v[170:171], v11 offset:896
ds_read_b64_tr_b16 v[172:173], v11 offset:64
ds_read_b64_tr_b16 v[174:175], v11 offset:960
ds_read_b64_tr_b16 v[176:177], v11 offset:112
ds_read_b64_tr_b16 v[178:179], v11 offset:1008
ds_read_b64_tr_b16 v[180:181], v11 offset:176
ds_read_b64_tr_b16 v[182:183], v11 offset:1072
L_rsgo_30:
s_lshr_b32 s46, s2, 4
s_mul_i32 s46, s46, 14336
s_lshl_b32 s47, s48, 12
s_add_u32 s46, s46, s47
s_and_b32 s47, s2, 3
s_mul_i32 s47, s47, 458752
s_add_u32 s46, s46, s47
s_add_u32 s46, s46, 22282240
s_add_u32 s47, s46, 229376
s_waitcnt lgkmcnt(6)
buffer_store_dwordx4 v[168:171], v1, s[28:31], s46 offen offset:0 sc1
s_waitcnt lgkmcnt(4)
buffer_store_dwordx4 v[172:175], v1, s[28:31], s46 offen offset:1024 sc1
s_waitcnt lgkmcnt(2)
buffer_store_dwordx4 v[176:179], v1, s[28:31], s47 offen offset:0 sc1
s_waitcnt lgkmcnt(0)
buffer_store_dwordx4 v[180:183], v1, s[28:31], s47 offen offset:1024 sc1
s_cmp_eq_u32 s48, 3
s_cbranch_scc1 L_rss_27
s_waitcnt lgkmcnt(6)
buffer_store_dwordx4 v[184:187], v1, s[28:31], s46 offen offset:2048 sc1
s_waitcnt lgkmcnt(4)
buffer_store_dwordx4 v[188:191], v1, s[28:31], s46 offen offset:3072 sc1
s_waitcnt lgkmcnt(2)
buffer_store_dwordx4 v[192:195], v1, s[28:31], s47 offen offset:2048 sc1
s_waitcnt lgkmcnt(0)
buffer_store_dwordx4 v[196:199], v1, s[28:31], s47 offen offset:3072 sc1
L_rss2_28:
L_rss_27:
s_lshl_b32 s46, s38, 8
s_add_u32 s46, s46, 160768
v_and_b32 v2, 31, v0
v_cmp_eq_u32 s[50:51], 28, v2
v_lshlrev_b32 v2, 2, v2
v_add_u32 v3, s46, v2
v_lshrrev_b32 v4, 5, v0
v_lshlrev_b32 v4, 4, v4
v_add_u32 v5, 157696, v4
v_add_u32 v4, s46, v4
v_add_u32 v2, 157696, v2
s_lshl_b32 s47, s37, 6
s_add_u32 s47, s47, s42
s_lshl_b32 s48, s47, 12
s_add_u32 s48, s48, 13893632
s_lshl_b32 s47, s47, 7
s_add_u32 s54, s47, 65536
s_lshl_b32 s49, s38, 12
s_add_u32 s49, s49, 140288
v_add_u32 v7, s49, v1
v_add_u32 v11, 107520, v1
s_add_u32 s57, s100, 28356608
s_add_u32 m0, s101, 16384
s_nop 0
buffer_load_dwordx4 v1, s[28:31], s57 offen lds
s_add_u32 s57, s100, 28385280
s_add_u32 m0, s101, 45056
s_nop 0
buffer_load_dwordx4 v1, s[28:31], s57 offen lds
s_add_u32 s57, s100, 28360704
s_add_u32 m0, s101, 20480
s_nop 0
buffer_load_dwordx4 v1, s[28:31], s57 offen lds
s_mul_i32 s53, s37, 384
s_add_u32 s53, s53, 29753344
s_mov_b64 exec, 0xffffff
s_add_u32 s57, s53, 0
buffer_load_dwordx4 v[16:19], v1, s[28:31], s57 offen sc1
s_add_u32 s57, s53, 6144
buffer_load_dwordx4 v[20:23], v1, s[28:31], s57 offen sc1
s_add_u32 s57, s53, 12288
buffer_load_dwordx4 v[32:35], v1, s[28:31], s57 offen sc1
s_add_u32 s57, s53, 18432
buffer_load_dwordx4 v[36:39], v1, s[28:31], s57 offen sc1
s_mov_b64 exec, -1
v_add_u32 v10, 157696, v1
s_cmp_eq_u32 s38, 1
s_cbranch_scc1 L_w12_32
s_cmp_lg_u32 s38, 2
s_cbranch_scc1 L_w03_31
s_cmp_ge_u32 s2, 224
s_cbranch_scc1 L_w03_31
s_branch L_w12_32
L_w03_31:
s_waitcnt vmcnt(7)
L_w12_32:
s_waitcnt vmcnt(11)
s_barrier
ds_read_b128 v[216:219], v1 offset:0
ds_read_b128 v[220:223], v1 offset:28672
ds_read_b128 v[224:227], v1 offset:1024
ds_read_b128 v[228:231], v1 offset:29696
ds_read_b128 v[232:235], v1 offset:2048
ds_read_b128 v[236:239], v1 offset:30720
s_waitcnt lgkmcnt(4)
v_mfma_f32_32x32x16_bf16 v[168:183], v[216:219], v[56:59], 0
ds_read_b128 v[240:243], v1 offset:3072
s_add_u32 s57, s100, 28389376
s_add_u32 m0, s101, 49152
s_nop 0
buffer_load_dwordx4 v1, s[28:31], s57 offen lds
v_mfma_f32_32x32x16_bf16 v[184:199], v[56:59], v[220:223], 0
ds_read_b128 v[244:247], v1 offset:31744
s_waitcnt lgkmcnt(4)
v_mfma_f32_32x32x16_bf16 v[168:183], v[224:227], v[60:63], v[168:183]
ds_read_b128 v[216:219], v1 offset:4096
s_add_u32 s57, s100, 28364800
s_add_u32 m0, s101, 24576
s_nop 0
buffer_load_dwordx4 v1, s[28:31], s57 offen lds
v_mfma_f32_32x32x16_bf16 v[184:199], v[60:63], v[228:231], v[184:199]
ds_read_b128 v[220:223], v1 offset:32768
s_waitcnt lgkmcnt(4)
v_mfma_f32_32x32x16_bf16 v[168:183], v[232:235], v[64:67], v[168:183]
ds_read_b128 v[224:227], v1 offset:5120
s_add_u32 s57, s100, 28393472
s_add_u32 m0, s101, 53248
s_nop 0
buffer_load_dwordx4 v1, s[28:31], s57 offen lds
v_mfma_f32_32x32x16_bf16 v[184:199], v[64:67], v[236:239], v[184:199]
ds_read_b128 v[228:231], v1 offset:33792
s_waitcnt lgkmcnt(4)
v_mfma_f32_32x32x16_bf16 v[168:183], v[240:243], v[68:71], v[168:183]
ds_read_b128 v[232:235], v1 offset:6144
s_add_u32 s57, s100, 28311552
s_add_u32 m0, s101, 107520
s_nop 0
buffer_load_dwordx4 v1, s[28:31], s57 offen lds
v_mfma_f32_32x32x16_bf16 v[184:199], v[68:71], v[244:247], v[184:199]
ds_read_b128 v[236:239], v1 offset:34816
s_waitcnt lgkmcnt(4)
v_mfma_f32_32x32x16_bf16 v[168:183], v[216:219], v[72:75], v[168:183]
ds_read_b128 v[240:243], v1 offset:7168
s_add_u32 s57, s100, 28315648
s_add_u32 m0, s101, 111616
s_nop 0
buffer_load_dwordx4 v1, s[28:31], s57 offen lds
v_mfma_f32_32x32x16_bf16 v[184:199], v[72:75], v[220:223], v[184:199]
ds_read_b128 v[244:247], v1 offset:35840
s_waitcnt lgkmcnt(4)
v_mfma_f32_32x32x16_bf16 v[168:183], v[224:227], v[76:79], v[168:183]
ds_read_b128 v[216:219], v1 offset:8192
s_add_u32 s57, s100, 28319744
s_add_u32 m0, s101, 115712
s_nop 0
buffer_load_dwordx4 v1, s[28:31], s57 offen lds
v_mfma_f32_32x32x16_bf16 v[184:199], v[76:79], v[228:231], v[184:199]
ds_read_b128 v[220:223], v1 offset:36864
s_waitcnt lgkmcnt(4)
v_mfma_f32_32x32x16_bf16 v[168:183], v[232:235], v[80:83], v[168:183]
ds_read_b128 v[224:227], v1 offset:9216
v_mfma_f32_32x32x16_bf16 v[184:199], v[80:83], v[236:239], v[184:199]
ds_read_b128 v[228:231], v1 offset:37888
s_waitcnt lgkmcnt(4)
v_mfma_f32_32x32x16_bf16 v[168:183], v[240:243], v[84:87], v[168:183]
ds_read_b128 v[232:235], v1 offset:10240
s_add_u32 s57, s100, 28323840
s_add_u32 m0, s101, 119808
s_nop 0
buffer_load_dwordx4 v1, s[28:31], s57 offen lds
v_mfma_f32_32x32x16_bf16 v[184:199], v[84:87], v[244:247], v[184:199]
ds_read_b128 v[236:239], v1 offset:38912
s_waitcnt lgkmcnt(4)
v_mfma_f32_32x32x16_bf16 v[168:183], v[216:219], v[88:91], v[168:183]
ds_read_b128 v[240:243], v1 offset:11264
v_mfma_f32_32x32x16_bf16 v[184:199], v[88:91], v[220:223], v[184:199]
ds_read_b128 v[244:247], v1 offset:39936
v_mov_b32 v40, v2
v_mov_b32 v41, v3
v_mov_b32 v42, v4
v_mov_b32 v43, v5
s_cmp_eq_u32 s38, 1
s_cbranch_scc1 L_rf_34
s_cmp_lg_u32 s38, 2
s_cbranch_scc1 L_norf_33
s_cmp_ge_u32 s2, 224
s_cbranch_scc1 L_norf_33
L_rf_34:
s_waitcnt vmcnt(14)
s_lshl_b32 s46, s38, 8
s_add_u32 s46, s46, s2
s_lshl_b32 s46, s46, 7
s_add_u32 s46, s46, 851968
v_mov_b32 v2, s44
v_mov_b32 v3, s45
v_mov_b32 v4, s44
v_mov_b32 v5, s45
s_mov_b64 exec, 0xff
buffer_store_dwordx4 v[2:5], v1, s[28:31], s46 offen sc1
s_mov_b64 exec, -1
L_norf_33:
s_cmp_lg_u32 s38, 3
s_cbranch_scc1 L_noxid_35
s_getreg_b32 s46, hwreg(HW_REG_XCC_ID, 0, 4)
s_lshl_b32 s47, s36, 4
s_add_u32 s47, s47, s37
s_lshl_b32 s47, s47, 7
s_add_u32 s47, s47, 983040
v_mov_b32 v2, s44
v_mov_b32 v3, s45
v_mov_b32 v4, s46
v_mov_b32 v5, 0
s_mov_b64 exec, 0xff
buffer_store_dwordx4 v[2:5], v1, s[28:31], s47 offen sc1
s_mov_b64 exec, -1
L_noxid_35:
s_nop 0
v_mov_b32 v2, v40
v_mov_b32 v3, v41
v_mov_b32 v4, v42
v_mov_b32 v5, v43
s_waitcnt lgkmcnt(4)
v_mfma_f32_32x32x16_bf16 v[168:183], v[224:227], v[92:95], v[168:183]
ds_read_b128 v[216:219], v1 offset:12288
s_add_u32 s57, s100, 28327936
s_add_u32 m0, s101, 123904
s_nop 0
buffer_load_dwordx4 v1, s[28:31], s57 offen lds
v_mfma_f32_32x32x16_bf16 v[184:199], v[92:95], v[228:231], v[184:199]
ds_read_b128 v[220:223], v1 offset:40960
s_waitcnt lgkmcnt(4)
v_mfma_f32_32x32x16_bf16 v[168:183], v[232:235], v[96:99], v[168:183]
ds_read_b128 v[224:227], v1 offset:13312
v_mfma_f32_32x32x16_bf16 v[184:199], v[96:99], v[236:239], v[184:199]
ds_read_b128 v[228:231], v1 offset:41984
s_waitcnt lgkmcnt(4)
v_mfma_f32_32x32x16_bf16 v[168:183], v[240:243], v[100:103], v[168:183]
ds_read_b128 v[232:235], v1 offset:14336
s_add_u32 s57, s100, 28332032
s_add_u32 m0, s101, 128000
s_nop 0
buffer_load_dwordx4 v1, s[28:31], s57 offen lds
v_mfma_f32_32x32x16_bf16 v[184:199], v[100:103], v[244:247], v[184:199]
ds_read_b128 v[236:239], v1 offset:43008
s_waitcnt lgkmcnt(4)
v_mfma_f32_32x32x16_bf16 v[168:183], v[216:219], v[104:107], v[168:183]
ds_read_b128 v[240:243], v1 offset:15360
v_mfma_f32_32x32x16_bf16 v[184:199], v[104:107], v[220:223], v[184:199]
ds_read_b128 v[244:247], v1 offset:44032
s_waitcnt lgkmcnt(4)
v_mfma_f32_32x32x16_bf16 v[168:183], v[224:227], v[108:111], v[168:183]
s_add_u32 s57, s100, 28336128
s_add_u32 m0, s101, 132096
s_nop 0
buffer_load_dwordx4 v1, s[28:31], s57 offen lds
v_mfma_f32_32x32x16_bf16 v[184:199], v[108:111], v[228:231], v[184:199]
s_waitcnt lgkmcnt(2)
v_mfma_f32_32x32x16_bf16 v[168:183], v[232:235], v[112:115], v[168:183]
v_mfma_f32_32x32x16_bf16 v[184:199], v[112:115], v[236:239], v[184:199]
s_waitcnt lgkmcnt(0)
v_mfma_f32_32x32x16_bf16 v[168:183], v[240:243], v[116:119], v[168:183]
v_mfma_f32_32x32x16_bf16 v[184:199], v[116:119], v[244:247], v[184:199]
s_waitcnt vmcnt(7)
v_pk_add_f32 v[16:17], v[16:17], v[20:21]
v_pk_add_f32 v[32:33], v[32:33], v[36:37]
v_pk_add_f32 v[16:17], v[16:17], v[32:33]
v_pk_add_f32 v[18:19], v[18:19], v[22:23]
v_pk_add_f32 v[34:35], v[34:35], v[38:39]
v_pk_add_f32 v[18:19], v[18:19], v[34:35]
s_mov_b64 exec, 0xffffff
ds_write_b128 v10, v[16:19]
s_mov_b64 exec, -1
s_waitcnt lgkmcnt(0)
s_barrier
ds_read_b128 v[216:219], v1 offset:16384
ds_read_b128 v[220:223], v1 offset:45056
ds_read_b128 v[224:227], v1 offset:17408
ds_read_b128 v[228:231], v1 offset:46080
ds_read_b128 v[232:235], v1 offset:18432
ds_read_b128 v[236:239], v1 offset:47104
s_waitcnt lgkmcnt(4)
v_mfma_f32_32x32x16_bf16 v[168:183], v[216:219], v[120:123], v[168:183]
ds_read_b128 v[240:243], v1 offset:19456
v_mfma_f32_32x32x16_bf16 v[184:199], v[120:123], v[220:223], v[184:199]
ds_read_b128 v[244:247], v1 offset:48128
s_waitcnt lgkmcnt(4)
v_mfma_f32_32x32x16_bf16 v[168:183], v[224:227], v[124:127], v[168:183]
ds_read_b128 v[216:219], v1 offset:20480
v_mfma_f32_32x32x16_bf16 v[184:199], v[124:127], v[228:231], v[184:199]
ds_read_b128 v[220:223], v1 offset:49152
s_waitcnt lgkmcnt(4)
v_mfma_f32_32x32x16_bf16 v[168:183], v[232:235], v[128:131], v[168:183]
ds_read_b128 v[224:227], v1 offset:21504
v_mfma_f32_32x32x16_bf16 v[184:199], v[128:131], v[236:239], v[184:199]
ds_read_b128 v[228:231], v1 offset:50176
s_waitcnt lgkmcnt(4)
v_mfma_f32_32x32x16_bf16 v[168:183], v[240:243], v[132:135], v[168:183]
ds_read_b128 v[232:235], v1 offset:22528
v_mfma_f32_32x32x16_bf16 v[184:199], v[132:135], v[244:247], v[184:199]
ds_read_b128 v[236:239], v1 offset:51200
s_waitcnt lgkmcnt(4)
v_mfma_f32_32x32x16_bf16 v[168:183], v[216:219], v[136:139], v[168:183]
ds_read_b128 v[240:243], v1 offset:23552
v_mfma_f32_32x32x16_bf16 v[184:199], v[136:139], v[220:223], v[184:199]
ds_read_b128 v[244:247], v1 offset:52224
s_waitcnt lgkmcnt(4)
v_mfma_f32_32x32x16_bf16 v[168:183], v[224:227], v[140:143], v[168:183]
ds_read_b128 v[216:219], v1 offset:24576
v_mfma_f32_32x32x16_bf16 v[184:199], v[140:143], v[228:231], v[184:199]
ds_read_b128 v[220:223], v1 offset:53248
s_waitcnt lgkmcnt(4)
v_mfma_f32_32x32x16_bf16 v[168:183], v[232:235], v[144:147], v[168:183]
ds_read_b128 v[224:227], v1 offset:25600
v_mfma_f32_32x32x16_bf16 v[184:199], v[144:147], v[236:239], v[184:199]
ds_read_b128 v[228:231], v1 offset:54272
s_waitcnt lgkmcnt(4)
v_mfma_f32_32x32x16_bf16 v[168:183], v[240:243], v[148:151], v[168:183]
ds_read_b128 v[232:235], v1 offset:26624
v_mfma_f32_32x32x16_bf16 v[184:199], v[148:151], v[244:247], v[184:199]
ds_read_b128 v[236:239], v1 offset:55296
s_waitcnt lgkmcnt(4)
v_mfma_f32_32x32x16_bf16 v[168:183], v[216:219], v[152:155], v[168:183]
ds_read_b128 v[240:243], v1 offset:27648
v_mfma_f32_32x32x16_bf16 v[184:199], v[152:155], v[220:223], v[184:199]
ds_read_b128 v[244:247], v1 offset:56320
s_waitcnt lgkmcnt(4)
v_mfma_f32_32x32x16_bf16 v[168:183], v[224:227], v[156:159], v[168:183]
ds_write_b32 v3, v12
ds_write_b32 v3, v13 offset:128
v_mfma_f32_32x32x16_bf16 v[184:199], v[156:159], v[228:231], v[184:199]
ds_read_b32 v6, v2 offset:256
ds_read_b128 v[200:203], v4 offset:0
s_waitcnt lgkmcnt(6)
v_mfma_f32_32x32x16_bf16 v[168:183], v[232:235], v[160:163], v[168:183]
ds_read_b128 v[204:207], v4 offset:32
ds_read_b128 v[208:211], v4 offset:64
v_mfma_f32_32x32x16_bf16 v[184:199], v[160:163], v[236:239], v[184:199]
ds_read_b128 v[212:215], v4 offset:96
ds_read_b128 v[248:251], v5 offset:128
s_waitcnt lgkmcnt(8)
v_mfma_f32_32x32x16_bf16 v[168:183], v[240:243], v[164:167], v[168:183]
ds_read_b128 v[252:255], v5 offset:160
v_mfma_f32_32x32x16_bf16 v[184:199], v[164:167], v[244:247], v[184:199]
ds_read_b128 v[224:227], v5 offset:192
ds_read_b128 v[228:231], v5 offset:224
ds_read_b128 v[232:235], v4 offset:128
ds_read_b128 v[236:239], v4 offset:160
ds_read_b128 v[240:243], v4 offset:192
ds_read_b128 v[244:247], v4 offset:224
s_nop 3
v_pk_mul_f32 v[168:169], v[168:169], v[12:13] op_sel_hi:[1,0]
v_pk_mul_f32 v[170:171], v[170:171], v[12:13] op_sel_hi:[1,0]
v_pk_mul_f32 v[172:173], v[172:173], v[12:13] op_sel_hi:[1,0]
v_pk_mul_f32 v[174:175], v[174:175], v[12:13] op_sel_hi:[1,0]
v_pk_mul_f32 v[176:177], v[176:177], v[12:13] op_sel_hi:[1,0]
v_pk_mul_f32 v[178:179], v[178:179], v[12:13] op_sel_hi:[1,0]
v_pk_mul_f32 v[180:181], v[180:181], v[12:13] op_sel_hi:[1,0]
v_pk_mul_f32 v[182:183], v[182:183], v[12:13] op_sel_hi:[1,0]
s_waitcnt lgkmcnt(4)
v_pk_fma_f32 v[168:169], v[248:249], v[12:13], v[168:169] op_sel:[0,1,0] op_sel_hi:[1,1,1]
v_pk_fma_f32 v[170:171], v[250:251], v[12:13], v[170:171] op_sel:[0,1,0] op_sel_hi:[1,1,1]
v_pk_fma_f32 v[172:173], v[252:253], v[12:13], v[172:173] op_sel:[0,1,0] op_sel_hi:[1,1,1]
v_pk_fma_f32 v[174:175], v[254:255], v[12:13], v[174:175] op_sel:[0,1,0] op_sel_hi:[1,1,1]
v_pk_fma_f32 v[176:177], v[224:225], v[12:13], v[176:177] op_sel:[0,1,0] op_sel_hi:[1,1,1]
v_pk_fma_f32 v[178:179], v[226:227], v[12:13], v[178:179] op_sel:[0,1,0] op_sel_hi:[1,1,1]
v_pk_fma_f32 v[180:181], v[228:229], v[12:13], v[180:181] op_sel:[0,1,0] op_sel_hi:[1,1,1]
v_pk_fma_f32 v[182:183], v[230:231], v[12:13], v[182:183] op_sel:[0,1,0] op_sel_hi:[1,1,1]
v_cvt_pk_bf16_f32 v168, v168, v169
v_cvt_pk_bf16_f32 v169, v170, v171
v_cvt_pk_bf16_f32 v170, v172, v173
v_cvt_pk_bf16_f32 v171, v174, v175
v_cvt_pk_bf16_f32 v172, v176, v177
v_cvt_pk_bf16_f32 v173, v178, v179
v_cvt_pk_bf16_f32 v174, v180, v181
v_cvt_pk_bf16_f32 v175, v182, v183
s_mov_b32 exec_lo, 0
v_mov_b32 v174, 0
v_mov_b32 v175, 0
s_mov_b32 exec_lo, -1
buffer_store_dwordx4 v[168:171], v1, s[28:31], s48 offen offset:0 sc1
buffer_store_dwordx4 v[172:175], v1, s[28:31], s48 offen offset:1024 sc1
s_waitcnt lgkmcnt(0)
v_pk_mul_f32 v[232:233], v[232:233], v[6:7] op_sel_hi:[1,0]
v_pk_mul_f32 v[234:235], v[234:235], v[6:7] op_sel_hi:[1,0]
v_pk_mul_f32 v[236:237], v[236:237], v[6:7] op_sel_hi:[1,0]
v_pk_mul_f32 v[238:239], v[238:239], v[6:7] op_sel_hi:[1,0]
v_pk_mul_f32 v[240:241], v[240:241], v[6:7] op_sel_hi:[1,0]
v_pk_mul_f32 v[242:243], v[242:243], v[6:7] op_sel_hi:[1,0]
v_pk_mul_f32 v[244:245], v[244:245], v[6:7] op_sel_hi:[1,0]
v_pk_mul_f32 v[246:247], v[246:247], v[6:7] op_sel_hi:[1,0]
v_pk_fma_f32 v[232:233], v[184:185], v[200:201], v[232:233]
v_pk_fma_f32 v[234:235], v[186:187], v[202:203], v[234:235]
v_pk_fma_f32 v[236:237], v[188:189], v[204:205], v[236:237]
v_pk_fma_f32 v[238:239], v[190:191], v[206:207], v[238:239]
v_pk_fma_f32 v[240:241], v[192:193], v[208:209], v[240:241]
v_pk_fma_f32 v[242:243], v[194:195], v[210:211], v[242:243]
v_pk_fma_f32 v[244:245], v[196:197], v[212:213], v[244:245]
v_pk_fma_f32 v[246:247], v[198:199], v[214:215], v[246:247]
v_cvt_pk_bf16_f32 v184, v232, v233
v_cvt_pk_bf16_f32 v185, v234, v235
v_cvt_pk_bf16_f32 v186, v236, v237
v_cvt_pk_bf16_f32 v187, v238, v239
v_cvt_pk_bf16_f32 v188, v240, v241
v_cvt_pk_bf16_f32 v189, v242, v243
v_cvt_pk_bf16_f32 v190, v244, v245
v_cvt_pk_bf16_f32 v191, v246, v247
s_mov_b32 s46, s58
s_mov_b32 s47, s58
s_mov_b64 exec, s[50:51]
v_mov_b64 v[184:185], s[46:47]
v_mov_b64 v[186:187], s[46:47]
v_mov_b64 v[188:189], s[46:47]
v_mov_b64 v[190:191], s[46:47]
s_mov_b64 exec, -1
buffer_store_dwordx4 v[184:187], v1, s[28:31], s48 offen offset:2048 sc1
buffer_store_dwordx4 v[188:191], v1, s[28:31], s48 offen offset:3072 sc1
ds_write_b128 v7, v[168:171] offset:0
ds_write_b128 v7, v[184:187] offset:2048
ds_write_b128 v7, v[172:175] offset:1024
ds_write_b128 v7, v[188:191] offset:3072
ds_read_b128 v[248:251], v5 offset:0
ds_read_b128 v[252:255], v5 offset:32
ds_read_b128 v[192:195], v5 offset:64
ds_read_b128 v[196:199], v5 offset:96
s_mul_i32 s56, s42, 28672
s_mul_i32 s57, s37, 1792
s_add_u32 s56, s56, s57
s_add_u32 s56, s56, 1048576
v_mul_u32_u24 v14, 128, v0
s_mov_b32 exec_lo, 0x3fff
s_mov_b32 exec_hi, 0x0
buffer_load_dword v14, v14, s[28:31], s56 offen
s_mov_b64 exec, -1
s_lshl_b32 s56, s42, 7
s_add_u32 s56, s56, 8192
v_mul_u32_u24 v14, 8192, v0
s_mov_b32 exec_lo, 0x1f
s_mov_b32 exec_hi, 0x0
buffer_load_dword v14, v14, s[28:31], s56 offen
s_mov_b64 exec, -1
s_mul_i32 s56, s42, 28672
s_mul_i32 s57, s37, 1792
s_add_u32 s56, s56, s57
s_add_u32 s56, s56, 2883584
v_mul_u32_u24 v14, 128, v0
s_mov_b32 exec_lo, 0x3fff
s_mov_b32 exec_hi, 0x0
buffer_load_dword v14, v14, s[28:31], s56 offen
s_mov_b64 exec, -1
s_mul_i32 s56, s42, 4096
s_mul_i32 s57, s37, 256
s_add_u32 s56, s56, s57
s_add_u32 s56, s56, 327680
v_mul_u32_u24 v14, 128, v0
s_mov_b32 exec_lo, 0x3
s_mov_b32 exec_hi, 0x0
buffer_load_dword v14, v14, s[28:31], s56 offen
s_mov_b64 exec, -1
s_lshl_b32 s46, s38, 6
s_lshr_b32 s47, s41, 1
s_add_u32 s46, s46, s47
s_add_u32 s46, s46, 256
v_lshl_add_u32 v6, v0, 2, s46
s_add_u32 s46, s37, 256
v_lshl_add_u32 v8, v0, 4, s46
v_cmp_lt_u32 vcc, 15, v0
s_nop 1
v_cndmask_b32 v6, v6, v8, vcc
s_lshl_b32 s46, s38, 4
s_lshl_b32 s47, s41, 1
s_add_u32 s46, s46, s47
s_add_u32 s46, s46, 162
v_add_u32 v8, s46, v0
v_cmp_lt_u32 vcc, 29, v0
s_nop 1
v_cndmask_b32 v6, v6, v8, vcc
v_lshlrev_b32 v6, 7, v6
s_mov_b32 s51, 851968
s_mov_b32 exec_hi, 0
buffer_load_dwordx2 v[8:9], v6, s[28:31], s51 offen sc1
s_mov_b64 exec, -1
s_waitcnt vmcnt(9)
s_waitcnt lgkmcnt(0)
s_barrier
ds_read_b128 v[216:219], v11 offset:0
ds_read_b128 v[220:223], v11 offset:1024
ds_read_b128 v[224:227], v11 offset:2048
ds_read_b128 v[228:231], v11 offset:3072
ds_read_b128 v[232:235], v11 offset:4096
ds_read_b128 v[236:239], v11 offset:5120
ds_read_b128 v[240:243], v11 offset:6144
s_waitcnt lgkmcnt(6)
v_mfma_f32_32x32x16_bf16 v[200:215], v[216:219], v[56:59], 0
ds_read_b128 v[244:247], v11 offset:7168
s_waitcnt lgkmcnt(6)
v_mfma_f32_32x32x16_bf16 v[200:215], v[220:223], v[60:63], v[200:215]
ds_read_b128 v[216:219], v11 offset:8192
s_waitcnt lgkmcnt(6)
v_mfma_f32_32x32x16_bf16 v[200:215], v[224:227], v[64:67], v[200:215]
ds_read_b128 v[220:223], v11 offset:9216
s_waitcnt lgkmcnt(6)
v_mfma_f32_32x32x16_bf16 v[200:215], v[228:231], v[68:71], v[200:215]
ds_read_b128 v[224:227], v11 offset:10240
s_waitcnt lgkmcnt(6)
v_mfma_f32_32x32x16_bf16 v[200:215], v[232:235], v[72:75], v[200:215]
ds_read_b128 v[228:231], v11 offset:11264
s_waitcnt lgkmcnt(6)
v_mfma_f32_32x32x16_bf16 v[200:215], v[236:239], v[76:79], v[200:215]
ds_read_b128 v[232:235], v11 offset:12288
s_waitcnt lgkmcnt(6)
v_mfma_f32_32x32x16_bf16 v[200:215], v[240:243], v[80:83], v[200:215]
ds_read_b128 v[236:239], v11 offset:13312
s_waitcnt lgkmcnt(6)
v_mfma_f32_32x32x16_bf16 v[200:215], v[244:247], v[84:87], v[200:215]
ds_read_b128 v[240:243], v11 offset:14336
s_waitcnt lgkmcnt(6)
v_mfma_f32_32x32x16_bf16 v[200:215], v[216:219], v[88:91], v[200:215]
ds_read_b128 v[244:247], v11 offset:15360
s_waitcnt lgkmcnt(6)
v_mfma_f32_32x32x16_bf16 v[200:215], v[220:223], v[92:95], v[200:215]
ds_read_b128 v[216:219], v11 offset:16384
s_waitcnt lgkmcnt(6)
v_mfma_f32_32x32x16_bf16 v[200:215], v[224:227], v[96:99], v[200:215]
ds_read_b128 v[220:223], v11 offset:17408
s_waitcnt lgkmcnt(6)
v_mfma_f32_32x32x16_bf16 v[200:215], v[228:231], v[100:103], v[200:215]
ds_read_b128 v[224:227], v11 offset:18432
s_waitcnt lgkmcnt(6)
v_mfma_f32_32x32x16_bf16 v[200:215], v[232:235], v[104:107], v[200:215]
ds_read_b128 v[228:231], v11 offset:19456
s_waitcnt lgkmcnt(6)
v_mfma_f32_32x32x16_bf16 v[200:215], v[236:239], v[108:111], v[200:215]
ds_read_b128 v[232:235], v11 offset:20480
s_waitcnt lgkmcnt(6)
v_mfma_f32_32x32x16_bf16 v[200:215], v[240:243], v[112:115], v[200:215]
ds_read_b128 v[236:239], v11 offset:21504
s_waitcnt lgkmcnt(6)
v_mfma_f32_32x32x16_bf16 v[200:215], v[244:247], v[116:119], v[200:215]
ds_read_b128 v[240:243], v11 offset:22528
s_waitcnt lgkmcnt(6)
v_mfma_f32_32x32x16_bf16 v[200:215], v[216:219], v[120:123], v[200:215]
ds_read_b128 v[244:247], v11 offset:23552
s_waitcnt lgkmcnt(6)
v_mfma_f32_32x32x16_bf16 v[200:215], v[220:223], v[124:127], v[200:215]
ds_read_b128 v[216:219], v11 offset:24576
s_waitcnt lgkmcnt(6)
v_mfma_f32_32x32x16_bf16 v[200:215], v[224:227], v[128:131], v[200:215]
ds_read_b128 v[220:223], v11 offset:25600
s_waitcnt lgkmcnt(6)
v_mfma_f32_32x32x16_bf16 v[200:215], v[228:231], v[132:135], v[200:215]
ds_read_b128 v[224:227], v11 offset:26624
s_waitcnt lgkmcnt(6)
v_mfma_f32_32x32x16_bf16 v[200:215], v[232:235], v[136:139], v[200:215]
ds_read_b128 v[228:231], v11 offset:27648
s_waitcnt lgkmcnt(6)
v_mfma_f32_32x32x16_bf16 v[200:215], v[236:239], v[140:143], v[200:215]
s_waitcnt lgkmcnt(5)
v_mfma_f32_32x32x16_bf16 v[200:215], v[240:243], v[144:147], v[200:215]
s_waitcnt lgkmcnt(4)
v_mfma_f32_32x32x16_bf16 v[200:215], v[244:247], v[148:151], v[200:215]
s_waitcnt lgkmcnt(3)
v_mfma_f32_32x32x16_bf16 v[200:215], v[216:219], v[152:155], v[200:215]
v_mov_b32 v2, s44
v_mov_b32 v3, s45
v_mov_b32 v4, s44
v_mov_b32 v5, s45
s_mov_b64 exec, 0xff
s_waitcnt vmcnt(5)
buffer_store_dwordx4 v[2:5], v1, s[28:31], s54 offen sc1
s_mov_b64 exec, -1
s_waitcnt lgkmcnt(2)
v_mfma_f32_32x32x16_bf16 v[200:215], v[220:223], v[156:159], v[200:215]
s_waitcnt lgkmcnt(1)
v_mfma_f32_32x32x16_bf16 v[200:215], v[224:227], v[160:163], v[200:215]
s_waitcnt lgkmcnt(0)
v_mfma_f32_32x32x16_bf16 v[200:215], v[228:231], v[164:167], v[200:215]
v_mul_f32 v12, 0x3e8b97f6, v12
v_mul_f32 v13, 0x3e8b97f6, v13
s_waitcnt vmcnt(1)
s_mov_b32 exec_hi, 0
v_cmp_ne_u64 vcc, s[44:45], v[8:9]
s_cbranch_vccnz L_chk_36
L_chkok_37:
s_mov_b64 exec, -1
s_mul_i32 s3, s37, 100352
s_add_u32 s3, s3, 24641536
s_lshl_b32 s43, s38, 10
s_add_u32 s3, s3, s43
s_nop 0
v_pk_mul_f32 v[200:201], v[200:201], v[12:13] op_sel_hi:[1,0]
v_pk_mul_f32 v[202:203], v[202:203], v[12:13] op_sel_hi:[1,0]
v_pk_mul_f32 v[204:205], v[204:205], v[12:13] op_sel_hi:[1,0]
v_pk_mul_f32 v[206:207], v[206:207], v[12:13] op_sel_hi:[1,0]
v_pk_mul_f32 v[208:209], v[208:209], v[12:13] op_sel_hi:[1,0]
v_pk_mul_f32 v[210:211], v[210:211], v[12:13] op_sel_hi:[1,0]
v_pk_mul_f32 v[212:213], v[212:213], v[12:13] op_sel_hi:[1,0]
v_pk_mul_f32 v[214:215], v[214:215], v[12:13] op_sel_hi:[1,0]
s_barrier
s_add_u32 s57, s3, 0
s_add_u32 m0, s43, 57344
s_nop 0
buffer_load_dwordx4 v1, s[28:31], s57 offen lds
v_pk_fma_f32 v[200:201], v[248:249], v[12:13], v[200:201] op_sel:[0,1,0] op_sel_hi:[1,1,1]
s_add_u32 s57, s3, 4096
s_add_u32 m0, s43, 61440
s_nop 0
buffer_load_dwordx4 v1, s[28:31], s57 offen lds
v_pk_fma_f32 v[202:203], v[250:251], v[12:13], v[202:203] op_sel:[0,1,0] op_sel_hi:[1,1,1]
s_add_u32 s57, s3, 8192
s_add_u32 m0, s43, 65536
s_nop 0
buffer_load_dwordx4 v1, s[28:31], s57 offen lds
v_pk_fma_f32 v[204:205], v[252:253], v[12:13], v[204:205] op_sel:[0,1,0] op_sel_hi:[1,1,1]
s_add_u32 s57, s3, 12288
s_add_u32 m0, s43, 69632
s_nop 0
buffer_load_dwordx4 v1, s[28:31], s57 offen lds
v_pk_fma_f32 v[206:207], v[254:255], v[12:13], v[206:207] op_sel:[0,1,0] op_sel_hi:[1,1,1]
s_add_u32 s57, s3, 16384
s_add_u32 m0, s43, 73728
s_nop 0
buffer_load_dwordx4 v1, s[28:31], s57 offen lds
v_pk_fma_f32 v[208:209], v[192:193], v[12:13], v[208:209] op_sel:[0,1,0] op_sel_hi:[1,1,1]
s_add_u32 s57, s3, 20480
s_add_u32 m0, s43, 77824
s_nop 0
buffer_load_dwordx4 v1, s[28:31], s57 offen lds
v_pk_fma_f32 v[210:211], v[194:195], v[12:13], v[210:211] op_sel:[0,1,0] op_sel_hi:[1,1,1]
s_add_u32 s57, s3, 24576
s_add_u32 m0, s43, 81920
s_nop 0
buffer_load_dwordx4 v1, s[28:31], s57 offen lds
v_pk_fma_f32 v[212:213], v[196:197], v[12:13], v[212:213] op_sel:[0,1,0] op_sel_hi:[1,1,1]
s_add_u32 s57, s3, 28672
s_add_u32 m0, s43, 86016
s_nop 0
buffer_load_dwordx4 v1, s[28:31], s57 offen lds
v_pk_fma_f32 v[214:215], v[198:199], v[12:13], v[214:215] op_sel:[0,1,0] op_sel_hi:[1,1,1]
v_cvt_pk_bf16_f32 v56, v200, v201
v_cvt_pk_bf16_f32 v57, v202, v203
v_cvt_pk_bf16_f32 v58, v204, v205
v_cvt_pk_bf16_f32 v59, v206, v207
v_cvt_pk_bf16_f32 v60, v208, v209
v_cvt_pk_bf16_f32 v61, v210, v211
v_cvt_pk_bf16_f32 v62, v212, v213
v_cvt_pk_bf16_f32 v63, v214, v215
s_mov_b32 exec_lo, 0
v_mov_b32 v62, 0
v_mov_b32 v63, 0
s_mov_b32 exec_lo, -1
s_add_u32 s46, s36, s38
s_cmp_lt_u32 s46, 2
s_cselect_b32 s49, 2, s38
s_cmp_ge_u32 s49, 2
s_cbranch_scc1 L_nw0_39
s_lshl_b32 s46, s46, 2
s_lshl_b32 s48, s37, 6
s_add_u32 s46, s46, s48
s_sub_u32 s46, s46, 8
s_lshl_b32 s48, s46, 7
s_add_u32 s48, s48, 65536
s_lshl_b32 s46, s46, 12
s_add_u32 s46, s46, 13893632
s_lshl_b32 s47, s38, 14
s_add_u32 s47, s47, 107520
v_lshlrev_b32 v2, 7, v0
s_mov_b64 exec, 15
buffer_load_dwordx2 v[4:5], v2, s[28:31], s48 offen sc1
s_mov_b64 exec, -1
L_nw0_39:
s_lshl_b32 s52, s38, 12
s_add_u32 s52, s52, 128000
s_add_u32 s53, s38, 1
v_add_u32 v236, s52, v1
ds_read_b128 v[144:147], v236 offset:12288
ds_read_b128 v[148:151], v236 offset:13312
ds_read_b128 v[152:155], v236 offset:8192
ds_read_b128 v[156:159], v236 offset:9216
ds_read_b128 v[160:163], v236 offset:4096
ds_read_b128 v[164:167], v236 offset:5120
ds_read_b128 v[168:171], v236 offset:0
ds_read_b128 v[172:175], v236 offset:1024
v_mov_b32 v233, 0xf149f2ca
v_mov_b32 v232, v233
s_waitcnt lgkmcnt(6)
v_mfma_f32_32x32x16_bf16 v[96:111], v[144:147], v[56:59], 0
v_mfma_f32_32x32x16_bf16 v[96:111], v[148:151], v[60:63], v[96:111]
s_waitcnt lgkmcnt(4)
v_mfma_f32_32x32x16_bf16 v[112:127], v[152:155], v[56:59], 0
v_mfma_f32_32x32x16_bf16 v[112:127], v[156:159], v[60:63], v[112:127]
s_nop 8
v_cndmask_b32 v96, v233, v96, s[64:65]
v_cndmask_b32 v97, v233, v97, s[66:67]
v_cndmask_b32 v98, v233, v98, s[68:69]
v_cndmask_b32 v99, v233, v99, s[70:71]
v_cndmask_b32 v100, v233, v100, s[72:73]
v_cndmask_b32 v101, v233, v101, s[74:75]
v_cndmask_b32 v102, v233, v102, s[76:77]
v_cndmask_b32 v103, v233, v103, s[78:79]
v_cndmask_b32 v104, v233, v104, s[80:81]
v_cndmask_b32 v105, v233, v105, s[82:83]
v_cndmask_b32 v106, v233, v106, s[84:85]
v_cndmask_b32 v107, v233, v107, s[86:87]
v_cndmask_b32 v108, v233, v108, s[88:89]
v_cndmask_b32 v109, v233, v109, s[90:91]
v_cndmask_b32 v110, v233, v110, s[92:93]
v_cndmask_b32 v111, v233, v111, s[94:95]
L_nomask_41:
v_max3_f32 v232, v96, v97, v232
v_max3_f32 v232, v98, v99, v232
v_max3_f32 v232, v100, v101, v232
v_max3_f32 v232, v102, v103, v232
v_max3_f32 v232, v104, v105, v232
v_max3_f32 v232, v106, v107, v232
v_max3_f32 v232, v108, v109, v232
v_max3_f32 v232, v110, v111, v232
s_cmp_eq_u32 s53, 1
s_cbranch_scc1 L_p1x_40
s_waitcnt lgkmcnt(2)
v_mfma_f32_32x32x16_bf16 v[96:111], v[160:163], v[56:59], 0
v_max3_f32 v232, v112, v113, v232
v_max3_f32 v232, v114, v115, v232
v_max3_f32 v232, v116, v117, v232
v_max3_f32 v232, v118, v119, v232
v_mfma_f32_32x32x16_bf16 v[96:111], v[164:167], v[60:63], v[96:111]
v_max3_f32 v232, v120, v121, v232
v_max3_f32 v232, v122, v123, v232
v_max3_f32 v232, v124, v125, v232
v_max3_f32 v232, v126, v127, v232
s_cmp_eq_u32 s53, 2
s_cbranch_scc1 L_p1x_40
s_waitcnt lgkmcnt(0)
v_mfma_f32_32x32x16_bf16 v[112:127], v[168:171], v[56:59], 0
s_nop 3
v_max3_f32 v232, v96, v97, v232
v_max3_f32 v232, v98, v99, v232
v_max3_f32 v232, v100, v101, v232
v_max3_f32 v232, v102, v103, v232
v_mfma_f32_32x32x16_bf16 v[112:127], v[172:175], v[60:63], v[112:127]
v_max3_f32 v232, v104, v105, v232
v_max3_f32 v232, v106, v107, v232
v_max3_f32 v232, v108, v109, v232
v_max3_f32 v232, v110, v111, v232
s_cmp_eq_u32 s53, 3
s_cbranch_scc1 L_p1x_40
s_nop 5
v_max3_f32 v232, v112, v113, v232
v_max3_f32 v232, v114, v115, v232
v_max3_f32 v232, v116, v117, v232
v_max3_f32 v232, v118, v119, v232
v_max3_f32 v232, v120, v121, v232
v_max3_f32 v232, v122, v123, v232
v_max3_f32 v232, v124, v125, v232
v_max3_f32 v232, v126, v127, v232
L_p1x_40:
v_mov_b32 v235, v232
s_nop 1
v_permlane32_swap_b32 v232, v235
v_max_f32 v232, v232, v235
v_pk_mul_f32 v[80:81], v[232:233], -1.0 op_sel_hi:[0,0]
v_pk_mul_f32 v[82:83], v[232:233], -1.0 op_sel_hi:[0,0]
v_pk_mul_f32 v[84:85], v[232:233], -1.0 op_sel_hi:[0,0]
v_pk_mul_f32 v[86:87], v[232:233], -1.0 op_sel_hi:[0,0]
v_pk_mul_f32 v[88:89], v[232:233], -1.0 op_sel_hi:[0,0]
v_pk_mul_f32 v[90:91], v[232:233], -1.0 op_sel_hi:[0,0]
v_pk_mul_f32 v[92:93], v[232:233], -1.0 op_sel_hi:[0,0]
v_pk_mul_f32 v[94:95], v[232:233], -1.0 op_sel_hi:[0,0]
s_cmp_ge_u32 s49, 2
s_cbranch_scc1 L_nw1_42
s_waitcnt vmcnt(0)
s_mov_b64 exec, 15
v_cmp_ne_u64 vcc, s[44:45], v[4:5]
s_cbranch_vccnz L_chk_43
L_chkok_44:
s_mov_b64 exec, -1
s_add_u32 s57, s46, 0
s_add_u32 m0, s47, 0
s_nop 0
buffer_load_dwordx4 v1, s[28:31], s57 offen sc1 lds
s_add_u32 s57, s46, 1024
s_add_u32 m0, s47, 1024
s_nop 0
buffer_load_dwordx4 v1, s[28:31], s57 offen sc1 lds
s_add_u32 s57, s46, 2048
s_add_u32 m0, s47, 2048
s_nop 0
buffer_load_dwordx4 v1, s[28:31], s57 offen sc1 lds
s_add_u32 s57, s46, 3072
s_add_u32 m0, s47, 3072
s_nop 0
buffer_load_dwordx4 v1, s[28:31], s57 offen sc1 lds
s_add_u32 s57, s46, 4096
s_add_u32 m0, s47, 4096
s_nop 0
buffer_load_dwordx4 v1, s[28:31], s57 offen sc1 lds
s_add_u32 s57, s46, 5120
s_add_u32 m0, s47, 5120
s_nop 0
buffer_load_dwordx4 v1, s[28:31], s57 offen sc1 lds
s_add_u32 s57, s46, 6144
s_add_u32 m0, s47, 6144
s_nop 0
buffer_load_dwordx4 v1, s[28:31], s57 offen sc1 lds
s_add_u32 s57, s46, 7168
s_add_u32 m0, s47, 7168
s_nop 0
buffer_load_dwordx4 v1, s[28:31], s57 offen sc1 lds
s_add_u32 s57, s46, 8192
s_add_u32 m0, s47, 8192
s_nop 0
buffer_load_dwordx4 v1, s[28:31], s57 offen sc1 lds
s_add_u32 s57, s46, 9216
s_add_u32 m0, s47, 9216
s_nop 0
buffer_load_dwordx4 v1, s[28:31], s57 offen sc1 lds
s_add_u32 s57, s46, 10240
s_add_u32 m0, s47, 10240
s_nop 0
buffer_load_dwordx4 v1, s[28:31], s57 offen sc1 lds
s_add_u32 s57, s46, 11264
s_add_u32 m0, s47, 11264
s_nop 0
buffer_load_dwordx4 v1, s[28:31], s57 offen sc1 lds
s_add_u32 s57, s46, 12288
s_add_u32 m0, s47, 12288
s_nop 0
buffer_load_dwordx4 v1, s[28:31], s57 offen sc1 lds
s_add_u32 s57, s46, 13312
s_add_u32 m0, s47, 13312
s_nop 0
buffer_load_dwordx4 v1, s[28:31], s57 offen sc1 lds
s_add_u32 s57, s46, 14336
s_add_u32 m0, s47, 14336
s_nop 0
buffer_load_dwordx4 v1, s[28:31], s57 offen sc1 lds
s_add_u32 s57, s46, 15360
s_add_u32 m0, s47, 15360
s_nop 0
buffer_load_dwordx4 v1, s[28:31], s57 offen sc1 lds
L_nw1_42:
s_add_u32 s57, s3, 32768
s_add_u32 m0, s43, 90112
s_nop 0
buffer_load_dwordx4 v1, s[28:31], s57 offen lds
s_add_u32 s57, s3, 36864
s_add_u32 m0, s43, 94208
s_nop 0
buffer_load_dwordx4 v1, s[28:31], s57 offen lds
s_add_u32 s57, s3, 40960
s_add_u32 m0, s43, 98304
s_nop 0
buffer_load_dwordx4 v1, s[28:31], s57 offen lds
s_add_u32 s57, s3, 45056
s_add_u32 m0, s43, 102400
s_nop 0
buffer_load_dwordx4 v1, s[28:31], s57 offen lds
s_sub_u32 s3, s3, s43
s_mov_b32 s43, 0
s_add_u32 s57, s3, 49152
s_add_u32 m0, s43, 106496
s_nop 0
buffer_load_dwordx4 v1, s[28:31], s57 offen lds
s_waitcnt lgkmcnt(0)
v_mfma_f32_32x32x16_bf16 v[96:111], v[144:147], v[56:59], v[80:95]
v_mfma_f32_32x32x16_bf16 v[96:111], v[148:151], v[60:63], v[96:111]
v_mfma_f32_32x32x16_bf16 v[112:127], v[152:155], v[56:59], v[80:95]
v_mfma_f32_32x32x16_bf16 v[112:127], v[156:159], v[60:63], v[112:127]
ds_read_b128 v[208:211], v236 offset:14336
ds_read_b128 v[212:215], v236 offset:15360
ds_read_b128 v[216:219], v236 offset:10240
ds_read_b128 v[220:223], v236 offset:11264
s_nop 5
v_cndmask_b32 v96, v233, v96, s[64:65]
v_cndmask_b32 v97, v233, v97, s[66:67]
v_cndmask_b32 v98, v233, v98, s[68:69]
v_cndmask_b32 v99, v233, v99, s[70:71]
v_cndmask_b32 v100, v233, v100, s[72:73]
v_cndmask_b32 v101, v233, v101, s[74:75]
v_cndmask_b32 v102, v233, v102, s[76:77]
v_cndmask_b32 v103, v233, v103, s[78:79]
v_cndmask_b32 v104, v233, v104, s[80:81]
v_cndmask_b32 v105, v233, v105, s[82:83]
v_cndmask_b32 v106, v233, v106, s[84:85]
v_cndmask_b32 v107, v233, v107, s[86:87]
v_cndmask_b32 v108, v233, v108, s[88:89]
v_cndmask_b32 v109, v233, v109, s[90:91]
v_cndmask_b32 v110, v233, v110, s[92:93]
v_cndmask_b32 v111, v233, v111, s[94:95]
L_nomask_46:
v_exp_f32 v96, v96
v_exp_f32 v97, v97
v_exp_f32 v98, v98
v_exp_f32 v99, v99
v_exp_f32 v100, v100
v_exp_f32 v101, v101
v_exp_f32 v102, v102
v_exp_f32 v103, v103
v_cvt_pk_bf16_f32 v128, v96, v97
v_cvt_pk_bf16_f32 v129, v98, v99
v_exp_f32 v104, v104
v_exp_f32 v105, v105
v_exp_f32 v106, v106
v_exp_f32 v107, v107
v_cvt_pk_bf16_f32 v130, v100, v101
v_cvt_pk_bf16_f32 v131, v102, v103
v_exp_f32 v108, v108
v_exp_f32 v109, v109
v_exp_f32 v110, v110
v_exp_f32 v111, v111
v_cvt_pk_bf16_f32 v132, v104, v105
v_cvt_pk_bf16_f32 v133, v106, v107
v_cvt_pk_bf16_f32 v134, v108, v109
v_cvt_pk_bf16_f32 v135, v110, v111
s_cmp_eq_u32 s53, 1
s_cbranch_scc1 L_p2s_47
v_mfma_f32_32x32x16_bf16 v[96:111], v[160:163], v[56:59], v[80:95]
v_exp_f32 v112, v112
v_exp_f32 v113, v113
v_exp_f32 v114, v114
v_exp_f32 v115, v115
v_mfma_f32_32x32x16_bf16 v[96:111], v[164:167], v[60:63], v[96:111]
v_exp_f32 v116, v116
v_exp_f32 v117, v117
v_exp_f32 v118, v118
v_exp_f32 v119, v119
v_cvt_pk_bf16_f32 v136, v112, v113
v_cvt_pk_bf16_f32 v137, v114, v115
s_waitcnt lgkmcnt(2)
v_mfma_f32_32x32x16_bf16 v[64:79], v[208:211], v[128:131], 0
v_exp_f32 v120, v120
v_exp_f32 v121, v121
v_exp_f32 v122, v122
v_exp_f32 v123, v123
v_cvt_pk_bf16_f32 v138, v116, v117
v_cvt_pk_bf16_f32 v139, v118, v119
v_mfma_f32_32x32x16_bf16 v[64:79], v[212:215], v[132:135], v[64:79]
ds_read_b128 v[224:227], v236 offset:6144
ds_read_b128 v[228:231], v236 offset:7168
v_exp_f32 v124, v124
v_exp_f32 v125, v125
v_exp_f32 v126, v126
v_exp_f32 v127, v127
v_cvt_pk_bf16_f32 v140, v120, v121
v_cvt_pk_bf16_f32 v141, v122, v123
v_cvt_pk_bf16_f32 v142, v124, v125
v_cvt_pk_bf16_f32 v143, v126, v127
s_cmp_eq_u32 s53, 2
s_cbranch_scc1 L_p2s_48
v_mfma_f32_32x32x16_bf16 v[112:127], v[168:171], v[56:59], v[80:95]
v_exp_f32 v96, v96
v_exp_f32 v97, v97
v_exp_f32 v98, v98
v_exp_f32 v99, v99
v_mfma_f32_32x32x16_bf16 v[112:127], v[172:175], v[60:63], v[112:127]
v_exp_f32 v100, v100
v_exp_f32 v101, v101
v_exp_f32 v102, v102
v_exp_f32 v103, v103
v_cvt_pk_bf16_f32 v128, v96, v97
v_cvt_pk_bf16_f32 v129, v98, v99
s_waitcnt lgkmcnt(2)
v_mfma_f32_32x32x16_bf16 v[64:79], v[216:219], v[136:139], v[64:79]
v_exp_f32 v104, v104
v_exp_f32 v105, v105
v_exp_f32 v106, v106
v_exp_f32 v107, v107
v_cvt_pk_bf16_f32 v130, v100, v101
v_cvt_pk_bf16_f32 v131, v102, v103
v_mfma_f32_32x32x16_bf16 v[64:79], v[220:223], v[140:143], v[64:79]
ds_read_b128 v[208:211], v236 offset:2048
ds_read_b128 v[212:215], v236 offset:3072
v_exp_f32 v108, v108
v_exp_f32 v109, v109
v_exp_f32 v110, v110
v_exp_f32 v111, v111
v_cvt_pk_bf16_f32 v132, v104, v105
v_cvt_pk_bf16_f32 v133, v106, v107
v_cvt_pk_bf16_f32 v134, v108, v109
v_cvt_pk_bf16_f32 v135, v110, v111
s_cmp_eq_u32 s53, 3
s_cbranch_scc1 L_p2s_49
s_waitcnt lgkmcnt(2)
v_mfma_f32_32x32x16_bf16 v[64:79], v[224:227], v[128:131], v[64:79]
v_exp_f32 v112, v112
v_exp_f32 v113, v113
v_exp_f32 v114, v114
v_exp_f32 v115, v115
v_exp_f32 v116, v116
v_exp_f32 v117, v117
v_exp_f32 v118, v118
v_exp_f32 v119, v119
v_cvt_pk_bf16_f32 v136, v112, v113
v_cvt_pk_bf16_f32 v137, v114, v115
v_mfma_f32_32x32x16_bf16 v[64:79], v[228:231], v[132:135], v[64:79]
v_exp_f32 v120, v120
v_exp_f32 v121, v121
v_exp_f32 v122, v122
v_exp_f32 v123, v123
v_cvt_pk_bf16_f32 v138, v116, v117
v_cvt_pk_bf16_f32 v139, v118, v119
v_exp_f32 v124, v124
v_exp_f32 v125, v125
v_exp_f32 v126, v126
v_exp_f32 v127, v127
v_cvt_pk_bf16_f32 v140, v120, v121
v_cvt_pk_bf16_f32 v141, v122, v123
v_cvt_pk_bf16_f32 v142, v124, v125
v_cvt_pk_bf16_f32 v143, v126, v127
s_waitcnt lgkmcnt(0)
v_mfma_f32_32x32x16_bf16 v[64:79], v[208:211], v[136:139], v[64:79]
v_mfma_f32_32x32x16_bf16 v[64:79], v[212:215], v[140:143], v[64:79]
s_branch L_p2x_45
L_p2s_47:
s_waitcnt lgkmcnt(0)
v_mfma_f32_32x32x16_bf16 v[64:79], v[208:211], v[128:131], 0
v_mfma_f32_32x32x16_bf16 v[64:79], v[212:215], v[132:135], v[64:79]
s_branch L_p2x_45
L_p2s_48:
s_waitcnt lgkmcnt(0)
v_mfma_f32_32x32x16_bf16 v[64:79], v[216:219], v[136:139], v[64:79]
v_mfma_f32_32x32x16_bf16 v[64:79], v[220:223], v[140:143], v[64:79]
s_branch L_p2x_45
L_p2s_49:
s_waitcnt lgkmcnt(0)
v_mfma_f32_32x32x16_bf16 v[64:79], v[224:227], v[128:131], v[64:79]
v_mfma_f32_32x32x16_bf16 v[64:79], v[228:231], v[132:135], v[64:79]
L_p2x_45:
v_and_b32 v6, 31, v0
v_mul_u32_u24 v6, 896, v6
v_lshrrev_b32 v9, 5, v0
v_lshl_add_u32 v9, v9, 4, v6
s_mul_i32 s52, s98, 28672
s_mul_i32 s53, s41, 112
s_add_u32 s52, s52, s53
s_lshl_b32 s53, s99, 6
s_add_u32 s52, s52, s53
buffer_load_dwordx4 v[24:27], v9, s[4:7], s52 offen offset:0
buffer_load_dwordx4 v[28:31], v9, s[4:7], s52 offen offset:32
s_mul_i32 s46, s37, 7
v_lshrrev_b32 v4, 5, v0
v_add_u32 v4, s46, v4
v_and_b32 v5, 1, v4
v_lshrrev_b32 v4, 1, v4
v_lshlrev_b32 v4, 9, v4
v_lshl_add_u32 v4, v5, 3, v4
v_and_b32 v5, 31, v0
v_lshl_add_u32 v7, v5, 4, v4
s_mul_i32 s46, s42, 28672
s_add_u32 s46, s46, 1048576
s_lshl_b32 s47, s42, 7
s_lshl_b32 s49, s37, 3
s_add_u32 s47, s47, s49
s_add_u32 s47, s47, 8192
s_cmp_ge_u32 s36, 2
s_cselect_b32 s54, 1, 0
s_cselect_b32 s52, s38, 4
s_sub_u32 s53, 8, s52
s_lshl_b32 s52, s52, 12
s_add_u32 s52, s52, 107520
v_add_u32 v236, s52, v1
s_mov_b32 s55, 0
s_lshl_b32 s50, s36, 11
s_add_u32 s50, s50, 983040
v_lshlrev_b32 v12, 7, v0
s_cmp_ge_u32 s38, 2
s_cbranch_scc1 L_hdone_38
s_waitcnt vmcnt(7)
L_hdone_38:
s_barrier
s_cmp_eq_u32 s36, 0
s_cbranch_scc1 L_nosegb_50
ds_read_b128 v[144:147], v236 offset:0
ds_read_b128 v[148:151], v236 offset:1024
ds_read_b128 v[152:155], v236 offset:4096
ds_read_b128 v[156:159], v236 offset:5120
s_waitcnt lgkmcnt(2)
v_mfma_f32_32x32x16_bf16 v[96:111], v[144:147], v[56:59], v[80:95]
v_mfma_f32_32x32x16_bf16 v[96:111], v[148:151], v[60:63], v[96:111]
ds_read_b128 v[160:163], v236 offset:8192
ds_read_b128 v[164:167], v236 offset:9216
ds_read_b128 v[168:171], v236 offset:12288
ds_read_b128 v[172:175], v236 offset:13312
ds_read_b128 v[176:179], v236 offset:16384
ds_read_b128 v[180:183], v236 offset:17408
ds_read_b128 v[184:187], v236 offset:20480
ds_read_b128 v[188:191], v236 offset:21504
ds_read_b128 v[192:195], v236 offset:24576
ds_read_b128 v[196:199], v236 offset:25600
ds_read_b128 v[200:203], v236 offset:28672
ds_read_b128 v[204:207], v236 offset:29696
s_waitcnt lgkmcnt(12)
v_mfma_f32_32x32x16_bf16 v[112:127], v[152:155], v[56:59], v[80:95]
v_mfma_f32_32x32x16_bf16 v[112:127], v[156:159], v[60:63], v[112:127]
ds_read_b128 v[208:211], v236 offset:2048
ds_read_b128 v[212:215], v236 offset:3072
ds_read_b128 v[216:219], v236 offset:6144
ds_read_b128 v[220:223], v236 offset:7168
s_cmp_eq_u32 s54, 0
s_cbranch_scc1 L_nomask_55
v_cndmask_b32 v96, v96, v233, s[64:65]
v_cndmask_b32 v97, v97, v233, s[66:67]
v_cndmask_b32 v98, v98, v233, s[68:69]
v_cndmask_b32 v99, v99, v233, s[70:71]
v_cndmask_b32 v100, v100, v233, s[72:73]
v_cndmask_b32 v101, v101, v233, s[74:75]
v_cndmask_b32 v102, v102, v233, s[76:77]
v_cndmask_b32 v103, v103, v233, s[78:79]
v_cndmask_b32 v104, v104, v233, s[80:81]
v_cndmask_b32 v105, v105, v233, s[82:83]
v_cndmask_b32 v106, v106, v233, s[84:85]
v_cndmask_b32 v107, v107, v233, s[86:87]
v_cndmask_b32 v108, v108, v233, s[88:89]
v_cndmask_b32 v109, v109, v233, s[90:91]
v_cndmask_b32 v110, v110, v233, s[92:93]
v_cndmask_b32 v111, v111, v233, s[94:95]
L_nomask_55:
v_exp_f32 v96, v96
v_exp_f32 v97, v97
v_exp_f32 v98, v98
v_exp_f32 v99, v99
s_mul_i32 s56, s42, 28672
s_mul_i32 s57, s37, 1792
s_add_u32 s56, s56, s57
s_add_u32 s56, s56, 2883584
v_mul_u32_u24 v14, 128, v0
s_mov_b32 exec_lo, 0x3fff
s_mov_b32 exec_hi, 0x0
buffer_load_dword v14, v14, s[28:31], s56 offen
s_mov_b64 exec, -1
s_mul_i32 s56, s42, 4096
s_mul_i32 s57, s37, 256
s_add_u32 s56, s56, s57
s_add_u32 s56, s56, 327680
v_mul_u32_u24 v14, 128, v0
s_mov_b32 exec_lo, 0x3
s_mov_b32 exec_hi, 0x0
buffer_load_dword v14, v14, s[28:31], s56 offen
s_mov_b64 exec, -1
v_exp_f32 v100, v100
v_exp_f32 v101, v101
v_exp_f32 v102, v102
v_exp_f32 v103, v103
v_cvt_pk_bf16_f32 v128, v96, v97
v_cvt_pk_bf16_f32 v129, v98, v99
s_mov_b64 exec, 0xffff
buffer_load_dwordx4 v[8:11], v12, s[28:31], s50 offen sc1
s_mov_b64 exec, -1
s_mul_i32 s100, s41, 57344
s_mul_i32 s48, s38, 14336
s_add_u32 s100, s100, s48
s_add_u32 s100, s100, 24117248
s_lshl_b32 s48, s99, 10
s_add_u32 s101, s100, 1024
s_add_u32 s100, s100, s48
s_sub_u32 s101, s101, s48
s_add_u32 s57, s100, 0
s_bitcmp1_b32 s57, 10
s_cselect_b32 exec_lo, s61, -1
s_mov_b32 exec_hi, exec_lo
buffer_load_dwordx4 a[224:227], v1, s[28:31], s57 offen
s_mov_b64 exec, -1
v_exp_f32 v104, v104
v_exp_f32 v105, v105
v_exp_f32 v106, v106
v_exp_f32 v107, v107
v_cvt_pk_bf16_f32 v130, v100, v101
v_cvt_pk_bf16_f32 v131, v102, v103
s_add_u32 s57, s101, 0
s_bitcmp1_b32 s57, 10
s_cselect_b32 exec_lo, s61, -1
s_mov_b32 exec_hi, exec_lo
buffer_load_dwordx4 a[228:231], v1, s[28:31], s57 offen
s_mov_b64 exec, -1
s_add_u32 s57, s100, 2048
s_bitcmp1_b32 s57, 10
s_cselect_b32 exec_lo, s61, -1
s_mov_b32 exec_hi, exec_lo
buffer_load_dwordx4 a[232:235], v1, s[28:31], s57 offen
s_mov_b64 exec, -1
v_exp_f32 v108, v108
v_exp_f32 v109, v109
v_exp_f32 v110, v110
v_exp_f32 v111, v111
v_cvt_pk_bf16_f32 v132, v104, v105
v_cvt_pk_bf16_f32 v133, v106, v107
v_cvt_pk_bf16_f32 v134, v108, v109
v_cvt_pk_bf16_f32 v135, v110, v111
s_add_u32 s57, s101, 2048
s_bitcmp1_b32 s57, 10
s_cselect_b32 exec_lo, s61, -1
s_mov_b32 exec_hi, exec_lo
buffer_load_dwordx4 a[236:239], v1, s[28:31], s57 offen
s_mov_b64 exec, -1
s_add_u32 s57, s100, 4096
s_bitcmp1_b32 s57, 10
s_cselect_b32 exec_lo, s61, -1
s_mov_b32 exec_hi, exec_lo
buffer_load_dwordx4 a[240:243], v1, s[28:31], s57 offen
s_mov_b64 exec, -1
s_waitcnt lgkmcnt(4)
v_mfma_f32_32x32x16_bf16 v[96:111], v[160:163], v[56:59], v[80:95]
v_exp_f32 v112, v112
v_exp_f32 v113, v113
v_exp_f32 v114, v114
v_exp_f32 v115, v115
s_add_u32 s57, s101, 4096
s_bitcmp1_b32 s57, 10
s_cselect_b32 exec_lo, s61, -1
s_mov_b32 exec_hi, exec_lo
buffer_load_dwordx4 a[244:247], v1, s[28:31], s57 offen
s_mov_b64 exec, -1
v_mfma_f32_32x32x16_bf16 v[96:111], v[164:167], v[60:63], v[96:111]
v_exp_f32 v116, v116
v_exp_f32 v117, v117
v_exp_f32 v118, v118
v_exp_f32 v119, v119
v_cvt_pk_bf16_f32 v136, v112, v113
v_cvt_pk_bf16_f32 v137, v114, v115
s_add_u32 s57, s100, 6144
s_bitcmp1_b32 s57, 10
s_cselect_b32 exec_lo, s61, -1
s_mov_b32 exec_hi, exec_lo
buffer_load_dwordx4 a[248:251], v1, s[28:31], s57 offen
s_mov_b64 exec, -1
s_waitcnt lgkmcnt(2)
v_mfma_f32_32x32x16_bf16 v[240:255], v[208:211], v[128:131], v[64:79]
v_exp_f32 v120, v120
v_exp_f32 v121, v121
v_exp_f32 v122, v122
v_exp_f32 v123, v123
v_cvt_pk_bf16_f32 v138, v116, v117
v_cvt_pk_bf16_f32 v139, v118, v119
s_add_u32 s57, s101, 6144
s_bitcmp1_b32 s57, 10
s_cselect_b32 exec_lo, s61, -1
s_mov_b32 exec_hi, exec_lo
buffer_load_dwordx4 a[252:255], v1, s[28:31], s57 offen
s_mov_b64 exec, -1
v_mfma_f32_32x32x16_bf16 v[240:255], v[212:215], v[132:135], v[240:255]
ds_read_b128 v[224:227], v236 offset:10240
ds_read_b128 v[228:231], v236 offset:11264
v_exp_f32 v124, v124
v_exp_f32 v125, v125
v_exp_f32 v126, v126
v_exp_f32 v127, v127
v_cvt_pk_bf16_f32 v140, v120, v121
v_cvt_pk_bf16_f32 v141, v122, v123
v_cvt_pk_bf16_f32 v142, v124, v125
v_cvt_pk_bf16_f32 v143, v126, v127
s_add_u32 s57, s100, 8192
s_bitcmp1_b32 s57, 10
s_cselect_b32 exec_lo, s61, -1
s_mov_b32 exec_hi, exec_lo
buffer_load_dwordx4 v[32:35], v1, s[28:31], s57 offen
s_mov_b64 exec, -1
v_mfma_f32_32x32x16_bf16 v[112:127], v[168:171], v[56:59], v[80:95]
v_exp_f32 v96, v96
v_exp_f32 v97, v97
v_exp_f32 v98, v98
v_exp_f32 v99, v99
s_add_u32 s57, s101, 8192
s_bitcmp1_b32 s57, 10
s_cselect_b32 exec_lo, s61, -1
s_mov_b32 exec_hi, exec_lo
buffer_load_dwordx4 v[36:39], v1, s[28:31], s57 offen
s_mov_b64 exec, -1
v_mfma_f32_32x32x16_bf16 v[112:127], v[172:175], v[60:63], v[112:127]
v_exp_f32 v100, v100
v_exp_f32 v101, v101
v_exp_f32 v102, v102
v_exp_f32 v103, v103
v_cvt_pk_bf16_f32 v128, v96, v97
v_cvt_pk_bf16_f32 v129, v98, v99
s_add_u32 s57, s100, 10240
s_bitcmp1_b32 s57, 10
s_cselect_b32 exec_lo, s61, -1
s_mov_b32 exec_hi, exec_lo
buffer_load_dwordx4 v[40:43], v1, s[28:31], s57 offen
s_mov_b64 exec, -1
s_waitcnt lgkmcnt(2)
v_mfma_f32_32x32x16_bf16 v[240:255], v[216:219], v[136:139], v[240:255]
v_exp_f32 v104, v104
v_exp_f32 v105, v105
v_exp_f32 v106, v106
v_exp_f32 v107, v107
v_cvt_pk_bf16_f32 v130, v100, v101
v_cvt_pk_bf16_f32 v131, v102, v103
s_add_u32 s57, s101, 10240
s_bitcmp1_b32 s57, 10
s_cselect_b32 exec_lo, s61, -1
s_mov_b32 exec_hi, exec_lo
buffer_load_dwordx4 v[44:47], v1, s[28:31], s57 offen
s_mov_b64 exec, -1
v_mfma_f32_32x32x16_bf16 v[240:255], v[220:223], v[140:143], v[240:255]
ds_read_b128 v[208:211], v236 offset:14336
ds_read_b128 v[212:215], v236 offset:15360
v_exp_f32 v108, v108
v_exp_f32 v109, v109
v_exp_f32 v110, v110
v_exp_f32 v111, v111
v_cvt_pk_bf16_f32 v132, v104, v105
v_cvt_pk_bf16_f32 v133, v106, v107
v_cvt_pk_bf16_f32 v134, v108, v109
v_cvt_pk_bf16_f32 v135, v110, v111
s_add_u32 s57, s100, 12288
s_bitcmp1_b32 s57, 10
s_cselect_b32 exec_lo, s61, -1
s_mov_b32 exec_hi, exec_lo
buffer_load_dwordx4 v[48:51], v1, s[28:31], s57 offen
s_mov_b64 exec, -1
v_mfma_f32_32x32x16_bf16 v[96:111], v[176:179], v[56:59], v[80:95]
v_exp_f32 v112, v112
v_exp_f32 v113, v113
v_exp_f32 v114, v114
v_exp_f32 v115, v115
s_add_u32 s57, s101, 12288
s_bitcmp1_b32 s57, 10
s_cselect_b32 exec_lo, s61, -1
s_mov_b32 exec_hi, exec_lo
buffer_load_dwordx4 v[52:55], v1, s[28:31], s57 offen
s_mov_b64 exec, -1
v_mfma_f32_32x32x16_bf16 v[96:111], v[180:183], v[60:63], v[96:111]
v_exp_f32 v116, v116
v_exp_f32 v117, v117
v_exp_f32 v118, v118
v_exp_f32 v119, v119
v_cvt_pk_bf16_f32 v136, v112, v113
v_cvt_pk_bf16_f32 v137, v114, v115
s_mul_i32 s100, s41, 229376
s_mul_i32 s48, s38, 57344
s_add_u32 s100, s100, s48
s_add_u32 s100, s100, 22282240
s_lshl_b32 s48, s99, 10
s_add_u32 s101, s100, 1024
s_add_u32 s100, s100, s48
s_sub_u32 s101, s101, s48
s_add_u32 s57, s100, 0
s_bitcmp1_b32 s57, 10
s_cselect_b32 exec_lo, s61, -1
s_mov_b32 exec_hi, exec_lo
buffer_load_dwordx4 a[0:3], v1, s[28:31], s57 offen
s_mov_b64 exec, -1
s_waitcnt lgkmcnt(2)
v_mfma_f32_32x32x16_bf16 v[240:255], v[224:227], v[128:131], v[240:255]
v_exp_f32 v120, v120
v_exp_f32 v121, v121
v_exp_f32 v122, v122
v_exp_f32 v123, v123
v_cvt_pk_bf16_f32 v138, v116, v117
v_cvt_pk_bf16_f32 v139, v118, v119
s_add_u32 s57, s101, 0
s_bitcmp1_b32 s57, 10
s_cselect_b32 exec_lo, s61, -1
s_mov_b32 exec_hi, exec_lo
buffer_load_dwordx4 a[4:7], v1, s[28:31], s57 offen
s_mov_b64 exec, -1
v_mfma_f32_32x32x16_bf16 v[240:255], v[228:231], v[132:135], v[240:255]
ds_read_b128 v[216:219], v236 offset:18432
ds_read_b128 v[220:223], v236 offset:19456
v_exp_f32 v124, v124
v_exp_f32 v125, v125
v_exp_f32 v126, v126
v_exp_f32 v127, v127
v_cvt_pk_bf16_f32 v140, v120, v121
v_cvt_pk_bf16_f32 v141, v122, v123
v_cvt_pk_bf16_f32 v142, v124, v125
v_cvt_pk_bf16_f32 v143, v126, v127
s_add_u32 s57, s100, 2048
s_bitcmp1_b32 s57, 10
s_cselect_b32 exec_lo, s61, -1
s_mov_b32 exec_hi, exec_lo
buffer_load_dwordx4 a[8:11], v1, s[28:31], s57 offen
s_mov_b64 exec, -1
s_add_u32 s57, s101, 2048
s_bitcmp1_b32 s57, 10
s_cselect_b32 exec_lo, s61, -1
s_mov_b32 exec_hi, exec_lo
buffer_load_dwordx4 a[12:15], v1, s[28:31], s57 offen
s_mov_b64 exec, -1
s_add_u32 s57, s100, 4096
s_bitcmp1_b32 s57, 10
s_cselect_b32 exec_lo, s61, -1
s_mov_b32 exec_hi, exec_lo
buffer_load_dwordx4 a[16:19], v1, s[28:31], s57 offen
s_mov_b64 exec, -1
s_add_u32 s57, s101, 4096
s_bitcmp1_b32 s57, 10
s_cselect_b32 exec_lo, s61, -1
s_mov_b32 exec_hi, exec_lo
buffer_load_dwordx4 a[20:23], v1, s[28:31], s57 offen
s_mov_b64 exec, -1
s_add_u32 s57, s100, 6144
s_bitcmp1_b32 s57, 10
s_cselect_b32 exec_lo, s61, -1
s_mov_b32 exec_hi, exec_lo
buffer_load_dwordx4 a[24:27], v1, s[28:31], s57 offen
s_mov_b64 exec, -1
s_add_u32 s57, s101, 6144
s_bitcmp1_b32 s57, 10
s_cselect_b32 exec_lo, s61, -1
s_mov_b32 exec_hi, exec_lo
buffer_load_dwordx4 a[28:31], v1, s[28:31], s57 offen
s_mov_b64 exec, -1
s_add_u32 s57, s100, 14336
s_bitcmp1_b32 s57, 10
s_cselect_b32 exec_lo, s61, -1
s_mov_b32 exec_hi, exec_lo
buffer_load_dwordx4 a[56:59], v1, s[28:31], s57 offen
s_mov_b64 exec, -1
s_add_u32 s57, s101, 14336
s_bitcmp1_b32 s57, 10
s_cselect_b32 exec_lo, s61, -1
s_mov_b32 exec_hi, exec_lo
buffer_load_dwordx4 a[60:63], v1, s[28:31], s57 offen
s_mov_b64 exec, -1
s_add_u32 s57, s100, 16384
s_bitcmp1_b32 s57, 10
s_cselect_b32 exec_lo, s61, -1
s_mov_b32 exec_hi, exec_lo
buffer_load_dwordx4 a[64:67], v1, s[28:31], s57 offen
s_mov_b64 exec, -1
s_add_u32 s57, s101, 16384
s_bitcmp1_b32 s57, 10
s_cselect_b32 exec_lo, s61, -1
s_mov_b32 exec_hi, exec_lo
buffer_load_dwordx4 a[68:71], v1, s[28:31], s57 offen
s_mov_b64 exec, -1
s_add_u32 s57, s100, 18432
s_bitcmp1_b32 s57, 10
s_cselect_b32 exec_lo, s61, -1
s_mov_b32 exec_hi, exec_lo
buffer_load_dwordx4 a[72:75], v1, s[28:31], s57 offen
s_mov_b64 exec, -1
s_add_u32 s57, s101, 18432
s_bitcmp1_b32 s57, 10
s_cselect_b32 exec_lo, s61, -1
s_mov_b32 exec_hi, exec_lo
buffer_load_dwordx4 a[76:79], v1, s[28:31], s57 offen
s_mov_b64 exec, -1
s_add_u32 s57, s100, 20480
s_bitcmp1_b32 s57, 10
s_cselect_b32 exec_lo, s61, -1
s_mov_b32 exec_hi, exec_lo
buffer_load_dwordx4 a[80:83], v1, s[28:31], s57 offen
s_mov_b64 exec, -1
s_add_u32 s57, s101, 20480
s_bitcmp1_b32 s57, 10
s_cselect_b32 exec_lo, s61, -1
s_mov_b32 exec_hi, exec_lo
buffer_load_dwordx4 a[84:87], v1, s[28:31], s57 offen
s_mov_b64 exec, -1
s_add_u32 s57, s100, 28672
s_bitcmp1_b32 s57, 10
s_cselect_b32 exec_lo, s61, -1
s_mov_b32 exec_hi, exec_lo
buffer_load_dwordx4 a[112:115], v1, s[28:31], s57 offen
s_mov_b64 exec, -1
s_add_u32 s57, s101, 28672
s_bitcmp1_b32 s57, 10
s_cselect_b32 exec_lo, s61, -1
s_mov_b32 exec_hi, exec_lo
buffer_load_dwordx4 a[116:119], v1, s[28:31], s57 offen
s_mov_b64 exec, -1
s_add_u32 s57, s100, 30720
s_bitcmp1_b32 s57, 10
s_cselect_b32 exec_lo, s61, -1
s_mov_b32 exec_hi, exec_lo
buffer_load_dwordx4 a[120:123], v1, s[28:31], s57 offen
s_mov_b64 exec, -1
s_add_u32 s57, s101, 30720
s_bitcmp1_b32 s57, 10
s_cselect_b32 exec_lo, s61, -1
s_mov_b32 exec_hi, exec_lo
buffer_load_dwordx4 a[124:127], v1, s[28:31], s57 offen
s_mov_b64 exec, -1
s_cmp_eq_u32 s53, 4
s_cbranch_scc1 L_p2s_56
v_mfma_f32_32x32x16_bf16 v[112:127], v[184:187], v[56:59], v[80:95]
v_exp_f32 v96, v96
v_exp_f32 v97, v97
v_exp_f32 v98, v98
v_exp_f32 v99, v99
v_mfma_f32_32x32x16_bf16 v[112:127], v[188:191], v[60:63], v[112:127]
v_exp_f32 v100, v100
v_exp_f32 v101, v101
v_exp_f32 v102, v102
v_exp_f32 v103, v103
v_cvt_pk_bf16_f32 v128, v96, v97
v_cvt_pk_bf16_f32 v129, v98, v99
s_waitcnt lgkmcnt(2)
v_mfma_f32_32x32x16_bf16 v[240:255], v[208:211], v[136:139], v[240:255]
v_exp_f32 v104, v104
v_exp_f32 v105, v105
v_exp_f32 v106, v106
v_exp_f32 v107, v107
v_cvt_pk_bf16_f32 v130, v100, v101
v_cvt_pk_bf16_f32 v131, v102, v103
v_mfma_f32_32x32x16_bf16 v[240:255], v[212:215], v[140:143], v[240:255]
ds_read_b128 v[224:227], v236 offset:22528
ds_read_b128 v[228:231], v236 offset:23552
v_exp_f32 v108, v108
v_exp_f32 v109, v109
v_exp_f32 v110, v110
v_exp_f32 v111, v111
v_cvt_pk_bf16_f32 v132, v104, v105
v_cvt_pk_bf16_f32 v133, v106, v107
v_cvt_pk_bf16_f32 v134, v108, v109
v_cvt_pk_bf16_f32 v135, v110, v111
s_cmp_eq_u32 s53, 5
s_cbranch_scc1 L_p2s_57
v_mfma_f32_32x32x16_bf16 v[96:111], v[192:195], v[56:59], v[80:95]
v_exp_f32 v112, v112
v_exp_f32 v113, v113
v_exp_f32 v114, v114
v_exp_f32 v115, v115
v_mfma_f32_32x32x16_bf16 v[96:111], v[196:199], v[60:63], v[96:111]
v_exp_f32 v116, v116
v_exp_f32 v117, v117
v_exp_f32 v118, v118
v_exp_f32 v119, v119
v_cvt_pk_bf16_f32 v136, v112, v113
v_cvt_pk_bf16_f32 v137, v114, v115
s_waitcnt lgkmcnt(2)
v_mfma_f32_32x32x16_bf16 v[240:255], v[216:219], v[128:131], v[240:255]
v_exp_f32 v120, v120
v_exp_f32 v121, v121
v_exp_f32 v122, v122
v_exp_f32 v123, v123
v_cvt_pk_bf16_f32 v138, v116, v117
v_cvt_pk_bf16_f32 v139, v118, v119
v_mfma_f32_32x32x16_bf16 v[240:255], v[220:223], v[132:135], v[240:255]
ds_read_b128 v[208:211], v236 offset:26624
ds_read_b128 v[212:215], v236 offset:27648
v_exp_f32 v124, v124
v_exp_f32 v125, v125
v_exp_f32 v126, v126
v_exp_f32 v127, v127
v_cvt_pk_bf16_f32 v140, v120, v121
v_cvt_pk_bf16_f32 v141, v122, v123
v_cvt_pk_bf16_f32 v142, v124, v125
v_cvt_pk_bf16_f32 v143, v126, v127
s_cmp_eq_u32 s53, 6
s_cbranch_scc1 L_p2s_58
v_mfma_f32_32x32x16_bf16 v[112:127], v[200:203], v[56:59], v[80:95]
v_exp_f32 v96, v96
v_exp_f32 v97, v97
v_exp_f32 v98, v98
v_exp_f32 v99, v99
v_mfma_f32_32x32x16_bf16 v[112:127], v[204:207], v[60:63], v[112:127]
v_exp_f32 v100, v100
v_exp_f32 v101, v101
v_exp_f32 v102, v102
v_exp_f32 v103, v103
v_cvt_pk_bf16_f32 v128, v96, v97
v_cvt_pk_bf16_f32 v129, v98, v99
s_waitcnt lgkmcnt(2)
v_mfma_f32_32x32x16_bf16 v[240:255], v[224:227], v[136:139], v[240:255]
v_exp_f32 v104, v104
v_exp_f32 v105, v105
v_exp_f32 v106, v106
v_exp_f32 v107, v107
v_cvt_pk_bf16_f32 v130, v100, v101
v_cvt_pk_bf16_f32 v131, v102, v103
v_mfma_f32_32x32x16_bf16 v[240:255], v[228:231], v[140:143], v[240:255]
ds_read_b128 v[216:219], v236 offset:30720
ds_read_b128 v[220:223], v236 offset:31744
v_exp_f32 v108, v108
v_exp_f32 v109, v109
v_exp_f32 v110, v110
v_exp_f32 v111, v111
v_cvt_pk_bf16_f32 v132, v104, v105
v_cvt_pk_bf16_f32 v133, v106, v107
v_cvt_pk_bf16_f32 v134, v108, v109
v_cvt_pk_bf16_f32 v135, v110, v111
s_cmp_eq_u32 s53, 7
s_cbranch_scc1 L_p2s_59
s_waitcnt lgkmcnt(2)
v_mfma_f32_32x32x16_bf16 v[240:255], v[208:211], v[128:131], v[240:255]
v_exp_f32 v112, v112
v_exp_f32 v113, v113
v_exp_f32 v114, v114
v_exp_f32 v115, v115
v_exp_f32 v116, v116
v_exp_f32 v117, v117
v_exp_f32 v118, v118
v_exp_f32 v119, v119
v_cvt_pk_bf16_f32 v136, v112, v113
v_cvt_pk_bf16_f32 v137, v114, v115
v_mfma_f32_32x32x16_bf16 v[240:255], v[212:215], v[132:135], v[240:255]
v_exp_f32 v120, v120
v_exp_f32 v121, v121
v_exp_f32 v122, v122
v_exp_f32 v123, v123
v_cvt_pk_bf16_f32 v138, v116, v117
v_cvt_pk_bf16_f32 v139, v118, v119
v_exp_f32 v124, v124
v_exp_f32 v125, v125
v_exp_f32 v126, v126
v_exp_f32 v127, v127
v_cvt_pk_bf16_f32 v140, v120, v121
v_cvt_pk_bf16_f32 v141, v122, v123
v_cvt_pk_bf16_f32 v142, v124, v125
v_cvt_pk_bf16_f32 v143, v126, v127
s_waitcnt lgkmcnt(0)
v_mfma_f32_32x32x16_bf16 v[240:255], v[216:219], v[136:139], v[240:255]
v_mfma_f32_32x32x16_bf16 v[240:255], v[220:223], v[140:143], v[240:255]
s_branch L_p2x_54
L_p2s_56:
s_waitcnt lgkmcnt(0)
v_mfma_f32_32x32x16_bf16 v[240:255], v[208:211], v[136:139], v[240:255]
v_mfma_f32_32x32x16_bf16 v[240:255], v[212:215], v[140:143], v[240:255]
s_branch L_p2x_54
L_p2s_57:
s_waitcnt lgkmcnt(0)
v_mfma_f32_32x32x16_bf16 v[240:255], v[216:219], v[128:131], v[240:255]
v_mfma_f32_32x32x16_bf16 v[240:255], v[220:223], v[132:135], v[240:255]
s_branch L_p2x_54
L_p2s_58:
s_waitcnt lgkmcnt(0)
v_mfma_f32_32x32x16_bf16 v[240:255], v[224:227], v[136:139], v[240:255]
v_mfma_f32_32x32x16_bf16 v[240:255], v[228:231], v[140:143], v[240:255]
s_branch L_p2x_54
L_p2s_59:
s_waitcnt lgkmcnt(0)
v_mfma_f32_32x32x16_bf16 v[240:255], v[208:211], v[128:131], v[240:255]
v_mfma_f32_32x32x16_bf16 v[240:255], v[212:215], v[132:135], v[240:255]
L_p2x_54:
v_mov_b32 v2, 0x5d800000
s_nop 10
v_cmp_nle_f32 vcc, v252, v2
s_nop 0
s_and_b64 vcc, vcc, s[62:63]
s_cbranch_scc1 L_redo_53
L_segbdone_51:
s_nop 10
v_rcp_f32 v2, v252
s_nop 0
v_mov_b32 v3, v2
s_nop 1
v_permlane32_swap_b32 v3, v2
s_waitcnt vmcnt(34)
s_mov_b64 exec, 0xffff
v_cmp_ne_u64 vcc, s[44:45], v[8:9]
s_cbranch_vccnz L_chk_60
L_chkok_61:
s_getreg_b32 s49, hwreg(HW_REG_XCC_ID, 0, 4)
v_cmp_ne_u32 vcc, s49, v10
s_mov_b64 exec, -1
s_cmp_eq_u64 vcc, 0
s_cselect_b32 s39, 1, 0
v_pk_mul_f32 v[240:241], v[240:241], v[2:3] op_sel_hi:[1,0]
v_pk_mul_f32 v[242:243], v[242:243], v[2:3] op_sel_hi:[1,0]
v_pk_mul_f32 v[244:245], v[244:245], v[2:3] op_sel_hi:[1,0]
v_pk_mul_f32 v[246:247], v[246:247], v[2:3] op_sel_hi:[1,0]
v_pk_mul_f32 v[248:249], v[248:249], v[2:3] op_sel_hi:[1,0]
v_pk_mul_f32 v[250:251], v[250:251], v[2:3] op_sel_hi:[1,0]
v_pk_mul_f32 v[252:253], v[252:253], v[2:3] op_sel_hi:[1,0]
v_pk_mul_f32 v[254:255], v[254:255], v[2:3] op_sel_hi:[1,0]
v_cvt_pk_bf16_f32 v240, v240, v241
v_cvt_pk_bf16_f32 v241, v242, v243
v_cvt_pk_bf16_f32 v242, v244, v245
v_cvt_pk_bf16_f32 v243, v246, v247
v_cvt_pk_bf16_f32 v244, v248, v249
v_cvt_pk_bf16_f32 v245, v250, v251
v_cvt_pk_bf16_f32 v246, v252, v253
v_cvt_pk_bf16_f32 v247, v254, v255
s_cmp_eq_u32 s39, 0
s_cbranch_scc1 L_slow_62
buffer_store_dwordx2 v[240:241], v7, s[28:31], s46 offen offset:0
buffer_store_dwordx2 v[242:243], v7, s[28:31], s46 offen offset:512
buffer_store_dwordx2 v[244:245], v7, s[28:31], s46 offen offset:1024
s_mov_b32 exec_hi, 0
buffer_store_dwordx2 v[246:247], v7, s[28:31], s46 offen offset:1536
s_mov_b32 exec_hi, -1
L_stored_63:
v_mov_b32 v2, s44
v_mov_b32 v3, s45
v_mov_b32 v4, 0
s_mov_b64 exec, 1
s_cmp_eq_u32 s39, 0
s_cbranch_scc1 L_slow_64
s_waitcnt vmcnt(0)
buffer_store_dwordx2 v[2:3], v4, s[28:31], s47 offen
L_stored_65:
s_mov_b64 exec, -1
v_permlane32_swap_b32 v24, v26
v_permlane32_swap_b32 v25, v27
v_permlane32_swap_b32 v28, v30
v_permlane32_swap_b32 v29, v31
v_lshlrev_b32 v16, 16, v24
v_and_b32 v17, 0xffff0000, v24
v_lshlrev_b32 v18, 16, v25
v_and_b32 v19, 0xffff0000, v25
v_lshlrev_b32 v20, 16, v26
v_and_b32 v21, 0xffff0000, v26
v_lshlrev_b32 v22, 16, v27
v_and_b32 v23, 0xffff0000, v27
v_lshlrev_b32 v24, 16, v28
v_and_b32 v25, 0xffff0000, v28
v_lshlrev_b32 v26, 16, v29
v_and_b32 v27, 0xffff0000, v29
v_lshlrev_b32 v28, 16, v30
v_and_b32 v29, 0xffff0000, v30
v_lshlrev_b32 v30, 16, v31
v_and_b32 v31, 0xffff0000, v31
s_cmp_lg_u32 s38, 3
s_cbranch_scc1 L_nocs1_66
s_lshl_b32 s46, s37, 9
s_add_u32 s46, s46, 26279936
s_mov_b64 exec, 0xfffffff
s_add_u32 s47, s46, 0
buffer_load_dwordx4 v[144:147], v1, s[28:31], s47 offen sc1
s_add_u32 s47, s46, 8192
buffer_load_dwordx4 v[148:151], v1, s[28:31], s47 offen sc1
s_add_u32 s47, s46, 16384
buffer_load_dwordx4 v[152:155], v1, s[28:31], s47 offen sc1
s_add_u32 s47, s46, 24576
buffer_load_dwordx4 v[156:159], v1, s[28:31], s47 offen sc1
s_add_u32 s47, s46, 32768
buffer_load_dwordx4 v[160:163], v1, s[28:31], s47 offen sc1
s_add_u32 s47, s46, 40960
buffer_load_dwordx4 v[164:167], v1, s[28:31], s47 offen sc1
s_add_u32 s47, s46, 49152
buffer_load_dwordx4 v[168:171], v1, s[28:31], s47 offen sc1
s_add_u32 s47, s46, 57344
buffer_load_dwordx4 v[172:175], v1, s[28:31], s47 offen sc1
s_add_u32 s47, s46, 65536
buffer_load_dwordx4 v[176:179], v1, s[28:31], s47 offen sc1
s_add_u32 s47, s46, 73728
buffer_load_dwordx4 v[180:183], v1, s[28:31], s47 offen sc1
s_add_u32 s47, s46, 81920
buffer_load_dwordx4 v[184:187], v1, s[28:31], s47 offen sc1
s_add_u32 s47, s46, 90112
buffer_load_dwordx4 v[188:191], v1, s[28:31], s47 offen sc1
s_add_u32 s47, s46, 98304
buffer_load_dwordx4 v[192:195], v1, s[28:31], s47 offen sc1
s_add_u32 s47, s46, 106496
buffer_load_dwordx4 v[196:199], v1, s[28:31], s47 offen sc1
v_add_u32 v2, 158080, v1
s_waitcnt vmcnt(12)
v_pk_add_f32 v[144:145], v[144:145], v[148:149]
v_pk_add_f32 v[146:147], v[146:147], v[150:151]
s_waitcnt vmcnt(11)
v_pk_add_f32 v[144:145], v[144:145], v[152:153]
v_pk_add_f32 v[146:147], v[146:147], v[154:155]
s_waitcnt vmcnt(10)
v_pk_add_f32 v[144:145], v[144:145], v[156:157]
v_pk_add_f32 v[146:147], v[146:147], v[158:159]
s_waitcnt vmcnt(9)
v_pk_add_f32 v[144:145], v[144:145], v[160:161]
v_pk_add_f32 v[146:147], v[146:147], v[162:163]
s_waitcnt vmcnt(8)
v_pk_add_f32 v[144:145], v[144:145], v[164:165]
v_pk_add_f32 v[146:147], v[146:147], v[166:167]
s_waitcnt vmcnt(7)
v_pk_add_f32 v[144:145], v[144:145], v[168:169]
v_pk_add_f32 v[146:147], v[146:147], v[170:171]
s_waitcnt vmcnt(6)
v_pk_add_f32 v[144:145], v[144:145], v[172:173]
v_pk_add_f32 v[146:147], v[146:147], v[174:175]
s_waitcnt vmcnt(5)
v_pk_add_f32 v[144:145], v[144:145], v[176:177]
v_pk_add_f32 v[146:147], v[146:147], v[178:179]
s_waitcnt vmcnt(4)
v_pk_add_f32 v[144:145], v[144:145], v[180:181]
v_pk_add_f32 v[146:147], v[146:147], v[182:183]
s_waitcnt vmcnt(3)
v_pk_add_f32 v[144:145], v[144:145], v[184:185]
v_pk_add_f32 v[146:147], v[146:147], v[186:187]
s_waitcnt vmcnt(2)
v_pk_add_f32 v[144:145], v[144:145], v[188:189]
v_pk_add_f32 v[146:147], v[146:147], v[190:191]
s_waitcnt vmcnt(1)
v_pk_add_f32 v[144:145], v[144:145], v[192:193]
v_pk_add_f32 v[146:147], v[146:147], v[194:195]
s_waitcnt vmcnt(0)
v_pk_add_f32 v[144:145], v[144:145], v[196:197]
v_pk_add_f32 v[146:147], v[146:147], v[198:199]
ds_write_b128 v2, v[144:147]
s_mov_b64 exec, -1
s_waitcnt lgkmcnt(0)
L_nocs1_66:
s_barrier
s_xor_b32 s52, s98, 1
s_mul_i32 s52, s52, 28672
s_mul_i32 s53, s98, 28672
s_mul_i32 s54, s38, 7168
s_add_u32 s54, s54, 1048576
s_add_u32 s52, s52, s54
s_add_u32 s53, s53, s54
v_and_b32 v7, 31, v0
v_lshrrev_b32 v4, 5, v0
s_mul_i32 s3, s41, 7
s_lshl_b32 s48, s99, 2
s_add_u32 s3, s3, s48
v_lshrrev_b32 v5, 4, v7
v_mul_u32_u24 v5, 14336, v5
v_and_b32 v6, 15, v7
v_lshl_add_u32 v5, v6, 4, v5
v_lshl_add_u32 v5, v4, 3, v5
s_lshl_b32 s3, s3, 8
s_mul_i32 s48, s98, 28672
s_add_u32 s3, s3, s48
s_add_u32 s3, s3, 2883584
v_lshlrev_b32 v7, 4, v7
s_lshl_b32 s43, s98, 12
s_lshl_b32 s49, s41, 9
s_add_u32 s43, s43, s49
s_lshl_b32 s49, s99, 3
s_add_u32 s43, s43, s49
s_add_u32 s43, s43, 327680
s_lshl_b32 s55, s98, 7
s_lshl_b32 s48, s41, 4
s_add_u32 s55, s55, s48
s_add_u32 s55, s55, s49
s_add_u32 s55, s55, 16384
s_mul_i32 s48, s38, 12288
s_add_u32 s48, s48, 107520
v_add_u32 v8, s48, v1
s_sub_u32 s50, s99, 1
s_mov_b32 s51, s50
v_and_b32 v9, 3, v0
v_lshlrev_b32 v9, 3, v9
v_bfe_u32 v3, v0, 2, 1
v_lshl_add_u32 v9, v3, 7, v9
s_andn2_b32 s47, s98, 1
s_lshl_b32 s47, s47, 7
s_lshl_b32 s48, s38, 5
s_add_u32 s47, s47, s48
s_add_u32 s47, s47, 8192
s_mov_b64 exec, 0xff
L_poll_67:
buffer_load_dwordx2 v[10:11], v9, s[28:31], s47 offen sc1
s_sub_u32 s59, s59, 1
s_cbranch_scc1 L_fin
s_waitcnt vmcnt(0)
v_cmp_ne_u64 vcc, s[44:45], v[10:11]
s_cbranch_vccnz L_poll_67
s_mov_b64 exec, -1
s_add_u32 s57, s52, 0
buffer_load_dwordx4 v[120:123], v1, s[28:31], s57 offen offset:0 sc1
s_add_u32 s57, s52, 0
buffer_load_dwordx4 v[124:127], v1, s[28:31], s57 offen offset:1024 sc1
s_add_u32 s57, s52, 0
buffer_load_dwordx4 v[128:131], v1, s[28:31], s57 offen offset:2048 sc1
s_add_u32 s57, s52, 0
buffer_load_dwordx4 v[132:135], v1, s[28:31], s57 offen offset:3072 sc1
s_add_u32 s57, s52, 4096
buffer_load_dwordx4 v[136:139], v1, s[28:31], s57 offen offset:0 sc1
s_add_u32 s57, s52, 4096
buffer_load_dwordx4 v[140:143], v1, s[28:31], s57 offen offset:1024 sc1
s_add_u32 s57, s52, 4096
buffer_load_dwordx4 v[144:147], v1, s[28:31], s57 offen offset:2048 sc1
s_waitcnt vmcnt(6)
v_mfma_f32_32x32x16_bf16 v[88:103], a[224:227], v[120:123], 0
s_add_u32 s57, s53, 0
buffer_load_dwordx4 v[148:151], v1, s[28:31], s57 offen offset:0 sc1
v_mfma_f32_32x32x16_bf16 v[104:119], a[228:231], v[120:123], 0
s_waitcnt vmcnt(6)
v_mfma_f32_32x32x16_bf16 v[88:103], a[232:235], v[124:127], v[88:103]
s_add_u32 s57, s53, 0
buffer_load_dwordx4 v[152:155], v1, s[28:31], s57 offen offset:1024 sc1
v_mfma_f32_32x32x16_bf16 v[104:119], a[236:239], v[124:127], v[104:119]
s_waitcnt vmcnt(6)
v_mfma_f32_32x32x16_bf16 v[88:103], a[240:243], v[128:131], v[88:103]
s_add_u32 s57, s53, 0
buffer_load_dwordx4 v[156:159], v1, s[28:31], s57 offen offset:2048 sc1
v_mfma_f32_32x32x16_bf16 v[104:119], a[244:247], v[128:131], v[104:119]
s_waitcnt vmcnt(6)
v_mfma_f32_32x32x16_bf16 v[88:103], a[248:251], v[132:135], v[88:103]
s_add_u32 s57, s53, 0
buffer_load_dwordx4 v[160:163], v1, s[28:31], s57 offen offset:3072 sc1
v_mfma_f32_32x32x16_bf16 v[104:119], a[252:255], v[132:135], v[104:119]
s_waitcnt vmcnt(6)
v_mfma_f32_32x32x16_bf16 v[88:103], v[32:35], v[136:139], v[88:103]
s_add_u32 s57, s53, 4096
buffer_load_dwordx4 v[164:167], v1, s[28:31], s57 offen offset:0 sc1
v_mfma_f32_32x32x16_bf16 v[104:119], v[36:39], v[136:139], v[104:119]
s_waitcnt vmcnt(6)
v_mfma_f32_32x32x16_bf16 v[88:103], v[40:43], v[140:143], v[88:103]
s_add_u32 s57, s53, 4096
buffer_load_dwordx4 v[168:171], v1, s[28:31], s57 offen offset:1024 sc1
v_mfma_f32_32x32x16_bf16 v[104:119], v[44:47], v[140:143], v[104:119]
s_waitcnt vmcnt(6)
v_mfma_f32_32x32x16_bf16 v[88:103], v[48:51], v[144:147], v[88:103]
s_add_u32 s57, s53, 4096
buffer_load_dwordx4 v[172:175], v1, s[28:31], s57 offen offset:2048 sc1
v_mfma_f32_32x32x16_bf16 v[104:119], v[52:55], v[144:147], v[104:119]
s_waitcnt vmcnt(6)
s_xor_b32 s46, s38, 2
s_mul_i32 s46, s46, 12288
s_add_u32 s46, s46, 111616
v_add_u32 v2, s46, v1
v_mfma_f32_32x32x16_bf16 v[56:71], a[224:227], v[148:151], 0
s_and_b32 s56, s36, 1
s_lshl_b32 s56, s56, 2
s_add_u32 s56, s56, s38
s_mul_i32 s56, s56, 6272
s_mul_i32 s57, s37, 100352
s_add_u32 s56, s56, s57
s_add_u32 s56, s56, 24691712
v_mul_u32_u24 v14, 128, v0
s_mov_b32 exec_lo, 0xffffffff
s_mov_b32 exec_hi, 0x1ffff
buffer_load_dword v14, v14, s[28:31], s56 offen
s_mov_b64 exec, -1
ds_write_b128 v2, v[88:91] offset:0
ds_write_b128 v2, v[92:95] offset:1024
v_mfma_f32_32x32x16_bf16 v[72:87], a[228:231], v[148:151], 0
ds_write_b128 v2, v[96:99] offset:2048
ds_write_b128 v2, v[100:103] offset:3072
s_waitcnt vmcnt(6)
s_xor_b32 s46, s38, 3
s_mul_i32 s46, s46, 12288
s_add_u32 s46, s46, 115712
v_add_u32 v2, s46, v1
v_mfma_f32_32x32x16_bf16 v[56:71], a[232:235], v[152:155], v[56:71]
ds_write_b128 v2, v[104:107] offset:0
ds_write_b128 v2, v[108:111] offset:1024
v_mfma_f32_32x32x16_bf16 v[72:87], a[236:239], v[152:155], v[72:87]
ds_write_b128 v2, v[112:115] offset:2048
ds_write_b128 v2, v[116:119] offset:3072
s_waitcnt vmcnt(5)
v_mfma_f32_32x32x16_bf16 v[56:71], a[240:243], v[156:159], v[56:71]
s_waitcnt lgkmcnt(0)
s_barrier
ds_read_b128 v[184:187], v8 offset:4096
ds_read_b128 v[188:191], v8 offset:5120
ds_read_b128 v[192:195], v8 offset:6144
v_mfma_f32_32x32x16_bf16 v[72:87], a[244:247], v[156:159], v[72:87]
ds_read_b128 v[196:199], v8 offset:7168
ds_read_b128 v[200:203], v8 offset:8192
ds_read_b128 v[204:207], v8 offset:9216
ds_read_b128 v[208:211], v8 offset:10240
ds_read_b128 v[212:215], v8 offset:11264
s_waitcnt vmcnt(4)
v_mfma_f32_32x32x16_bf16 v[56:71], a[248:251], v[160:163], v[56:71]
v_mfma_f32_32x32x16_bf16 v[72:87], a[252:255], v[160:163], v[72:87]
s_waitcnt vmcnt(3)
v_mfma_f32_32x32x16_bf16 v[56:71], v[32:35], v[164:167], v[56:71]
s_waitcnt lgkmcnt(0)
v_add_f32 v184, v184, v200
v_add_f32 v185, v185, v201
v_add_f32 v186, v186, v202
v_add_f32 v187, v187, v203
v_mfma_f32_32x32x16_bf16 v[72:87], v[36:39], v[164:167], v[72:87]
v_add_f32 v188, v188, v204
v_add_f32 v189, v189, v205
v_add_f32 v190, v190, v206
v_add_f32 v191, v191, v207
s_waitcnt vmcnt(2)
v_mfma_f32_32x32x16_bf16 v[56:71], v[40:43], v[168:171], v[56:71]
v_add_f32 v192, v192, v208
v_add_f32 v193, v193, v209
v_add_f32 v194, v194, v210
v_add_f32 v195, v195, v211
v_mfma_f32_32x32x16_bf16 v[72:87], v[44:47], v[168:171], v[72:87]
v_add_f32 v196, v196, v212
v_add_f32 v197, v197, v213
v_add_f32 v198, v198, v214
v_add_f32 v199, v199, v215
s_waitcnt vmcnt(1)
s_xor_b32 s46, s38, 1
s_mul_i32 s46, s46, 12288
s_add_u32 s46, s46, 107520
v_add_u32 v2, s46, v1
v_mfma_f32_32x32x16_bf16 v[72:87], v[52:55], v[172:175], v[72:87]
v_mfma_f32_32x32x16_bf16 v[56:71], v[48:51], v[172:175], v[56:71]
s_nop 10
ds_write_b128 v2, v[72:75] offset:0
ds_write_b128 v2, v[76:79] offset:1024
ds_write_b128 v2, v[80:83] offset:2048
ds_write_b128 v2, v[84:87] offset:3072
v_pk_add_f32 v[56:57], v[56:57], v[184:185]
v_pk_add_f32 v[58:59], v[58:59], v[186:187]
v_pk_add_f32 v[60:61], v[60:61], v[188:189]
v_pk_add_f32 v[62:63], v[62:63], v[190:191]
v_pk_add_f32 v[64:65], v[64:65], v[192:193]
v_pk_add_f32 v[66:67], v[66:67], v[194:195]
v_pk_add_f32 v[68:69], v[68:69], v[196:197]
v_pk_add_f32 v[70:71], v[70:71], v[198:199]
s_waitcnt lgkmcnt(0)
s_barrier
ds_read_b128 v[184:187], v8 offset:0
ds_read_b128 v[188:191], v8 offset:1024
ds_read_b128 v[192:195], v8 offset:2048
ds_read_b128 v[196:199], v8 offset:3072
v_pk_add_f32 v[56:57], v[56:57], v[16:17]
v_pk_add_f32 v[58:59], v[58:59], v[18:19]
v_pk_add_f32 v[60:61], v[60:61], v[20:21]
v_pk_add_f32 v[62:63], v[62:63], v[22:23]
v_pk_add_f32 v[64:65], v[64:65], v[24:25]
v_pk_add_f32 v[66:67], v[66:67], v[26:27]
v_pk_add_f32 v[68:69], v[68:69], v[28:29]
v_pk_add_f32 v[70:71], v[70:71], v[30:31]
s_waitcnt lgkmcnt(3)
v_pk_add_f32 v[56:57], v[56:57], v[184:185]
v_pk_add_f32 v[58:59], v[58:59], v[186:187]
v_cvt_pk_bf16_f32 v88, v56, v57
v_cvt_pk_bf16_f32 v89, v58, v59
s_waitcnt lgkmcnt(2)
v_pk_add_f32 v[60:61], v[60:61], v[188:189]
v_pk_add_f32 v[62:63], v[62:63], v[190:191]
v_cvt_pk_bf16_f32 v90, v60, v61
v_cvt_pk_bf16_f32 v91, v62, v63
s_waitcnt lgkmcnt(1)
v_pk_add_f32 v[64:65], v[64:65], v[192:193]
v_pk_add_f32 v[66:67], v[66:67], v[194:195]
v_cvt_pk_bf16_f32 v92, v64, v65
v_cvt_pk_bf16_f32 v93, v66, v67
s_waitcnt lgkmcnt(0)
v_pk_add_f32 v[68:69], v[68:69], v[196:197]
v_pk_add_f32 v[70:71], v[70:71], v[198:199]
v_cvt_pk_bf16_f32 v94, v68, v69
v_cvt_pk_bf16_f32 v95, v70, v71
s_cmp_eq_u32 s39, 0
s_cbranch_scc1 L_slow_69
buffer_store_dwordx2 v[88:89], v5, s[28:31], s3 offen offset:0
buffer_store_dwordx2 v[90:91], v5, s[28:31], s3 offen offset:256
buffer_store_dwordx2 v[92:93], v5, s[28:31], s3 offen offset:512
s_mov_b64 exec, s[50:51]
buffer_store_dwordx2 v[94:95], v5, s[28:31], s3 offen offset:768
s_mov_b64 exec, -1
L_stored_70:
v_and_b32 v96, s50, v94
v_and_b32 v97, s50, v95
v_mov_b32 v98, 0
v_mov_b32 v99, 0
v_mov_b32 v100, 0
v_mov_b32 v101, 0
v_dot2c_f32_bf16 v98, s58, v88
v_dot2c_f32_bf16 v99, v88, v88
v_dot2c_f32_bf16 v100, s58, v89
v_dot2c_f32_bf16 v101, v89, v89
v_dot2c_f32_bf16 v98, s58, v90
v_dot2c_f32_bf16 v99, v90, v90
v_dot2c_f32_bf16 v100, s58, v91
v_dot2c_f32_bf16 v101, v91, v91
v_dot2c_f32_bf16 v98, s58, v92
v_dot2c_f32_bf16 v99, v92, v92
v_dot2c_f32_bf16 v100, s58, v93
v_dot2c_f32_bf16 v101, v93, v93
v_dot2c_f32_bf16 v98, s58, v96
v_dot2c_f32_bf16 v99, v96, v96
v_dot2c_f32_bf16 v100, s58, v97
v_dot2c_f32_bf16 v101, v97, v97
s_nop 2
v_pk_add_f32 v[98:99], v[98:99], v[100:101]
v_mov_b32 v100, v98
v_mov_b32 v101, v99
s_nop 0
v_permlane32_swap_b32 v98, v100
v_permlane32_swap_b32 v99, v101
v_pk_add_f32 v[98:99], v[98:99], v[100:101]
s_cmp_eq_u32 s39, 0
s_cbranch_scc1 L_slow_71
s_mov_b32 exec_hi, 0
buffer_store_dwordx2 v[98:99], v7, s[28:31], s43 offen
s_mov_b32 exec_hi, -1
L_stored_72:
v_lshlrev_b32 v16, 16, v88
v_and_b32 v17, 0xffff0000, v88
v_lshlrev_b32 v18, 16, v89
v_and_b32 v19, 0xffff0000, v89
v_lshlrev_b32 v20, 16, v90
v_and_b32 v21, 0xffff0000, v90
v_lshlrev_b32 v22, 16, v91
v_and_b32 v23, 0xffff0000, v91
v_lshlrev_b32 v24, 16, v92
v_and_b32 v25, 0xffff0000, v92
v_lshlrev_b32 v26, 16, v93
v_and_b32 v27, 0xffff0000, v93
v_lshlrev_b32 v28, 16, v94
v_and_b32 v29, 0xffff0000, v94
v_lshlrev_b32 v30, 16, v95
v_and_b32 v31, 0xffff0000, v95
v_mov_b32 v2, s44
v_mov_b32 v3, s45
v_mov_b32 v4, 0
s_mov_b64 exec, 1
s_cmp_eq_u32 s39, 0
s_cbranch_scc1 L_slow_73
s_waitcnt vmcnt(0)
buffer_store_dwordx2 v[2:3], v4, s[28:31], s55 offen
L_stored_74:
s_mov_b64 exec, -1
s_barrier
s_mul_i32 s3, s37, 100352
s_add_u32 s3, s3, 24691712
s_lshl_b32 s43, s38, 10
s_add_u32 s3, s3, s43
s_add_u32 s57, s3, 0
s_add_u32 m0, s43, 107520
s_nop 0
buffer_load_dwordx4 v1, s[28:31], s57 offen lds
s_add_u32 s57, s3, 4096
s_add_u32 m0, s43, 111616
s_nop 0
buffer_load_dwordx4 v1, s[28:31], s57 offen lds
s_add_u32 s57, s3, 8192
s_add_u32 m0, s43, 115712
s_nop 0
buffer_load_dwordx4 v1, s[28:31], s57 offen lds
s_add_u32 s57, s3, 12288
s_add_u32 m0, s43, 119808
s_nop 0
buffer_load_dwordx4 v1, s[28:31], s57 offen lds
s_add_u32 s57, s3, 16384
s_add_u32 m0, s43, 123904
s_nop 0
buffer_load_dwordx4 v1, s[28:31], s57 offen lds
s_add_u32 s57, s3, 20480
s_add_u32 m0, s43, 128000
s_nop 0
buffer_load_dwordx4 v1, s[28:31], s57 offen lds
s_add_u32 s57, s3, 24576
s_add_u32 m0, s43, 132096
s_nop 0
buffer_load_dwordx4 v1, s[28:31], s57 offen lds
s_add_u32 s57, s3, 28672
s_add_u32 m0, s43, 136192
s_nop 0
buffer_load_dwordx4 v1, s[28:31], s57 offen lds
s_add_u32 s57, s3, 32768
s_add_u32 m0, s43, 140288
s_nop 0
buffer_load_dwordx4 v1, s[28:31], s57 offen lds
s_add_u32 s57, s3, 36864
s_add_u32 m0, s43, 144384
s_nop 0
buffer_load_dwordx4 v1, s[28:31], s57 offen lds
s_add_u32 s57, s3, 40960
s_add_u32 m0, s43, 148480
s_nop 0
buffer_load_dwordx4 v1, s[28:31], s57 offen lds
s_add_u32 s57, s3, 45056
s_add_u32 m0, s43, 152576
s_nop 0
buffer_load_dwordx4 v1, s[28:31], s57 offen lds
s_sub_u32 s3, s3, s43
s_mov_b32 s43, 0
s_add_u32 s57, s3, 49152
s_add_u32 m0, s43, 156672
s_nop 0
buffer_load_dwordx4 v1, s[28:31], s57 offen lds
v_add_u32 v12, 57344, v1
v_lshlrev_b32 v2, 3, v0
s_lshl_b32 s46, s42, 7
s_add_u32 s46, s46, 16384
s_mul_i32 s3, s42, 28672
s_add_u32 s3, s3, 2883584
s_add_u32 s43, s3, 14336
s_lshl_b32 s48, s42, 12
s_add_u32 s48, s48, 327680
v_and_b32 v6, 15, v0
v_lshlrev_b32 v3, 4, v6
v_lshrrev_b32 v7, 4, v0
v_lshl_add_u32 v6, v7, 10, v3
s_lshl_b32 s49, s38, 8
s_add_u32 s49, s49, 160768
v_lshrrev_b32 v8, 2, v3
v_add_u32 v8, s49, v8
s_and_b32 s49, s98, 3
s_lshl_b32 s49, s49, 8
s_add_u32 s49, s49, 160768
v_and_b32 v9, 31, v0
v_lshl_add_u32 v9, v9, 2, s49
v_lshl_add_u32 v10, v7, 9, v3
v_lshrrev_b32 v11, 1, v7
v_lshl_add_u32 v11, v11, 9, v3
v_and_b32 v7, 1, v7
v_lshl_add_u32 v11, v7, 3, v11
s_mul_i32 s50, s42, 114688
s_mul_i32 s51, s37, 7168
s_add_u32 s50, s50, s51
s_add_u32 s50, s50, 6553600
s_add_u32 s51, s50, 4096
s_lshl_b32 s55, s42, 7
s_lshl_b32 s54, s37, 3
s_add_u32 s55, s55, s54
s_add_u32 s55, s55, 24576
s_mov_b64 exec, 0xffff
L_poll_75:
buffer_load_dwordx2 v[4:5], v2, s[28:31], s46 offen sc1
s_sub_u32 s59, s59, 1
s_cbranch_scc1 L_fin
s_waitcnt vmcnt(0)
v_cmp_ne_u64 vcc, s[44:45], v[4:5]
s_cbranch_vccnz L_poll_75
s_mov_b64 exec, -1
buffer_load_dwordx4 v[56:59], v1, s[28:31], s3 offen offset:0 sc1
buffer_load_dwordx4 v[60:63], v1, s[28:31], s43 offen offset:0 sc1
buffer_load_dwordx4 v[64:67], v1, s[28:31], s3 offen offset:1024 sc1
buffer_load_dwordx4 v[68:71], v1, s[28:31], s43 offen offset:1024 sc1
buffer_load_dwordx4 v[72:75], v1, s[28:31], s3 offen offset:2048 sc1
buffer_load_dwordx4 v[76:79], v1, s[28:31], s43 offen offset:2048 sc1
buffer_load_dwordx4 v[200:203], v6, s[28:31], s48 offen offset:0 sc1
buffer_load_dwordx4 v[80:83], v1, s[28:31], s3 offen offset:3072 sc1
ds_read_b128 v[224:227], v12 offset:0
ds_read_b128 v[228:231], v12 offset:1024
ds_read_b128 v[232:235], v12 offset:2048
ds_read_b128 v[236:239], v12 offset:3072
ds_read_b128 v[240:243], v12 offset:4096
ds_read_b128 v[244:247], v12 offset:5120
ds_read_b128 v[248:251], v12 offset:6144
s_waitcnt vmcnt(6) lgkmcnt(6)
v_mfma_f32_16x16x32_bf16 v[168:171], v[224:227], v[56:59], 0
ds_read_b128 v[252:255], v12 offset:7168
buffer_load_dwordx4 v[84:87], v1, s[28:31], s43 offen offset:3072 sc1
v_mfma_f32_16x16x32_bf16 v[184:187], v[224:227], v[60:63], 0
s_waitcnt lgkmcnt(6)
v_mfma_f32_16x16x32_bf16 v[172:175], v[228:231], v[56:59], 0
ds_read_b128 v[224:227], v12 offset:8192
buffer_load_dwordx4 v[204:207], v6, s[28:31], s48 offen offset:512 sc1
v_mfma_f32_16x16x32_bf16 v[188:191], v[228:231], v[60:63], 0
s_waitcnt lgkmcnt(6)
v_mfma_f32_16x16x32_bf16 v[176:179], v[232:235], v[56:59], 0
ds_read_b128 v[228:231], v12 offset:9216
s_add_u32 s3, s3, 4096
buffer_load_dwordx4 v[88:91], v1, s[28:31], s3 offen offset:0 sc1
v_mfma_f32_16x16x32_bf16 v[192:195], v[232:235], v[60:63], 0
s_waitcnt lgkmcnt(6)
v_mfma_f32_16x16x32_bf16 v[180:183], v[236:239], v[56:59], 0
ds_read_b128 v[232:235], v12 offset:10240
s_add_u32 s43, s43, 4096
buffer_load_dwordx4 v[92:95], v1, s[28:31], s43 offen offset:0 sc1
v_mfma_f32_16x16x32_bf16 v[196:199], v[236:239], v[60:63], 0
s_waitcnt vmcnt(8) lgkmcnt(6)
v_mfma_f32_16x16x32_bf16 v[168:171], v[240:243], v[64:67], v[168:171]
ds_read_b128 v[236:239], v12 offset:11264
buffer_load_dwordx4 v[208:211], v6, s[28:31], s48 offen offset:256 sc1
v_mfma_f32_16x16x32_bf16 v[184:187], v[240:243], v[68:71], v[184:187]
s_waitcnt lgkmcnt(6)
v_mfma_f32_16x16x32_bf16 v[172:175], v[244:247], v[64:67], v[172:175]
ds_read_b128 v[240:243], v12 offset:12288
buffer_load_dwordx4 v[96:99], v1, s[28:31], s3 offen offset:1024 sc1
v_mfma_f32_16x16x32_bf16 v[188:191], v[244:247], v[68:71], v[188:191]
s_waitcnt lgkmcnt(6)
v_mfma_f32_16x16x32_bf16 v[176:179], v[248:251], v[64:67], v[176:179]
ds_read_b128 v[244:247], v12 offset:13312
buffer_load_dwordx4 v[100:103], v1, s[28:31], s43 offen offset:1024 sc1
v_mfma_f32_16x16x32_bf16 v[192:195], v[248:251], v[68:71], v[192:195]
s_waitcnt lgkmcnt(6)
v_mfma_f32_16x16x32_bf16 v[180:183], v[252:255], v[64:67], v[180:183]
ds_read_b128 v[248:251], v12 offset:14336
v_mfma_f32_16x16x32_bf16 v[196:199], v[252:255], v[68:71], v[196:199]
s_waitcnt vmcnt(9) lgkmcnt(6)
v_mfma_f32_16x16x32_bf16 v[168:171], v[224:227], v[72:75], v[168:171]
ds_read_b128 v[252:255], v12 offset:15360
buffer_load_dwordx4 v[212:215], v6, s[28:31], s48 offen offset:768 sc1
v_mfma_f32_16x16x32_bf16 v[184:187], v[224:227], v[76:79], v[184:187]
s_waitcnt lgkmcnt(6)
v_mfma_f32_16x16x32_bf16 v[172:175], v[228:231], v[72:75], v[172:175]
ds_read_b128 v[224:227], v12 offset:16384
buffer_load_dwordx4 v[104:107], v1, s[28:31], s3 offen offset:2048 sc1
v_mfma_f32_16x16x32_bf16 v[188:191], v[228:231], v[76:79], v[188:191]
s_waitcnt lgkmcnt(6)
v_mfma_f32_16x16x32_bf16 v[176:179], v[232:235], v[72:75], v[176:179]
ds_read_b128 v[228:231], v12 offset:17408
buffer_load_dwordx4 v[108:111], v1, s[28:31], s43 offen offset:2048 sc1
v_mfma_f32_16x16x32_bf16 v[192:195], v[232:235], v[76:79], v[192:195]
s_waitcnt lgkmcnt(6)
v_mfma_f32_16x16x32_bf16 v[180:183], v[236:239], v[72:75], v[180:183]
ds_read_b128 v[232:235], v12 offset:18432
v_mfma_f32_16x16x32_bf16 v[196:199], v[236:239], v[76:79], v[196:199]
s_waitcnt vmcnt(9) lgkmcnt(6)
v_mfma_f32_16x16x32_bf16 v[168:171], v[240:243], v[80:83], v[168:171]
ds_read_b128 v[236:239], v12 offset:19456
buffer_load_dwordx4 v[112:115], v1, s[28:31], s3 offen offset:3072 sc1
v_mfma_f32_16x16x32_bf16 v[184:187], v[240:243], v[84:87], v[184:187]
s_waitcnt lgkmcnt(6)
v_mfma_f32_16x16x32_bf16 v[172:175], v[244:247], v[80:83], v[172:175]
ds_read_b128 v[240:243], v12 offset:20480
buffer_load_dwordx4 v[116:119], v1, s[28:31], s43 offen offset:3072 sc1
v_mfma_f32_16x16x32_bf16 v[188:191], v[244:247], v[84:87], v[188:191]
s_waitcnt lgkmcnt(6)
v_mfma_f32_16x16x32_bf16 v[176:179], v[248:251], v[80:83], v[176:179]
ds_read_b128 v[244:247], v12 offset:21504
v_mfma_f32_16x16x32_bf16 v[192:195], v[248:251], v[84:87], v[192:195]
s_waitcnt lgkmcnt(6)
v_mfma_f32_16x16x32_bf16 v[180:183], v[252:255], v[80:83], v[180:183]
ds_read_b128 v[248:251], v12 offset:22528
v_mfma_f32_16x16x32_bf16 v[196:199], v[252:255], v[84:87], v[196:199]
s_waitcnt vmcnt(8) lgkmcnt(6)
v_mfma_f32_16x16x32_bf16 v[168:171], v[224:227], v[88:91], v[168:171]
ds_read_b128 v[252:255], v12 offset:23552
s_add_u32 s3, s3, 4096
buffer_load_dwordx4 v[120:123], v1, s[28:31], s3 offen offset:0 sc1
v_mfma_f32_16x16x32_bf16 v[184:187], v[224:227], v[92:95], v[184:187]
s_waitcnt lgkmcnt(6)
v_mfma_f32_16x16x32_bf16 v[172:175], v[228:231], v[88:91], v[172:175]
ds_read_b128 v[224:227], v12 offset:24576
s_add_u32 s43, s43, 4096
buffer_load_dwordx4 v[124:127], v1, s[28:31], s43 offen offset:0 sc1
v_mfma_f32_16x16x32_bf16 v[188:191], v[228:231], v[92:95], v[188:191]
s_waitcnt lgkmcnt(6)
v_mfma_f32_16x16x32_bf16 v[176:179], v[232:235], v[88:91], v[176:179]
ds_read_b128 v[228:231], v12 offset:25600
v_mfma_f32_16x16x32_bf16 v[192:195], v[232:235], v[92:95], v[192:195]
s_waitcnt lgkmcnt(6)
v_mfma_f32_16x16x32_bf16 v[180:183], v[236:239], v[88:91], v[180:183]
ds_read_b128 v[232:235], v12 offset:26624
v_mfma_f32_16x16x32_bf16 v[196:199], v[236:239], v[92:95], v[196:199]
s_waitcnt vmcnt(7) lgkmcnt(6)
v_mfma_f32_16x16x32_bf16 v[168:171], v[240:243], v[96:99], v[168:171]
ds_read_b128 v[236:239], v12 offset:27648
buffer_load_dwordx4 v[128:131], v1, s[28:31], s3 offen offset:1024 sc1
v_mfma_f32_16x16x32_bf16 v[184:187], v[240:243], v[100:103], v[184:187]
s_waitcnt lgkmcnt(6)
v_mfma_f32_16x16x32_bf16 v[172:175], v[244:247], v[96:99], v[172:175]
ds_read_b128 v[240:243], v12 offset:28672
buffer_load_dwordx4 v[132:135], v1, s[28:31], s43 offen offset:1024 sc1
v_mfma_f32_16x16x32_bf16 v[188:191], v[244:247], v[100:103], v[188:191]
s_waitcnt lgkmcnt(6)
v_mfma_f32_16x16x32_bf16 v[176:179], v[248:251], v[96:99], v[176:179]
ds_read_b128 v[244:247], v12 offset:29696
v_mfma_f32_16x16x32_bf16 v[192:195], v[248:251], v[100:103], v[192:195]
s_waitcnt lgkmcnt(6)
v_mfma_f32_16x16x32_bf16 v[180:183], v[252:255], v[96:99], v[180:183]
ds_read_b128 v[248:251], v12 offset:30720
v_mfma_f32_16x16x32_bf16 v[196:199], v[252:255], v[100:103], v[196:199]
s_waitcnt vmcnt(6) lgkmcnt(6)
v_mfma_f32_16x16x32_bf16 v[168:171], v[224:227], v[104:107], v[168:171]
ds_read_b128 v[252:255], v12 offset:31744
buffer_load_dwordx4 v[136:139], v1, s[28:31], s3 offen offset:2048 sc1
v_mfma_f32_16x16x32_bf16 v[184:187], v[224:227], v[108:111], v[184:187]
v_add_f32 v200, v200, v202
v_add_f32 v204, v204, v206
s_waitcnt lgkmcnt(6)
v_mfma_f32_16x16x32_bf16 v[172:175], v[228:231], v[104:107], v[172:175]
ds_read_b128 v[224:227], v12 offset:32768
buffer_load_dwordx4 v[140:143], v1, s[28:31], s43 offen offset:2048 sc1
v_mfma_f32_16x16x32_bf16 v[188:191], v[228:231], v[108:111], v[188:191]
v_add_f32 v201, v201, v203
v_add_f32 v205, v205, v207
s_waitcnt lgkmcnt(6)
v_mfma_f32_16x16x32_bf16 v[176:179], v[232:235], v[104:107], v[176:179]
ds_read_b128 v[228:231], v12 offset:33792
v_mfma_f32_16x16x32_bf16 v[192:195], v[232:235], v[108:111], v[192:195]
v_add_f32 v200, v200, v204
v_add_f32 v201, v201, v205
s_waitcnt lgkmcnt(6)
v_mfma_f32_16x16x32_bf16 v[180:183], v[236:239], v[104:107], v[180:183]
ds_read_b128 v[232:235], v12 offset:34816
v_mfma_f32_16x16x32_bf16 v[196:199], v[236:239], v[108:111], v[196:199]
v_mov_b32 v202, v200
v_mov_b32 v203, v201
s_waitcnt vmcnt(6) lgkmcnt(6)
v_mfma_f32_16x16x32_bf16 v[168:171], v[240:243], v[112:115], v[168:171]
ds_read_b128 v[236:239], v12 offset:35840
buffer_load_dwordx4 v[144:147], v1, s[28:31], s3 offen offset:3072 sc1
v_mfma_f32_16x16x32_bf16 v[184:187], v[240:243], v[116:119], v[184:187]
v_permlane16_swap_b32 v200, v202
v_permlane16_swap_b32 v201, v203
s_waitcnt lgkmcnt(6)
v_mfma_f32_16x16x32_bf16 v[172:175], v[244:247], v[112:115], v[172:175]
ds_read_b128 v[240:243], v12 offset:36864
buffer_load_dwordx4 v[148:151], v1, s[28:31], s43 offen offset:3072 sc1
v_mfma_f32_16x16x32_bf16 v[188:191], v[244:247], v[116:119], v[188:191]
v_add_f32 v200, v200, v202
v_add_f32 v201, v201, v203
s_waitcnt lgkmcnt(6)
v_mfma_f32_16x16x32_bf16 v[176:179], v[248:251], v[112:115], v[176:179]
ds_read_b128 v[244:247], v12 offset:37888
v_mfma_f32_16x16x32_bf16 v[192:195], v[248:251], v[116:119], v[192:195]
v_mov_b32 v202, v200
v_mov_b32 v203, v201
s_waitcnt lgkmcnt(6)
v_mfma_f32_16x16x32_bf16 v[180:183], v[252:255], v[112:115], v[180:183]
ds_read_b128 v[248:251], v12 offset:38912
v_mfma_f32_16x16x32_bf16 v[196:199], v[252:255], v[116:119], v[196:199]
v_permlane32_swap_b32 v200, v202
v_permlane32_swap_b32 v201, v203
s_waitcnt vmcnt(6) lgkmcnt(6)
v_mfma_f32_16x16x32_bf16 v[168:171], v[224:227], v[120:123], v[168:171]
ds_read_b128 v[252:255], v12 offset:39936
s_add_u32 s3, s3, 4096
buffer_load_dwordx4 v[152:155], v1, s[28:31], s3 offen offset:0 sc1
v_mfma_f32_16x16x32_bf16 v[184:187], v[224:227], v[124:127], v[184:187]
v_add_f32 v200, v200, v202
v_add_f32 v201, v201, v203
s_waitcnt lgkmcnt(6)
v_mfma_f32_16x16x32_bf16 v[172:175], v[228:231], v[120:123], v[172:175]
ds_read_b128 v[224:227], v12 offset:40960
s_add_u32 s43, s43, 4096
buffer_load_dwordx4 v[156:159], v1, s[28:31], s43 offen offset:0 sc1
v_mfma_f32_16x16x32_bf16 v[188:191], v[228:231], v[124:127], v[188:191]
v_mul_f32 v200, 0xbb124925, v200
v_mul_f32 v201, 0x3b124925, v201
s_waitcnt lgkmcnt(6)
v_mfma_f32_16x16x32_bf16 v[176:179], v[232:235], v[120:123], v[176:179]
ds_read_b128 v[228:231], v12 offset:41984
v_mfma_f32_16x16x32_bf16 v[192:195], v[232:235], v[124:127], v[192:195]
v_fma_f32 v201, -v200, v200, v201
v_max_f32 v201, 0, v201
s_waitcnt lgkmcnt(6)
v_mfma_f32_16x16x32_bf16 v[180:183], v[236:239], v[120:123], v[180:183]
ds_read_b128 v[232:235], v12 offset:43008
v_mfma_f32_16x16x32_bf16 v[196:199], v[236:239], v[124:127], v[196:199]
v_add_f32 v201, 0x3727c5ac, v201
v_rsq_f32 v202, v201
s_waitcnt vmcnt(6) lgkmcnt(6)
v_mfma_f32_16x16x32_bf16 v[168:171], v[240:243], v[128:131], v[168:171]
ds_read_b128 v[236:239], v12 offset:44032
buffer_load_dwordx4 v[160:163], v1, s[28:31], s3 offen offset:1024 sc1
v_mfma_f32_16x16x32_bf16 v[184:187], v[240:243], v[132:135], v[184:187]
v_mov_b32 v2, v200
v_add_f32 v208, v208, v210
s_waitcnt lgkmcnt(6)
v_mfma_f32_16x16x32_bf16 v[172:175], v[244:247], v[128:131], v[172:175]
ds_read_b128 v[240:243], v12 offset:45056
buffer_load_dwordx4 v[164:167], v1, s[28:31], s43 offen offset:1024 sc1
v_mfma_f32_16x16x32_bf16 v[188:191], v[244:247], v[132:135], v[188:191]
v_add_f32 v212, v212, v214
v_add_f32 v209, v209, v211
s_waitcnt lgkmcnt(6)
v_mfma_f32_16x16x32_bf16 v[176:179], v[248:251], v[128:131], v[176:179]
ds_read_b128 v[244:247], v12 offset:46080
v_mfma_f32_16x16x32_bf16 v[192:195], v[248:251], v[132:135], v[192:195]
v_add_f32 v213, v213, v215
v_add_f32 v208, v208, v212
s_waitcnt lgkmcnt(6)
v_mfma_f32_16x16x32_bf16 v[180:183], v[252:255], v[128:131], v[180:183]
ds_read_b128 v[248:251], v12 offset:47104
v_mfma_f32_16x16x32_bf16 v[196:199], v[252:255], v[132:135], v[196:199]
v_add_f32 v209, v209, v213
v_mov_b32 v210, v208
s_waitcnt vmcnt(6) lgkmcnt(6)
v_mfma_f32_16x16x32_bf16 v[168:171], v[224:227], v[136:139], v[168:171]
ds_read_b128 v[252:255], v12 offset:48128
v_mfma_f32_16x16x32_bf16 v[184:187], v[224:227], v[140:143], v[184:187]
v_mov_b32 v211, v209
v_permlane16_swap_b32 v208, v210
s_barrier
s_waitcnt lgkmcnt(6)
v_mfma_f32_16x16x32_bf16 v[172:175], v[228:231], v[136:139], v[172:175]
ds_read_b128 v[224:227], v12 offset:49152
v_mfma_f32_16x16x32_bf16 v[188:191], v[228:231], v[140:143], v[188:191]
v_permlane16_swap_b32 v209, v211
v_add_f32 v208, v208, v210
s_waitcnt lgkmcnt(6)
v_mfma_f32_16x16x32_bf16 v[176:179], v[232:235], v[136:139], v[176:179]
ds_read_b128 v[228:231], v12 offset:50176
v_mfma_f32_16x16x32_bf16 v[192:195], v[232:235], v[140:143], v[192:195]
v_add_f32 v209, v209, v211
v_mov_b32 v210, v208
s_waitcnt lgkmcnt(6)
v_mfma_f32_16x16x32_bf16 v[180:183], v[236:239], v[136:139], v[180:183]
ds_read_b128 v[232:235], v12 offset:51200
v_mfma_f32_16x16x32_bf16 v[196:199], v[236:239], v[140:143], v[196:199]
v_mov_b32 v211, v209
v_permlane32_swap_b32 v208, v210
s_waitcnt vmcnt(4) lgkmcnt(6)
v_mfma_f32_16x16x32_bf16 v[168:171], v[240:243], v[144:147], v[168:171]
ds_read_b128 v[236:239], v12 offset:52224
v_mfma_f32_16x16x32_bf16 v[184:187], v[240:243], v[148:151], v[184:187]
v_permlane32_swap_b32 v209, v211
v_add_f32 v208, v208, v210
s_waitcnt lgkmcnt(6)
v_mfma_f32_16x16x32_bf16 v[172:175], v[244:247], v[144:147], v[172:175]
ds_read_b128 v[240:243], v12 offset:53248
v_mfma_f32_16x16x32_bf16 v[188:191], v[244:247], v[148:151], v[188:191]
v_add_f32 v209, v209, v211
v_mul_f32 v208, 0xbb124925, v208
s_waitcnt lgkmcnt(6)
v_mfma_f32_16x16x32_bf16 v[176:179], v[248:251], v[144:147], v[176:179]
ds_read_b128 v[244:247], v12 offset:54272
v_mfma_f32_16x16x32_bf16 v[192:195], v[248:251], v[148:151], v[192:195]
v_mul_f32 v209, 0x3b124925, v209
v_fma_f32 v209, -v208, v208, v209
s_waitcnt lgkmcnt(6)
v_mfma_f32_16x16x32_bf16 v[180:183], v[252:255], v[144:147], v[180:183]
ds_read_b128 v[248:251], v12 offset:55296
v_mfma_f32_16x16x32_bf16 v[196:199], v[252:255], v[148:151], v[196:199]
v_max_f32 v209, 0, v209
v_add_f32 v209, 0x3727c5ac, v209
s_waitcnt vmcnt(2) lgkmcnt(6)
v_mfma_f32_16x16x32_bf16 v[168:171], v[224:227], v[152:155], v[168:171]
ds_read_b128 v[252:255], v12 offset:56320
v_mfma_f32_16x16x32_bf16 v[184:187], v[224:227], v[156:159], v[184:187]
v_rsq_f32 v210, v209
v_mov_b32 v3, v208
s_waitcnt lgkmcnt(6)
v_mfma_f32_16x16x32_bf16 v[172:175], v[228:231], v[152:155], v[172:175]
v_mfma_f32_16x16x32_bf16 v[188:191], v[228:231], v[156:159], v[188:191]
s_waitcnt lgkmcnt(5)
v_mfma_f32_16x16x32_bf16 v[176:179], v[232:235], v[152:155], v[176:179]
v_mfma_f32_16x16x32_bf16 v[192:195], v[232:235], v[156:159], v[192:195]
s_waitcnt lgkmcnt(4)
v_mfma_f32_16x16x32_bf16 v[180:183], v[236:239], v[152:155], v[180:183]
v_mfma_f32_16x16x32_bf16 v[196:199], v[236:239], v[156:159], v[196:199]
s_waitcnt vmcnt(0) lgkmcnt(3)
v_mfma_f32_16x16x32_bf16 v[168:171], v[240:243], v[160:163], v[168:171]
v_mfma_f32_16x16x32_bf16 v[184:187], v[240:243], v[164:167], v[184:187]
s_waitcnt lgkmcnt(2)
v_mfma_f32_16x16x32_bf16 v[172:175], v[244:247], v[160:163], v[172:175]
v_mfma_f32_16x16x32_bf16 v[188:191], v[244:247], v[164:167], v[188:191]
s_waitcnt lgkmcnt(1)
v_mfma_f32_16x16x32_bf16 v[176:179], v[248:251], v[160:163], v[176:179]
v_mfma_f32_16x16x32_bf16 v[192:195], v[248:251], v[164:167], v[192:195]
s_waitcnt lgkmcnt(0)
v_mfma_f32_16x16x32_bf16 v[180:183], v[252:255], v[160:163], v[180:183]
v_mfma_f32_16x16x32_bf16 v[196:199], v[252:255], v[164:167], v[196:199]
ds_write_b32 v8, v202
ds_write_b32 v8, v210 offset:64
v_add_u32 v12, 57344, v12
v_and_b32 v4, 48, v0
v_add_u32 v4, 158080, v4
ds_read_b128 v[240:243], v4 offset:0
ds_read_b128 v[244:247], v4 offset:64
ds_read_b128 v[248:251], v4 offset:128
ds_read_b128 v[252:255], v4 offset:192
ds_read_b128 v[224:227], v12 offset:0
ds_read_b128 v[228:231], v12 offset:1024
ds_read_b128 v[232:235], v12 offset:2048
v_mov_b32 v6, v3
s_waitcnt lgkmcnt(3)
v_pk_fma_f32 v[168:169], v[240:241], v[2:3], v[168:169] op_sel_hi:[1,0,1]
v_pk_fma_f32 v[170:171], v[242:243], v[2:3], v[170:171] op_sel_hi:[1,0,1]
v_pk_fma_f32 v[172:173], v[244:245], v[2:3], v[172:173] op_sel_hi:[1,0,1]
v_pk_fma_f32 v[174:175], v[246:247], v[2:3], v[174:175] op_sel_hi:[1,0,1]
v_pk_fma_f32 v[176:177], v[248:249], v[2:3], v[176:177] op_sel_hi:[1,0,1]
v_pk_fma_f32 v[178:179], v[250:251], v[2:3], v[178:179] op_sel_hi:[1,0,1]
v_pk_fma_f32 v[180:181], v[252:253], v[2:3], v[180:181] op_sel_hi:[1,0,1]
v_pk_fma_f32 v[182:183], v[254:255], v[2:3], v[182:183] op_sel_hi:[1,0,1]
v_pk_fma_f32 v[184:185], v[240:241], v[6:7], v[184:185] op_sel_hi:[1,0,1]
v_pk_fma_f32 v[186:187], v[242:243], v[6:7], v[186:187] op_sel_hi:[1,0,1]
v_pk_fma_f32 v[188:189], v[244:245], v[6:7], v[188:189] op_sel_hi:[1,0,1]
v_pk_fma_f32 v[190:191], v[246:247], v[6:7], v[190:191] op_sel_hi:[1,0,1]
v_pk_fma_f32 v[192:193], v[248:249], v[6:7], v[192:193] op_sel_hi:[1,0,1]
v_pk_fma_f32 v[194:195], v[250:251], v[6:7], v[194:195] op_sel_hi:[1,0,1]
v_pk_fma_f32 v[196:197], v[252:253], v[6:7], v[196:197] op_sel_hi:[1,0,1]
v_pk_fma_f32 v[198:199], v[254:255], v[6:7], v[198:199] op_sel_hi:[1,0,1]
v_cvt_pk_bf16_f32 v168, v168, v169
v_cvt_pk_bf16_f32 v169, v170, v171
v_cvt_pk_bf16_f32 v170, v172, v173
v_cvt_pk_bf16_f32 v171, v174, v175
v_pk_max_i16 v168, v168, 0
v_pk_max_i16 v169, v169, 0
v_pk_max_i16 v170, v170, 0
v_pk_max_i16 v171, v171, 0
v_cvt_pk_bf16_f32 v176, v176, v177
v_cvt_pk_bf16_f32 v177, v178, v179
v_cvt_pk_bf16_f32 v178, v180, v181
v_cvt_pk_bf16_f32 v179, v182, v183
v_pk_max_i16 v176, v176, 0
v_pk_max_i16 v177, v177, 0
v_pk_max_i16 v178, v178, 0
v_pk_max_i16 v179, v179, 0
v_cvt_pk_bf16_f32 v184, v184, v185
v_cvt_pk_bf16_f32 v185, v186, v187
v_cvt_pk_bf16_f32 v186, v188, v189
v_cvt_pk_bf16_f32 v187, v190, v191
v_pk_max_i16 v184, v184, 0
v_pk_max_i16 v185, v185, 0
v_pk_max_i16 v186, v186, 0
v_pk_max_i16 v187, v187, 0
v_cvt_pk_bf16_f32 v192, v192, v193
v_cvt_pk_bf16_f32 v193, v194, v195
v_cvt_pk_bf16_f32 v194, v196, v197
v_cvt_pk_bf16_f32 v195, v198, v199
v_pk_max_i16 v192, v192, 0
v_pk_max_i16 v193, v193, 0
v_pk_max_i16 v194, v194, 0
v_pk_max_i16 v195, v195, 0
buffer_store_dwordx4 v[168:171], v10, s[28:31], s50 offen offset:0 sc1
buffer_store_dwordx4 v[184:187], v10, s[28:31], s50 offen offset:256 sc1
buffer_store_dwordx4 v[176:179], v10, s[28:31], s50 offen offset:2048 sc1
buffer_store_dwordx4 v[192:195], v10, s[28:31], s50 offen offset:2304 sc1
s_getpc_b64 s[46:47]
L_pc_77:
s_lshr_b32 s56, s2, 3
s_lshl_b32 s56, s56, 2
s_add_u32 s56, s56, s38
s_lshl_b32 s56, s56, 8
v_lshl_add_u32 v14, v0, 7, s56
s_mov_b32 s56, L_code_end-L_pc_77-8
v_min_u32 v14, s56, v14
s_mov_b64 exec, 3
global_load_dword v14, v14, s[46:47]
s_mov_b64 exec, -1
ds_read_b128 v[244:247], v4 offset:256
ds_read_b128 v[248:251], v4 offset:320
ds_read_b128 v[252:255], v4 offset:384
s_waitcnt lgkmcnt(0)
s_waitcnt lgkmcnt(2)
v_mfma_f32_16x16x32_bf16 v[200:203], v[224:227], v[56:59], 0
ds_read_b128 v[236:239], v12 offset:3072
v_mfma_f32_16x16x32_bf16 v[212:215], v[224:227], v[60:63], 0
s_xor_b32 s52, s98, 1
s_mul_i32 s52, s52, 114688
s_mul_i32 s100, s41, 229376
s_mul_i32 s48, s38, 57344
s_add_u32 s100, s100, s48
s_add_u32 s100, s100, 22282240
s_lshl_b32 s48, s99, 10
s_add_u32 s101, s100, 1024
s_add_u32 s100, s100, s48
s_sub_u32 s101, s101, s48
s_add_u32 s57, s100, 32768
s_bitcmp1_b32 s57, 10
s_cselect_b32 exec_lo, s61, -1
s_mov_b32 exec_hi, exec_lo
buffer_load_dwordx4 a[128:131], v1, s[28:31], s57 offen
s_mov_b64 exec, -1
s_waitcnt lgkmcnt(2)
v_mfma_f32_16x16x32_bf16 v[204:207], v[228:231], v[56:59], 0
ds_read_b128 v[224:227], v12 offset:4096
v_mfma_f32_16x16x32_bf16 v[216:219], v[228:231], v[60:63], 0
s_mul_i32 s53, s98, 114688
s_mul_i32 s54, s38, 28672
s_add_u32 s57, s101, 32768
s_bitcmp1_b32 s57, 10
s_cselect_b32 exec_lo, s61, -1
s_mov_b32 exec_hi, exec_lo
buffer_load_dwordx4 a[132:135], v1, s[28:31], s57 offen
s_mov_b64 exec, -1
s_waitcnt lgkmcnt(2)
v_mfma_f32_16x16x32_bf16 v[208:211], v[232:235], v[56:59], 0
ds_read_b128 v[228:231], v12 offset:5120
v_mfma_f32_16x16x32_bf16 v[220:223], v[232:235], v[60:63], 0
s_add_u32 s54, s54, 6553600
s_add_u32 s52, s52, s54
s_add_u32 s57, s100, 34816
s_bitcmp1_b32 s57, 10
s_cselect_b32 exec_lo, s61, -1
s_mov_b32 exec_hi, exec_lo
buffer_load_dwordx4 a[136:139], v1, s[28:31], s57 offen
s_mov_b64 exec, -1
s_waitcnt lgkmcnt(2)
v_mfma_f32_16x16x32_bf16 v[200:203], v[236:239], v[64:67], v[200:203]
ds_read_b128 v[232:235], v12 offset:6144
v_mfma_f32_16x16x32_bf16 v[212:215], v[236:239], v[68:71], v[212:215]
s_add_u32 s53, s53, s54
v_and_b32 v8, 3, v0
s_add_u32 s57, s101, 34816
s_bitcmp1_b32 s57, 10
s_cselect_b32 exec_lo, s61, -1
s_mov_b32 exec_hi, exec_lo
buffer_load_dwordx4 a[140:143], v1, s[28:31], s57 offen
s_mov_b64 exec, -1
s_waitcnt lgkmcnt(2)
v_mfma_f32_16x16x32_bf16 v[204:207], v[224:227], v[64:67], v[204:207]
ds_read_b128 v[236:239], v12 offset:7168
v_mfma_f32_16x16x32_bf16 v[216:219], v[224:227], v[68:71], v[216:219]
v_lshlrev_b32 v8, 3, v8
v_bfe_u32 v5, v0, 2, 1
s_add_u32 s57, s100, 43008
s_bitcmp1_b32 s57, 10
s_cselect_b32 exec_lo, s61, -1
s_mov_b32 exec_hi, exec_lo
buffer_load_dwordx4 a[168:171], v1, s[28:31], s57 offen
s_mov_b64 exec, -1
s_waitcnt lgkmcnt(2)
v_mfma_f32_16x16x32_bf16 v[208:211], v[228:231], v[64:67], v[208:211]
ds_read_b128 v[224:227], v12 offset:8192
v_mfma_f32_16x16x32_bf16 v[220:223], v[228:231], v[68:71], v[220:223]
v_lshl_add_u32 v8, v5, 7, v8
s_andn2_b32 s47, s98, 1
s_add_u32 s57, s101, 43008
s_bitcmp1_b32 s57, 10
s_cselect_b32 exec_lo, s61, -1
s_mov_b32 exec_hi, exec_lo
buffer_load_dwordx4 a[172:175], v1, s[28:31], s57 offen
s_mov_b64 exec, -1
s_waitcnt lgkmcnt(2)
v_mfma_f32_16x16x32_bf16 v[200:203], v[232:235], v[72:75], v[200:203]
ds_read_b128 v[228:231], v12 offset:9216
v_mfma_f32_16x16x32_bf16 v[212:215], v[232:235], v[76:79], v[212:215]
s_lshl_b32 s47, s47, 7
s_lshl_b32 s46, s38, 5
s_add_u32 s57, s100, 45056
s_bitcmp1_b32 s57, 10
s_cselect_b32 exec_lo, s61, -1
s_mov_b32 exec_hi, exec_lo
buffer_load_dwordx4 a[176:179], v1, s[28:31], s57 offen
s_mov_b64 exec, -1
s_waitcnt lgkmcnt(2)
v_mfma_f32_16x16x32_bf16 v[204:207], v[236:239], v[72:75], v[204:207]
ds_read_b128 v[232:235], v12 offset:10240
v_mfma_f32_16x16x32_bf16 v[216:219], v[236:239], v[76:79], v[216:219]
s_add_u32 s47, s47, s46
s_add_u32 s47, s47, 24576
s_add_u32 s57, s101, 45056
s_bitcmp1_b32 s57, 10
s_cselect_b32 exec_lo, s61, -1
s_mov_b32 exec_hi, exec_lo
buffer_load_dwordx4 a[180:183], v1, s[28:31], s57 offen
s_mov_b64 exec, -1
s_waitcnt lgkmcnt(2)
v_mfma_f32_16x16x32_bf16 v[208:211], v[224:227], v[72:75], v[208:211]
ds_read_b128 v[236:239], v12 offset:11264
v_mfma_f32_16x16x32_bf16 v[220:223], v[224:227], v[76:79], v[220:223]
s_add_u32 s57, s100, 47104
s_bitcmp1_b32 s57, 10
s_cselect_b32 exec_lo, s61, -1
s_mov_b32 exec_hi, exec_lo
buffer_load_dwordx4 a[184:187], v1, s[28:31], s57 offen
s_mov_b64 exec, -1
s_waitcnt lgkmcnt(2)
v_mfma_f32_16x16x32_bf16 v[200:203], v[228:231], v[80:83], v[200:203]
ds_read_b128 v[224:227], v12 offset:12288
v_mfma_f32_16x16x32_bf16 v[212:215], v[228:231], v[84:87], v[212:215]
s_waitcnt lgkmcnt(2)
v_mfma_f32_16x16x32_bf16 v[204:207], v[232:235], v[80:83], v[204:207]
ds_read_b128 v[228:231], v12 offset:13312
v_mfma_f32_16x16x32_bf16 v[216:219], v[232:235], v[84:87], v[216:219]
s_add_u32 s57, s101, 47104
s_bitcmp1_b32 s57, 10
s_cselect_b32 exec_lo, s61, -1
s_mov_b32 exec_hi, exec_lo
buffer_load_dwordx4 a[188:191], v1, s[28:31], s57 offen
s_mov_b64 exec, -1
s_waitcnt lgkmcnt(2)
v_mfma_f32_16x16x32_bf16 v[208:211], v[236:239], v[80:83], v[208:211]
ds_read_b128 v[232:235], v12 offset:14336
v_mfma_f32_16x16x32_bf16 v[220:223], v[236:239], v[84:87], v[220:223]
s_add_u32 s57, s100, 49152
s_bitcmp1_b32 s57, 10
s_cselect_b32 exec_lo, s61, -1
s_mov_b32 exec_hi, exec_lo
buffer_load_dwordx4 a[192:195], v1, s[28:31], s57 offen
s_mov_b64 exec, -1
s_waitcnt lgkmcnt(2)
v_mfma_f32_16x16x32_bf16 v[200:203], v[224:227], v[88:91], v[200:203]
ds_read_b128 v[236:239], v12 offset:15360
v_mfma_f32_16x16x32_bf16 v[212:215], v[224:227], v[92:95], v[212:215]
s_waitcnt lgkmcnt(2)
v_mfma_f32_16x16x32_bf16 v[204:207], v[228:231], v[88:91], v[204:207]
ds_read_b128 v[224:227], v12 offset:16384
v_mfma_f32_16x16x32_bf16 v[216:219], v[228:231], v[92:95], v[216:219]
s_add_u32 s57, s101, 49152
s_bitcmp1_b32 s57, 10
s_cselect_b32 exec_lo, s61, -1
s_mov_b32 exec_hi, exec_lo
buffer_load_dwordx4 a[196:199], v1, s[28:31], s57 offen
s_mov_b64 exec, -1
v_mov_b32 v242, s44
v_mov_b32 v243, s45
v_mov_b32 v241, 0
s_mov_b64 exec, 1
s_cmp_eq_u32 s39, 0
s_cbranch_scc1 L_slow_78
s_waitcnt vmcnt(13)
buffer_store_dwordx2 v[242:243], v241, s[28:31], s55 offen
L_stored_79:
s_mov_b64 exec, -1
s_waitcnt lgkmcnt(2)
v_mfma_f32_16x16x32_bf16 v[208:211], v[232:235], v[88:91], v[208:211]
ds_read_b128 v[228:231], v12 offset:17408
v_mfma_f32_16x16x32_bf16 v[220:223], v[232:235], v[92:95], v[220:223]
s_add_u32 s57, s100, 8192
s_bitcmp1_b32 s57, 10
s_cselect_b32 exec_lo, s61, -1
s_mov_b32 exec_hi, exec_lo
buffer_load_dwordx4 a[32:35], v1, s[28:31], s57 offen
s_mov_b64 exec, -1
s_waitcnt lgkmcnt(2)
v_mfma_f32_16x16x32_bf16 v[200:203], v[236:239], v[96:99], v[200:203]
ds_read_b128 v[232:235], v12 offset:18432
v_mfma_f32_16x16x32_bf16 v[212:215], v[236:239], v[100:103], v[212:215]
s_waitcnt lgkmcnt(2)
v_mfma_f32_16x16x32_bf16 v[204:207], v[224:227], v[96:99], v[204:207]
ds_read_b128 v[236:239], v12 offset:19456
v_mfma_f32_16x16x32_bf16 v[216:219], v[224:227], v[100:103], v[216:219]
s_add_u32 s57, s101, 8192
s_bitcmp1_b32 s57, 10
s_cselect_b32 exec_lo, s61, -1
s_mov_b32 exec_hi, exec_lo
buffer_load_dwordx4 a[36:39], v1, s[28:31], s57 offen
s_mov_b64 exec, -1
s_waitcnt lgkmcnt(2)
v_mfma_f32_16x16x32_bf16 v[208:211], v[228:231], v[96:99], v[208:211]
ds_read_b128 v[224:227], v12 offset:20480
v_mfma_f32_16x16x32_bf16 v[220:223], v[228:231], v[100:103], v[220:223]
s_add_u32 s57, s100, 10240
s_bitcmp1_b32 s57, 10
s_cselect_b32 exec_lo, s61, -1
s_mov_b32 exec_hi, exec_lo
buffer_load_dwordx4 a[40:43], v1, s[28:31], s57 offen
s_mov_b64 exec, -1
s_waitcnt lgkmcnt(2)
v_mfma_f32_16x16x32_bf16 v[200:203], v[232:235], v[104:107], v[200:203]
ds_read_b128 v[228:231], v12 offset:21504
v_mfma_f32_16x16x32_bf16 v[212:215], v[232:235], v[108:111], v[212:215]
s_waitcnt lgkmcnt(2)
v_mfma_f32_16x16x32_bf16 v[204:207], v[236:239], v[104:107], v[204:207]
ds_read_b128 v[232:235], v12 offset:22528
v_mfma_f32_16x16x32_bf16 v[216:219], v[236:239], v[108:111], v[216:219]
s_add_u32 s57, s101, 10240
s_bitcmp1_b32 s57, 10
s_cselect_b32 exec_lo, s61, -1
s_mov_b32 exec_hi, exec_lo
buffer_load_dwordx4 a[44:47], v1, s[28:31], s57 offen
s_mov_b64 exec, -1
s_waitcnt lgkmcnt(2)
v_mfma_f32_16x16x32_bf16 v[208:211], v[224:227], v[104:107], v[208:211]
ds_read_b128 v[236:239], v12 offset:23552
v_mfma_f32_16x16x32_bf16 v[220:223], v[224:227], v[108:111], v[220:223]
s_waitcnt lgkmcnt(2)
v_mfma_f32_16x16x32_bf16 v[200:203], v[228:231], v[112:115], v[200:203]
ds_read_b128 v[224:227], v12 offset:24576
v_mfma_f32_16x16x32_bf16 v[212:215], v[228:231], v[116:119], v[212:215]
s_waitcnt lgkmcnt(2)
v_mfma_f32_16x16x32_bf16 v[204:207], v[232:235], v[112:115], v[204:207]
ds_read_b128 v[228:231], v12 offset:25600
v_mfma_f32_16x16x32_bf16 v[216:219], v[232:235], v[116:119], v[216:219]
s_waitcnt lgkmcnt(2)
v_mfma_f32_16x16x32_bf16 v[208:211], v[236:239], v[112:115], v[208:211]
ds_read_b128 v[232:235], v12 offset:26624
v_mfma_f32_16x16x32_bf16 v[220:223], v[236:239], v[116:119], v[220:223]
s_waitcnt lgkmcnt(2)
v_mfma_f32_16x16x32_bf16 v[200:203], v[224:227], v[120:123], v[200:203]
ds_read_b128 v[236:239], v12 offset:27648
v_mfma_f32_16x16x32_bf16 v[212:215], v[224:227], v[124:127], v[212:215]
s_waitcnt lgkmcnt(2)
v_mfma_f32_16x16x32_bf16 v[204:207], v[228:231], v[120:123], v[204:207]
ds_read_b128 v[224:227], v12 offset:28672
v_mfma_f32_16x16x32_bf16 v[216:219], v[228:231], v[124:127], v[216:219]
s_waitcnt lgkmcnt(2)
v_mfma_f32_16x16x32_bf16 v[208:211], v[232:235], v[120:123], v[208:211]
ds_read_b128 v[228:231], v12 offset:29696
v_mfma_f32_16x16x32_bf16 v[220:223], v[232:235], v[124:127], v[220:223]
s_waitcnt lgkmcnt(2)
v_mfma_f32_16x16x32_bf16 v[200:203], v[236:239], v[128:131], v[200:203]
ds_read_b128 v[232:235], v12 offset:30720
v_mfma_f32_16x16x32_bf16 v[212:215], v[236:239], v[132:135], v[212:215]
s_mov_b64 exec, 0xff
buffer_load_dwordx2 v[240:241], v8, s[28:31], s47 offen sc1
s_mov_b64 exec, -1
s_waitcnt lgkmcnt(2)
v_mfma_f32_16x16x32_bf16 v[204:207], v[224:227], v[128:131], v[204:207]
ds_read_b128 v[236:239], v12 offset:31744
v_mfma_f32_16x16x32_bf16 v[216:219], v[224:227], v[132:135], v[216:219]
s_waitcnt lgkmcnt(2)
v_mfma_f32_16x16x32_bf16 v[208:211], v[228:231], v[128:131], v[208:211]
ds_read_b128 v[224:227], v12 offset:32768
v_mfma_f32_16x16x32_bf16 v[220:223], v[228:231], v[132:135], v[220:223]
s_waitcnt lgkmcnt(2)
v_mfma_f32_16x16x32_bf16 v[200:203], v[232:235], v[136:139], v[200:203]
ds_read_b128 v[228:231], v12 offset:33792
v_mfma_f32_16x16x32_bf16 v[212:215], v[232:235], v[140:143], v[212:215]
s_waitcnt lgkmcnt(2)
v_mfma_f32_16x16x32_bf16 v[204:207], v[236:239], v[136:139], v[204:207]
ds_read_b128 v[232:235], v12 offset:34816
v_mfma_f32_16x16x32_bf16 v[216:219], v[236:239], v[140:143], v[216:219]
s_waitcnt lgkmcnt(2)
v_mfma_f32_16x16x32_bf16 v[208:211], v[224:227], v[136:139], v[208:211]
ds_read_b128 v[236:239], v12 offset:35840
v_mfma_f32_16x16x32_bf16 v[220:223], v[224:227], v[140:143], v[220:223]
s_waitcnt lgkmcnt(2)
v_mfma_f32_16x16x32_bf16 v[200:203], v[228:231], v[144:147], v[200:203]
ds_read_b128 v[224:227], v12 offset:36864
v_mfma_f32_16x16x32_bf16 v[212:215], v[228:231], v[148:151], v[212:215]
s_waitcnt lgkmcnt(2)
v_mfma_f32_16x16x32_bf16 v[204:207], v[232:235], v[144:147], v[204:207]
ds_read_b128 v[228:231], v12 offset:37888
v_mfma_f32_16x16x32_bf16 v[216:219], v[232:235], v[148:151], v[216:219]
s_waitcnt lgkmcnt(2)
v_mfma_f32_16x16x32_bf16 v[208:211], v[236:239], v[144:147], v[208:211]
ds_read_b128 v[232:235], v12 offset:38912
v_mfma_f32_16x16x32_bf16 v[220:223], v[236:239], v[148:151], v[220:223]
s_waitcnt lgkmcnt(2)
v_mfma_f32_16x16x32_bf16 v[200:203], v[224:227], v[152:155], v[200:203]
ds_read_b128 v[236:239], v12 offset:39936
v_mfma_f32_16x16x32_bf16 v[212:215], v[224:227], v[156:159], v[212:215]
s_waitcnt lgkmcnt(2)
v_mfma_f32_16x16x32_bf16 v[204:207], v[228:231], v[152:155], v[204:207]
ds_read_b128 v[224:227], v12 offset:40960
v_mfma_f32_16x16x32_bf16 v[216:219], v[228:231], v[156:159], v[216:219]
s_waitcnt vmcnt(0)
s_mov_b64 exec, 0xff
v_cmp_ne_u64 vcc, s[44:45], v[240:241]
s_cbranch_vccnz L_chk_80
L_chkok_81:
s_mov_b64 exec, -1
s_waitcnt lgkmcnt(2)
v_mfma_f32_16x16x32_bf16 v[208:211], v[232:235], v[152:155], v[208:211]
ds_read_b128 v[228:231], v12 offset:41984
s_add_u32 s57, s52, 0
buffer_load_dwordx4 v[120:123], v1, s[28:31], s57 offen offset:0 sc1
v_mfma_f32_16x16x32_bf16 v[220:223], v[232:235], v[156:159], v[220:223]
s_add_u32 s57, s52, 0
buffer_load_dwordx4 v[124:127], v1, s[28:31], s57 offen offset:1024 sc1
s_waitcnt lgkmcnt(2)
v_mfma_f32_16x16x32_bf16 v[200:203], v[236:239], v[160:163], v[200:203]
s_add_u32 s57, s52, 0
buffer_load_dwordx4 v[128:131], v1, s[28:31], s57 offen offset:2048 sc1
v_mfma_f32_16x16x32_bf16 v[212:215], v[236:239], v[164:167], v[212:215]
s_add_u32 s57, s52, 0
buffer_load_dwordx4 v[132:135], v1, s[28:31], s57 offen offset:3072 sc1
s_waitcnt lgkmcnt(1)
v_mfma_f32_16x16x32_bf16 v[204:207], v[224:227], v[160:163], v[204:207]
s_add_u32 s57, s52, 4096
buffer_load_dwordx4 v[136:139], v1, s[28:31], s57 offen offset:3072 sc1
v_mfma_f32_16x16x32_bf16 v[216:219], v[224:227], v[164:167], v[216:219]
s_add_u32 s57, s52, 8192
buffer_load_dwordx4 v[140:143], v1, s[28:31], s57 offen offset:0 sc1
s_waitcnt lgkmcnt(0)
v_mfma_f32_16x16x32_bf16 v[208:211], v[228:231], v[160:163], v[208:211]
s_add_u32 s57, s52, 8192
buffer_load_dwordx4 v[144:147], v1, s[28:31], s57 offen offset:1024 sc1
v_mfma_f32_16x16x32_bf16 v[220:223], v[228:231], v[164:167], v[220:223]
s_add_u32 s57, s52, 8192
buffer_load_dwordx4 v[148:151], v1, s[28:31], s57 offen offset:2048 sc1
s_waitcnt lgkmcnt(0)
v_pk_fma_f32 v[200:201], v[244:245], v[2:3], v[200:201] op_sel_hi:[1,0,1]
v_pk_fma_f32 v[202:203], v[246:247], v[2:3], v[202:203] op_sel_hi:[1,0,1]
v_pk_fma_f32 v[204:205], v[248:249], v[2:3], v[204:205] op_sel_hi:[1,0,1]
v_pk_fma_f32 v[206:207], v[250:251], v[2:3], v[206:207] op_sel_hi:[1,0,1]
v_pk_fma_f32 v[208:209], v[252:253], v[2:3], v[208:209] op_sel_hi:[1,0,1]
v_pk_fma_f32 v[210:211], v[254:255], v[2:3], v[210:211] op_sel_hi:[1,0,1]
v_cvt_pk_bf16_f32 v200, v200, v201
v_cvt_pk_bf16_f32 v201, v202, v203
v_cvt_pk_bf16_f32 v202, v204, v205
v_cvt_pk_bf16_f32 v203, v206, v207
v_cvt_pk_bf16_f32 v204, v208, v209
v_cvt_pk_bf16_f32 v205, v210, v211
v_pk_max_i16 v200, v200, 0
v_pk_max_i16 v201, v201, 0
v_pk_max_i16 v202, v202, 0
v_pk_max_i16 v203, v203, 0
v_pk_max_i16 v204, v204, 0
v_pk_max_i16 v205, v205, 0
v_pk_fma_f32 v[212:213], v[244:245], v[6:7], v[212:213] op_sel_hi:[1,0,1]
v_pk_fma_f32 v[214:215], v[246:247], v[6:7], v[214:215] op_sel_hi:[1,0,1]
v_pk_fma_f32 v[216:217], v[248:249], v[6:7], v[216:217] op_sel_hi:[1,0,1]
v_pk_fma_f32 v[218:219], v[250:251], v[6:7], v[218:219] op_sel_hi:[1,0,1]
v_pk_fma_f32 v[220:221], v[252:253], v[6:7], v[220:221] op_sel_hi:[1,0,1]
v_pk_fma_f32 v[222:223], v[254:255], v[6:7], v[222:223] op_sel_hi:[1,0,1]
v_cvt_pk_bf16_f32 v212, v212, v213
v_cvt_pk_bf16_f32 v213, v214, v215
v_cvt_pk_bf16_f32 v214, v216, v217
v_cvt_pk_bf16_f32 v215, v218, v219
v_cvt_pk_bf16_f32 v216, v220, v221
v_cvt_pk_bf16_f32 v217, v222, v223
v_pk_max_i16 v212, v212, 0
v_pk_max_i16 v213, v213, 0
v_pk_max_i16 v214, v214, 0
v_pk_max_i16 v215, v215, 0
v_pk_max_i16 v216, v216, 0
v_pk_max_i16 v217, v217, 0
buffer_store_dwordx4 v[200:203], v10, s[28:31], s51 offen offset:0 sc1
buffer_store_dwordx2 v[204:205], v11, s[28:31], s51 offen offset:2048 sc1
buffer_store_dwordx4 v[212:215], v10, s[28:31], s51 offen offset:256 sc1
buffer_store_dwordx2 v[216:217], v11, s[28:31], s51 offen offset:2304 sc1
s_add_u32 s56, s55, 16384
s_mov_b32 s96, s51
s_barrier
ds_read_b32 v13, v9
s_add_u32 s57, s52, 12288
buffer_load_dwordx4 v[152:155], v1, s[28:31], s57 offen offset:2048 sc1
s_add_u32 s57, s52, 12288
buffer_load_dwordx4 v[156:159], v1, s[28:31], s57 offen offset:3072 sc1
v_and_b32 v7, 31, v0
v_lshrrev_b32 v4, 5, v0
s_mul_i32 s3, s41, 7
s_lshl_b32 s48, s99, 2
s_add_u32 s3, s3, s48
v_lshlrev_b32 v5, 4, v7
v_lshl_add_u32 v5, v4, 3, v5
s_lshl_b32 s3, s3, 9
s_mul_i32 s48, s98, 28672
s_add_u32 s3, s3, s48
s_add_u32 s3, s3, 2883584
v_lshlrev_b32 v7, 4, v7
s_lshl_b32 s43, s98, 12
s_lshl_b32 s49, s41, 9
s_add_u32 s43, s43, s49
s_lshl_b32 s49, s99, 3
s_add_u32 s43, s43, s49
s_add_u32 s43, s43, 327680
s_lshl_b32 s55, s98, 7
s_lshl_b32 s48, s41, 4
s_add_u32 s55, s55, s48
s_add_u32 s55, s55, s49
s_add_u32 s55, s55, 32768
s_mul_i32 s48, s38, 12288
s_add_u32 s48, s48, 107520
v_add_u32 v8, s48, v1
s_sub_u32 s50, s99, 1
s_mov_b32 s51, s50
v_and_b32 v9, 3, v0
v_lshlrev_b32 v9, 3, v9
v_bfe_u32 v3, v0, 2, 1
v_lshl_add_u32 v9, v3, 7, v9
s_andn2_b32 s47, s98, 1
s_lshl_b32 s47, s47, 7
s_lshl_b32 s48, s38, 5
s_add_u32 s47, s47, s48
s_waitcnt vmcnt(13)
v_mfma_f32_32x32x16_bf16 v[88:103], a[0:3], v[120:123], 0
s_add_u32 s57, s52, 16384
buffer_load_dwordx4 v[160:163], v1, s[28:31], s57 offen offset:0 sc1
v_mfma_f32_32x32x16_bf16 v[104:119], a[4:7], v[120:123], 0
s_mul_i32 s100, s41, 229376
s_mul_i32 s48, s38, 57344
s_add_u32 s100, s100, s48
s_add_u32 s100, s100, 22282240
s_lshl_b32 s48, s99, 10
s_add_u32 s101, s100, 1024
s_add_u32 s100, s100, s48
s_sub_u32 s101, s101, s48
s_add_u32 s57, s100, 12288
s_bitcmp1_b32 s57, 10
s_cselect_b32 exec_lo, s61, -1
s_mov_b32 exec_hi, exec_lo
buffer_load_dwordx4 a[48:51], v1, s[28:31], s57 offen
s_mov_b64 exec, -1
s_waitcnt vmcnt(14)
v_mfma_f32_32x32x16_bf16 v[88:103], a[8:11], v[124:127], v[88:103]
s_add_u32 s57, s52, 16384
buffer_load_dwordx4 v[164:167], v1, s[28:31], s57 offen offset:1024 sc1
v_mfma_f32_32x32x16_bf16 v[104:119], a[12:15], v[124:127], v[104:119]
s_add_u32 s57, s101, 12288
s_bitcmp1_b32 s57, 10
s_cselect_b32 exec_lo, s61, -1
s_mov_b32 exec_hi, exec_lo
buffer_load_dwordx4 a[52:55], v1, s[28:31], s57 offen
s_mov_b64 exec, -1
s_waitcnt vmcnt(15)
v_mfma_f32_32x32x16_bf16 v[88:103], a[16:19], v[128:131], v[88:103]
s_add_u32 s57, s52, 20480
buffer_load_dwordx4 v[168:171], v1, s[28:31], s57 offen offset:1024 sc1
v_mfma_f32_32x32x16_bf16 v[104:119], a[20:23], v[128:131], v[104:119]
s_add_u32 s57, s100, 22528
s_bitcmp1_b32 s57, 10
s_cselect_b32 exec_lo, s61, -1
s_mov_b32 exec_hi, exec_lo
buffer_load_dwordx4 a[88:91], v1, s[28:31], s57 offen
s_mov_b64 exec, -1
s_waitcnt vmcnt(16)
v_mfma_f32_32x32x16_bf16 v[88:103], a[24:27], v[132:135], v[88:103]
s_add_u32 s57, s52, 20480
buffer_load_dwordx4 v[172:175], v1, s[28:31], s57 offen offset:2048 sc1
v_mfma_f32_32x32x16_bf16 v[104:119], a[28:31], v[132:135], v[104:119]
s_add_u32 s57, s101, 22528
s_bitcmp1_b32 s57, 10
s_cselect_b32 exec_lo, s61, -1
s_mov_b32 exec_hi, exec_lo
buffer_load_dwordx4 a[92:95], v1, s[28:31], s57 offen
s_mov_b64 exec, -1
s_waitcnt vmcnt(17)
v_mov_b32 v2, s44
v_mov_b32 v3, s45
v_mov_b32 v4, 0
s_mov_b64 exec, 1
s_cmp_eq_u32 s39, 0
s_cbranch_scc1 L_slow_82
s_waitcnt vmcnt(10)
buffer_store_dwordx2 v[2:3], v4, s[28:31], s56 offen
L_stored_83:
s_mov_b64 exec, -1
v_mfma_f32_32x32x16_bf16 v[88:103], a[56:59], v[136:139], v[88:103]
s_add_u32 s57, s52, 20480
buffer_load_dwordx4 v[176:179], v1, s[28:31], s57 offen offset:3072 sc1
v_mfma_f32_32x32x16_bf16 v[104:119], a[60:63], v[136:139], v[104:119]
s_add_u32 s57, s100, 24576
s_bitcmp1_b32 s57, 10
s_cselect_b32 exec_lo, s61, -1
s_mov_b32 exec_hi, exec_lo
buffer_load_dwordx4 a[96:99], v1, s[28:31], s57 offen
s_mov_b64 exec, -1
v_mfma_f32_32x32x16_bf16 v[88:103], a[64:67], v[140:143], v[88:103]
s_add_u32 s57, s52, 24576
buffer_load_dwordx4 v[180:183], v1, s[28:31], s57 offen offset:0 sc1
v_mfma_f32_32x32x16_bf16 v[104:119], a[68:71], v[140:143], v[104:119]
s_add_u32 s57, s101, 24576
s_bitcmp1_b32 s57, 10
s_cselect_b32 exec_lo, s61, -1
s_mov_b32 exec_hi, exec_lo
buffer_load_dwordx4 a[100:103], v1, s[28:31], s57 offen
s_mov_b64 exec, -1
v_mfma_f32_32x32x16_bf16 v[88:103], a[72:75], v[144:147], v[88:103]
s_add_u32 s57, s53, 0
buffer_load_dwordx4 v[120:123], v1, s[28:31], s57 offen offset:0 sc1
v_mfma_f32_32x32x16_bf16 v[104:119], a[76:79], v[144:147], v[104:119]
s_add_u32 s57, s100, 26624
s_bitcmp1_b32 s57, 10
s_cselect_b32 exec_lo, s61, -1
s_mov_b32 exec_hi, exec_lo
buffer_load_dwordx4 a[104:107], v1, s[28:31], s57 offen
s_mov_b64 exec, -1
v_mfma_f32_32x32x16_bf16 v[88:103], a[80:83], v[148:151], v[88:103]
s_add_u32 s57, s53, 0
buffer_load_dwordx4 v[124:127], v1, s[28:31], s57 offen offset:1024 sc1
v_mfma_f32_32x32x16_bf16 v[104:119], a[84:87], v[148:151], v[104:119]
s_add_u32 s57, s101, 26624
s_bitcmp1_b32 s57, 10
s_cselect_b32 exec_lo, s61, -1
s_mov_b32 exec_hi, exec_lo
buffer_load_dwordx4 a[108:111], v1, s[28:31], s57 offen
s_mov_b64 exec, -1
s_waitcnt vmcnt(18)
v_mfma_f32_32x32x16_bf16 v[88:103], a[112:115], v[152:155], v[88:103]
s_add_u32 s57, s53, 0
buffer_load_dwordx4 v[128:131], v1, s[28:31], s57 offen offset:2048 sc1
v_mfma_f32_32x32x16_bf16 v[104:119], a[116:119], v[152:155], v[104:119]
s_add_u32 s57, s100, 36864
s_bitcmp1_b32 s57, 10
s_cselect_b32 exec_lo, s61, -1
s_mov_b32 exec_hi, exec_lo
buffer_load_dwordx4 a[144:147], v1, s[28:31], s57 offen
s_mov_b64 exec, -1
s_waitcnt vmcnt(19)
v_mfma_f32_32x32x16_bf16 v[88:103], a[120:123], v[156:159], v[88:103]
s_add_u32 s57, s53, 0
buffer_load_dwordx4 v[132:135], v1, s[28:31], s57 offen offset:3072 sc1
v_mfma_f32_32x32x16_bf16 v[104:119], a[124:127], v[156:159], v[104:119]
s_add_u32 s57, s101, 36864
s_bitcmp1_b32 s57, 10
s_cselect_b32 exec_lo, s61, -1
s_mov_b32 exec_hi, exec_lo
buffer_load_dwordx4 a[148:151], v1, s[28:31], s57 offen
s_mov_b64 exec, -1
s_waitcnt vmcnt(20)
v_mfma_f32_32x32x16_bf16 v[88:103], a[128:131], v[160:163], v[88:103]
s_add_u32 s57, s53, 4096
buffer_load_dwordx4 v[136:139], v1, s[28:31], s57 offen offset:3072 sc1
v_mfma_f32_32x32x16_bf16 v[104:119], a[132:135], v[160:163], v[104:119]
s_add_u32 s57, s100, 38912
s_bitcmp1_b32 s57, 10
s_cselect_b32 exec_lo, s61, -1
s_mov_b32 exec_hi, exec_lo
buffer_load_dwordx4 a[152:155], v1, s[28:31], s57 offen
s_mov_b64 exec, -1
s_waitcnt vmcnt(20)
v_mfma_f32_32x32x16_bf16 v[88:103], a[136:139], v[164:167], v[88:103]
s_add_u32 s57, s53, 8192
buffer_load_dwordx4 v[140:143], v1, s[28:31], s57 offen offset:0 sc1
v_mfma_f32_32x32x16_bf16 v[104:119], a[140:143], v[164:167], v[104:119]
s_add_u32 s57, s101, 38912
s_bitcmp1_b32 s57, 10
s_cselect_b32 exec_lo, s61, -1
s_mov_b32 exec_hi, exec_lo
buffer_load_dwordx4 a[156:159], v1, s[28:31], s57 offen
s_mov_b64 exec, -1
s_waitcnt vmcnt(20)
v_mfma_f32_32x32x16_bf16 v[88:103], a[168:171], v[168:171], v[88:103]
s_add_u32 s57, s53, 8192
buffer_load_dwordx4 v[144:147], v1, s[28:31], s57 offen offset:1024 sc1
v_mfma_f32_32x32x16_bf16 v[104:119], a[172:175], v[168:171], v[104:119]
s_add_u32 s57, s100, 40960
s_bitcmp1_b32 s57, 10
s_cselect_b32 exec_lo, s61, -1
s_mov_b32 exec_hi, exec_lo
buffer_load_dwordx4 a[160:163], v1, s[28:31], s57 offen
s_mov_b64 exec, -1
s_waitcnt vmcnt(20)
v_mfma_f32_32x32x16_bf16 v[88:103], a[176:179], v[172:175], v[88:103]
s_add_u32 s57, s53, 8192
buffer_load_dwordx4 v[148:151], v1, s[28:31], s57 offen offset:2048 sc1
v_mfma_f32_32x32x16_bf16 v[104:119], a[180:183], v[172:175], v[104:119]
s_add_u32 s57, s101, 40960
s_bitcmp1_b32 s57, 10
s_cselect_b32 exec_lo, s61, -1
s_mov_b32 exec_hi, exec_lo
buffer_load_dwordx4 a[164:167], v1, s[28:31], s57 offen
s_mov_b64 exec, -1
s_waitcnt vmcnt(19)
v_mfma_f32_32x32x16_bf16 v[88:103], a[184:187], v[176:179], v[88:103]
s_add_u32 s57, s53, 12288
buffer_load_dwordx4 v[152:155], v1, s[28:31], s57 offen offset:2048 sc1
v_mfma_f32_32x32x16_bf16 v[104:119], a[188:191], v[176:179], v[104:119]
s_add_u32 s57, s100, 51200
s_bitcmp1_b32 s57, 10
s_cselect_b32 exec_lo, s61, -1
s_mov_b32 exec_hi, exec_lo
buffer_load_dwordx4 a[200:203], v1, s[28:31], s57 offen
s_mov_b64 exec, -1
s_waitcnt vmcnt(19)
v_mfma_f32_32x32x16_bf16 v[88:103], a[192:195], v[180:183], v[88:103]
s_add_u32 s57, s53, 12288
buffer_load_dwordx4 v[156:159], v1, s[28:31], s57 offen offset:3072 sc1
v_mfma_f32_32x32x16_bf16 v[104:119], a[196:199], v[180:183], v[104:119]
s_add_u32 s57, s101, 51200
s_bitcmp1_b32 s57, 10
s_cselect_b32 exec_lo, s61, -1
s_mov_b32 exec_hi, exec_lo
buffer_load_dwordx4 a[204:207], v1, s[28:31], s57 offen
s_mov_b64 exec, -1
s_waitcnt vmcnt(19)
v_mfma_f32_32x32x16_bf16 v[56:71], a[0:3], v[120:123], 0
s_add_u32 s57, s53, 16384
buffer_load_dwordx4 v[160:163], v1, s[28:31], s57 offen offset:0 sc1
s_add_u32 s47, s47, 40960
s_mov_b64 exec, 0xff
buffer_load_dwordx2 v[10:11], v9, s[28:31], s47 offen sc1
s_mov_b64 exec, -1
v_mfma_f32_32x32x16_bf16 v[72:87], a[4:7], v[120:123], 0
s_add_u32 s57, s100, 53248
s_bitcmp1_b32 s57, 10
s_cselect_b32 exec_lo, s61, -1
s_mov_b32 exec_hi, exec_lo
buffer_load_dwordx4 a[208:211], v1, s[28:31], s57 offen
s_mov_b64 exec, -1
s_waitcnt vmcnt(20)
v_mfma_f32_32x32x16_bf16 v[56:71], a[8:11], v[124:127], v[56:71]
s_add_u32 s57, s53, 16384
buffer_load_dwordx4 v[164:167], v1, s[28:31], s57 offen offset:1024 sc1
v_mfma_f32_32x32x16_bf16 v[72:87], a[12:15], v[124:127], v[72:87]
s_add_u32 s57, s101, 53248
s_bitcmp1_b32 s57, 10
s_cselect_b32 exec_lo, s61, -1
s_mov_b32 exec_hi, exec_lo
buffer_load_dwordx4 a[212:215], v1, s[28:31], s57 offen
s_mov_b64 exec, -1
s_waitcnt vmcnt(20)
v_mfma_f32_32x32x16_bf16 v[56:71], a[16:19], v[128:131], v[56:71]
s_add_u32 s57, s53, 20480
buffer_load_dwordx4 v[168:171], v1, s[28:31], s57 offen offset:1024 sc1
v_mfma_f32_32x32x16_bf16 v[72:87], a[20:23], v[128:131], v[72:87]
s_add_u32 s57, s100, 55296
s_bitcmp1_b32 s57, 10
s_cselect_b32 exec_lo, s61, -1
s_mov_b32 exec_hi, exec_lo
buffer_load_dwordx4 a[216:219], v1, s[28:31], s57 offen
s_mov_b64 exec, -1
s_waitcnt vmcnt(20)
v_mfma_f32_32x32x16_bf16 v[56:71], a[24:27], v[132:135], v[56:71]
s_add_u32 s57, s53, 20480
buffer_load_dwordx4 v[172:175], v1, s[28:31], s57 offen offset:2048 sc1
v_mfma_f32_32x32x16_bf16 v[72:87], a[28:31], v[132:135], v[72:87]
s_add_u32 s57, s101, 55296
s_bitcmp1_b32 s57, 10
s_cselect_b32 exec_lo, s61, -1
s_mov_b32 exec_hi, exec_lo
buffer_load_dwordx4 a[220:223], v1, s[28:31], s57 offen
s_mov_b64 exec, -1
s_waitcnt vmcnt(20)
v_mfma_f32_32x32x16_bf16 v[56:71], a[56:59], v[136:139], v[56:71]
s_add_u32 s57, s53, 20480
buffer_load_dwordx4 v[176:179], v1, s[28:31], s57 offen offset:3072 sc1
v_mfma_f32_32x32x16_bf16 v[72:87], a[60:63], v[136:139], v[72:87]
s_waitcnt vmcnt(19)
v_mfma_f32_32x32x16_bf16 v[56:71], a[64:67], v[140:143], v[56:71]
s_add_u32 s57, s53, 24576
buffer_load_dwordx4 v[180:183], v1, s[28:31], s57 offen offset:0 sc1
v_mfma_f32_32x32x16_bf16 v[72:87], a[68:71], v[140:143], v[72:87]
s_waitcnt vmcnt(18)
v_mfma_f32_32x32x16_bf16 v[56:71], a[72:75], v[144:147], v[56:71]
s_waitcnt vmcnt(9)
s_mov_b64 exec, 0xff
v_cmp_ne_u64 vcc, s[44:45], v[10:11]
s_cbranch_vccnz L_chk_84
L_chkok_85:
s_mov_b64 exec, -1
s_add_u32 s57, s52, 4096
buffer_load_dwordx4 v[120:123], v1, s[28:31], s57 offen offset:0 sc1
v_mfma_f32_32x32x16_bf16 v[72:87], a[76:79], v[144:147], v[72:87]
v_mfma_f32_32x32x16_bf16 v[56:71], a[80:83], v[148:151], v[56:71]
s_add_u32 s57, s52, 4096
buffer_load_dwordx4 v[124:127], v1, s[28:31], s57 offen offset:1024 sc1
v_mfma_f32_32x32x16_bf16 v[72:87], a[84:87], v[148:151], v[72:87]
v_mfma_f32_32x32x16_bf16 v[56:71], a[112:115], v[152:155], v[56:71]
s_add_u32 s57, s52, 4096
buffer_load_dwordx4 v[128:131], v1, s[28:31], s57 offen offset:2048 sc1
v_mfma_f32_32x32x16_bf16 v[72:87], a[116:119], v[152:155], v[72:87]
v_mfma_f32_32x32x16_bf16 v[56:71], a[120:123], v[156:159], v[56:71]
s_add_u32 s57, s52, 8192
buffer_load_dwordx4 v[132:135], v1, s[28:31], s57 offen offset:3072 sc1
v_mfma_f32_32x32x16_bf16 v[72:87], a[124:127], v[156:159], v[72:87]
v_mfma_f32_32x32x16_bf16 v[56:71], a[128:131], v[160:163], v[56:71]
s_add_u32 s57, s52, 12288
buffer_load_dwordx4 v[136:139], v1, s[28:31], s57 offen offset:0 sc1
v_mfma_f32_32x32x16_bf16 v[72:87], a[132:135], v[160:163], v[72:87]
s_waitcnt vmcnt(12)
v_mfma_f32_32x32x16_bf16 v[56:71], a[136:139], v[164:167], v[56:71]
s_add_u32 s57, s52, 12288
buffer_load_dwordx4 v[140:143], v1, s[28:31], s57 offen offset:1024 sc1
v_mfma_f32_32x32x16_bf16 v[72:87], a[140:143], v[164:167], v[72:87]
s_waitcnt vmcnt(11)
v_mfma_f32_32x32x16_bf16 v[56:71], a[168:171], v[168:171], v[56:71]
s_add_u32 s57, s52, 16384
buffer_load_dwordx4 v[144:147], v1, s[28:31], s57 offen offset:2048 sc1
v_mfma_f32_32x32x16_bf16 v[72:87], a[172:175], v[168:171], v[72:87]
s_waitcnt vmcnt(10)
v_mfma_f32_32x32x16_bf16 v[56:71], a[176:179], v[172:175], v[56:71]
s_add_u32 s57, s52, 16384
buffer_load_dwordx4 v[148:151], v1, s[28:31], s57 offen offset:3072 sc1
v_mfma_f32_32x32x16_bf16 v[72:87], a[180:183], v[172:175], v[72:87]
s_waitcnt vmcnt(9)
v_mfma_f32_32x32x16_bf16 v[56:71], a[184:187], v[176:179], v[56:71]
s_add_u32 s57, s52, 20480
buffer_load_dwordx4 v[152:155], v1, s[28:31], s57 offen offset:0 sc1
v_mfma_f32_32x32x16_bf16 v[72:87], a[188:191], v[176:179], v[72:87]
s_waitcnt vmcnt(9)
v_mfma_f32_32x32x16_bf16 v[56:71], a[192:195], v[180:183], v[56:71]
s_add_u32 s57, s52, 24576
buffer_load_dwordx4 v[156:159], v1, s[28:31], s57 offen offset:1024 sc1
v_mfma_f32_32x32x16_bf16 v[72:87], a[196:199], v[180:183], v[72:87]
s_waitcnt vmcnt(9)
v_mfma_f32_32x32x16_bf16 v[88:103], a[32:35], v[120:123], v[88:103]
s_add_u32 s57, s52, 24576
buffer_load_dwordx4 v[160:163], v1, s[28:31], s57 offen offset:2048 sc1
v_mfma_f32_32x32x16_bf16 v[104:119], a[36:39], v[120:123], v[104:119]
s_waitcnt vmcnt(9)
v_mfma_f32_32x32x16_bf16 v[88:103], a[40:43], v[124:127], v[88:103]
s_add_u32 s57, s52, 24576
buffer_load_dwordx4 v[164:167], v1, s[28:31], s57 offen offset:3072 sc1
v_mfma_f32_32x32x16_bf16 v[104:119], a[44:47], v[124:127], v[104:119]
s_waitcnt vmcnt(9)
v_mfma_f32_32x32x16_bf16 v[88:103], a[48:51], v[128:131], v[88:103]
s_add_u32 s57, s53, 4096
buffer_load_dwordx4 v[168:171], v1, s[28:31], s57 offen offset:0 sc1
v_mfma_f32_32x32x16_bf16 v[104:119], a[52:55], v[128:131], v[104:119]
s_waitcnt vmcnt(9)
v_mfma_f32_32x32x16_bf16 v[88:103], a[88:91], v[132:135], v[88:103]
s_add_u32 s57, s53, 4096
buffer_load_dwordx4 v[172:175], v1, s[28:31], s57 offen offset:1024 sc1
v_mfma_f32_32x32x16_bf16 v[104:119], a[92:95], v[132:135], v[104:119]
s_waitcnt vmcnt(9)
v_mfma_f32_32x32x16_bf16 v[88:103], a[96:99], v[136:139], v[88:103]
s_add_u32 s57, s53, 4096
buffer_load_dwordx4 v[176:179], v1, s[28:31], s57 offen offset:2048 sc1
v_mfma_f32_32x32x16_bf16 v[104:119], a[100:103], v[136:139], v[104:119]
s_waitcnt vmcnt(9)
v_mfma_f32_32x32x16_bf16 v[88:103], a[104:107], v[140:143], v[88:103]
s_add_u32 s57, s53, 8192
buffer_load_dwordx4 v[180:183], v1, s[28:31], s57 offen offset:3072 sc1
v_mfma_f32_32x32x16_bf16 v[104:119], a[108:111], v[140:143], v[104:119]
s_waitcnt vmcnt(9)
v_mfma_f32_32x32x16_bf16 v[88:103], a[144:147], v[144:147], v[88:103]
s_add_u32 s57, s53, 12288
buffer_load_dwordx4 v[120:123], v1, s[28:31], s57 offen offset:0 sc1
v_mfma_f32_32x32x16_bf16 v[104:119], a[148:151], v[144:147], v[104:119]
s_waitcnt vmcnt(9)
v_mfma_f32_32x32x16_bf16 v[88:103], a[152:155], v[148:151], v[88:103]
s_add_u32 s57, s53, 12288
buffer_load_dwordx4 v[124:127], v1, s[28:31], s57 offen offset:1024 sc1
v_mfma_f32_32x32x16_bf16 v[104:119], a[156:159], v[148:151], v[104:119]
s_waitcnt vmcnt(9)
v_mfma_f32_32x32x16_bf16 v[88:103], a[160:163], v[152:155], v[88:103]
s_add_u32 s57, s53, 16384
buffer_load_dwordx4 v[128:131], v1, s[28:31], s57 offen offset:2048 sc1
v_mfma_f32_32x32x16_bf16 v[104:119], a[164:167], v[152:155], v[104:119]
s_waitcnt vmcnt(9)
v_mfma_f32_32x32x16_bf16 v[88:103], a[200:203], v[156:159], v[88:103]
s_add_u32 s57, s53, 16384
buffer_load_dwordx4 v[132:135], v1, s[28:31], s57 offen offset:3072 sc1
v_mfma_f32_32x32x16_bf16 v[104:119], a[204:207], v[156:159], v[104:119]
s_waitcnt vmcnt(9)
v_mfma_f32_32x32x16_bf16 v[88:103], a[208:211], v[160:163], v[88:103]
s_add_u32 s57, s53, 20480
buffer_load_dwordx4 v[136:139], v1, s[28:31], s57 offen offset:0 sc1
v_mfma_f32_32x32x16_bf16 v[104:119], a[212:215], v[160:163], v[104:119]
s_waitcnt vmcnt(9)
v_mfma_f32_32x32x16_bf16 v[88:103], a[216:219], v[164:167], v[88:103]
s_add_u32 s57, s53, 24576
buffer_load_dwordx4 v[140:143], v1, s[28:31], s57 offen offset:1024 sc1
v_mfma_f32_32x32x16_bf16 v[104:119], a[220:223], v[164:167], v[104:119]
s_waitcnt vmcnt(9)
s_xor_b32 s46, s38, 2
s_mul_i32 s46, s46, 12288
s_add_u32 s46, s46, 111616
v_add_u32 v2, s46, v1
v_mfma_f32_32x32x16_bf16 v[56:71], a[32:35], v[168:171], v[56:71]
s_add_u32 s57, s53, 24576
buffer_load_dwordx4 v[144:147], v1, s[28:31], s57 offen offset:2048 sc1
s_nop 0
ds_write_b128 v2, v[88:91] offset:0
ds_write_b128 v2, v[92:95] offset:1024
v_mfma_f32_32x32x16_bf16 v[72:87], a[36:39], v[168:171], v[72:87]
ds_write_b128 v2, v[96:99] offset:2048
ds_write_b128 v2, v[100:103] offset:3072
s_waitcnt vmcnt(9)
s_xor_b32 s46, s38, 3
s_mul_i32 s46, s46, 12288
s_add_u32 s46, s46, 115712
v_add_u32 v2, s46, v1
v_mfma_f32_32x32x16_bf16 v[56:71], a[40:43], v[172:175], v[56:71]
s_add_u32 s57, s53, 24576
buffer_load_dwordx4 v[148:151], v1, s[28:31], s57 offen offset:3072 sc1
ds_write_b128 v2, v[104:107] offset:0
ds_write_b128 v2, v[108:111] offset:1024
v_mfma_f32_32x32x16_bf16 v[72:87], a[44:47], v[172:175], v[72:87]
ds_write_b128 v2, v[112:115] offset:2048
ds_write_b128 v2, v[116:119] offset:3072
s_waitcnt vmcnt(9)
v_mfma_f32_32x32x16_bf16 v[56:71], a[48:51], v[176:179], v[56:71]
s_waitcnt lgkmcnt(0)
s_barrier
ds_read_b128 v[184:187], v8 offset:4096
ds_read_b128 v[188:191], v8 offset:5120
ds_read_b128 v[192:195], v8 offset:6144
v_mfma_f32_32x32x16_bf16 v[72:87], a[52:55], v[176:179], v[72:87]
ds_read_b128 v[196:199], v8 offset:7168
ds_read_b128 v[200:203], v8 offset:8192
ds_read_b128 v[204:207], v8 offset:9216
ds_read_b128 v[208:211], v8 offset:10240
ds_read_b128 v[212:215], v8 offset:11264
s_waitcnt vmcnt(8)
v_mfma_f32_32x32x16_bf16 v[56:71], a[88:91], v[180:183], v[56:71]
v_mfma_f32_32x32x16_bf16 v[72:87], a[92:95], v[180:183], v[72:87]
s_waitcnt vmcnt(7)
v_mfma_f32_32x32x16_bf16 v[56:71], a[96:99], v[120:123], v[56:71]
s_waitcnt lgkmcnt(0)
v_add_f32 v184, v184, v200
v_add_f32 v185, v185, v201
v_add_f32 v186, v186, v202
v_add_f32 v187, v187, v203
v_mfma_f32_32x32x16_bf16 v[72:87], a[100:103], v[120:123], v[72:87]
v_add_f32 v188, v188, v204
v_add_f32 v189, v189, v205
v_add_f32 v190, v190, v206
v_add_f32 v191, v191, v207
s_waitcnt vmcnt(6)
v_mfma_f32_32x32x16_bf16 v[56:71], a[104:107], v[124:127], v[56:71]
v_add_f32 v192, v192, v208
v_add_f32 v193, v193, v209
v_add_f32 v194, v194, v210
v_add_f32 v195, v195, v211
v_mfma_f32_32x32x16_bf16 v[72:87], a[108:111], v[124:127], v[72:87]
v_add_f32 v196, v196, v212
v_add_f32 v197, v197, v213
v_add_f32 v198, v198, v214
v_add_f32 v199, v199, v215
s_waitcnt vmcnt(5)
v_mfma_f32_32x32x16_bf16 v[56:71], a[144:147], v[128:131], v[56:71]
v_mfma_f32_32x32x16_bf16 v[72:87], a[148:151], v[128:131], v[72:87]
s_waitcnt vmcnt(4)
v_mfma_f32_32x32x16_bf16 v[56:71], a[152:155], v[132:135], v[56:71]
v_mfma_f32_32x32x16_bf16 v[72:87], a[156:159], v[132:135], v[72:87]
s_waitcnt vmcnt(3)
v_mfma_f32_32x32x16_bf16 v[56:71], a[160:163], v[136:139], v[56:71]
v_mfma_f32_32x32x16_bf16 v[72:87], a[164:167], v[136:139], v[72:87]
s_waitcnt vmcnt(2)
v_mfma_f32_32x32x16_bf16 v[56:71], a[200:203], v[140:143], v[56:71]
v_mfma_f32_32x32x16_bf16 v[72:87], a[204:207], v[140:143], v[72:87]
s_waitcnt vmcnt(1)
v_mfma_f32_32x32x16_bf16 v[56:71], a[208:211], v[144:147], v[56:71]
v_mfma_f32_32x32x16_bf16 v[72:87], a[212:215], v[144:147], v[72:87]
s_waitcnt vmcnt(0)
s_xor_b32 s46, s38, 1
s_mul_i32 s46, s46, 12288
s_add_u32 s46, s46, 107520
v_add_u32 v2, s46, v1
v_mfma_f32_32x32x16_bf16 v[72:87], a[220:223], v[148:151], v[72:87]
v_mfma_f32_32x32x16_bf16 v[56:71], a[216:219], v[148:151], v[56:71]
s_nop 10
ds_write_b128 v2, v[72:75] offset:0
ds_write_b128 v2, v[76:79] offset:1024
ds_write_b128 v2, v[80:83] offset:2048
ds_write_b128 v2, v[84:87] offset:3072
v_pk_add_f32 v[56:57], v[56:57], v[184:185]
v_pk_add_f32 v[58:59], v[58:59], v[186:187]
v_pk_add_f32 v[60:61], v[60:61], v[188:189]
v_pk_add_f32 v[62:63], v[62:63], v[190:191]
v_pk_add_f32 v[64:65], v[64:65], v[192:193]
v_pk_add_f32 v[66:67], v[66:67], v[194:195]
v_pk_add_f32 v[68:69], v[68:69], v[196:197]
v_pk_add_f32 v[70:71], v[70:71], v[198:199]
s_waitcnt lgkmcnt(0)
s_barrier
ds_read_b128 v[184:187], v8 offset:0
ds_read_b128 v[188:191], v8 offset:1024
ds_read_b128 v[192:195], v8 offset:2048
ds_read_b128 v[196:199], v8 offset:3072
v_pk_fma_f32 v[56:57], v[56:57], v[12:13], v[16:17] op_sel:[0,1,0] op_sel_hi:[1,1,1]
v_pk_fma_f32 v[58:59], v[58:59], v[12:13], v[18:19] op_sel:[0,1,0] op_sel_hi:[1,1,1]
v_pk_fma_f32 v[60:61], v[60:61], v[12:13], v[20:21] op_sel:[0,1,0] op_sel_hi:[1,1,1]
v_pk_fma_f32 v[62:63], v[62:63], v[12:13], v[22:23] op_sel:[0,1,0] op_sel_hi:[1,1,1]
v_pk_fma_f32 v[64:65], v[64:65], v[12:13], v[24:25] op_sel:[0,1,0] op_sel_hi:[1,1,1]
v_pk_fma_f32 v[66:67], v[66:67], v[12:13], v[26:27] op_sel:[0,1,0] op_sel_hi:[1,1,1]
v_pk_fma_f32 v[68:69], v[68:69], v[12:13], v[28:29] op_sel:[0,1,0] op_sel_hi:[1,1,1]
v_pk_fma_f32 v[70:71], v[70:71], v[12:13], v[30:31] op_sel:[0,1,0] op_sel_hi:[1,1,1]
s_waitcnt lgkmcnt(3)
v_pk_fma_f32 v[56:57], v[184:185], v[12:13], v[56:57] op_sel:[0,1,0] op_sel_hi:[1,1,1]
v_pk_fma_f32 v[58:59], v[186:187], v[12:13], v[58:59] op_sel:[0,1,0] op_sel_hi:[1,1,1]
v_cvt_pk_bf16_f32 v88, v56, v57
v_cvt_pk_bf16_f32 v89, v58, v59
s_waitcnt lgkmcnt(2)
v_pk_fma_f32 v[60:61], v[188:189], v[12:13], v[60:61] op_sel:[0,1,0] op_sel_hi:[1,1,1]
v_pk_fma_f32 v[62:63], v[190:191], v[12:13], v[62:63] op_sel:[0,1,0] op_sel_hi:[1,1,1]
v_cvt_pk_bf16_f32 v90, v60, v61
v_cvt_pk_bf16_f32 v91, v62, v63
s_waitcnt lgkmcnt(1)
v_pk_fma_f32 v[64:65], v[192:193], v[12:13], v[64:65] op_sel:[0,1,0] op_sel_hi:[1,1,1]
v_pk_fma_f32 v[66:67], v[194:195], v[12:13], v[66:67] op_sel:[0,1,0] op_sel_hi:[1,1,1]
v_cvt_pk_bf16_f32 v92, v64, v65
v_cvt_pk_bf16_f32 v93, v66, v67
s_waitcnt lgkmcnt(0)
v_pk_fma_f32 v[68:69], v[196:197], v[12:13], v[68:69] op_sel:[0,1,0] op_sel_hi:[1,1,1]
v_pk_fma_f32 v[70:71], v[198:199], v[12:13], v[70:71] op_sel:[0,1,0] op_sel_hi:[1,1,1]
v_cvt_pk_bf16_f32 v94, v68, v69
v_cvt_pk_bf16_f32 v95, v70, v71
s_cmp_eq_u32 s39, 0
s_cbranch_scc1 L_slow_86
buffer_store_dwordx2 v[88:89], v5, s[28:31], s3 offen offset:0
buffer_store_dwordx2 v[90:91], v5, s[28:31], s3 offen offset:512
buffer_store_dwordx2 v[92:93], v5, s[28:31], s3 offen offset:1024
s_mov_b64 exec, s[50:51]
buffer_store_dwordx2 v[94:95], v5, s[28:31], s3 offen offset:1536
s_mov_b64 exec, -1
L_stored_87:
v_and_b32 v96, s50, v94
v_and_b32 v97, s50, v95
v_mov_b32 v98, 0
v_mov_b32 v99, 0
v_mov_b32 v100, 0
v_mov_b32 v101, 0
v_dot2c_f32_bf16 v98, s58, v88
v_dot2c_f32_bf16 v99, v88, v88
v_dot2c_f32_bf16 v100, s58, v89
v_dot2c_f32_bf16 v101, v89, v89
v_dot2c_f32_bf16 v98, s58, v90
v_dot2c_f32_bf16 v99, v90, v90
v_dot2c_f32_bf16 v100, s58, v91
v_dot2c_f32_bf16 v101, v91, v91
v_dot2c_f32_bf16 v98, s58, v92
v_dot2c_f32_bf16 v99, v92, v92
v_dot2c_f32_bf16 v100, s58, v93
v_dot2c_f32_bf16 v101, v93, v93
v_dot2c_f32_bf16 v98, s58, v96
v_dot2c_f32_bf16 v99, v96, v96
v_dot2c_f32_bf16 v100, s58, v97
v_dot2c_f32_bf16 v101, v97, v97
s_nop 2
v_pk_add_f32 v[98:99], v[98:99], v[100:101]
v_mov_b32 v100, v98
v_mov_b32 v101, v99
s_nop 0
v_permlane32_swap_b32 v98, v100
v_permlane32_swap_b32 v99, v101
v_pk_add_f32 v[98:99], v[98:99], v[100:101]
s_cmp_eq_u32 s39, 0
s_cbranch_scc1 L_slow_88
s_mov_b32 exec_hi, 0
buffer_store_dwordx2 v[98:99], v7, s[28:31], s43 offen
s_mov_b32 exec_hi, -1
L_stored_89:
v_lshlrev_b32 v16, 16, v88
v_and_b32 v17, 0xffff0000, v88
v_lshlrev_b32 v18, 16, v89
v_and_b32 v19, 0xffff0000, v89
v_lshlrev_b32 v20, 16, v90
v_and_b32 v21, 0xffff0000, v90
v_lshlrev_b32 v22, 16, v91
v_and_b32 v23, 0xffff0000, v91
v_lshlrev_b32 v24, 16, v92
v_and_b32 v25, 0xffff0000, v92
v_lshlrev_b32 v26, 16, v93
v_and_b32 v27, 0xffff0000, v93
v_lshlrev_b32 v28, 16, v94
v_and_b32 v29, 0xffff0000, v94
v_lshlrev_b32 v30, 16, v95
v_and_b32 v31, 0xffff0000, v95
v_mov_b32 v2, s44
v_mov_b32 v3, s45
v_mov_b32 v4, 0
s_mov_b64 exec, 1
s_cmp_eq_u32 s39, 0
s_cbranch_scc1 L_slow_90
s_waitcnt vmcnt(0)
buffer_store_dwordx2 v[2:3], v4, s[28:31], s55 offen
L_stored_91:
s_mov_b64 exec, -1
s_barrier
s_mul_i32 s100, s37, 86016
s_lshl_b32 s101, s38, 10
s_add_u32 s100, s100, s101
s_add_u32 s57, s100, 28311552
s_add_u32 m0, s101, 107520
s_nop 0
buffer_load_dwordx4 v1, s[28:31], s57 offen lds
s_add_u32 s57, s100, 28315648
s_add_u32 m0, s101, 111616
s_nop 0
buffer_load_dwordx4 v1, s[28:31], s57 offen lds
s_add_u32 s57, s100, 28319744
s_add_u32 m0, s101, 115712
s_nop 0
buffer_load_dwordx4 v1, s[28:31], s57 offen lds
s_add_u32 s57, s100, 28323840
s_add_u32 m0, s101, 119808
s_nop 0
buffer_load_dwordx4 v1, s[28:31], s57 offen lds
s_add_u32 s57, s100, 28327936
s_add_u32 m0, s101, 123904
s_nop 0
buffer_load_dwordx4 v1, s[28:31], s57 offen lds
s_add_u32 s57, s100, 28332032
s_add_u32 m0, s101, 128000
s_nop 0
buffer_load_dwordx4 v1, s[28:31], s57 offen lds
s_add_u32 s57, s100, 28336128
s_add_u32 m0, s101, 132096
s_nop 0
buffer_load_dwordx4 v1, s[28:31], s57 offen lds
s_lshl_b32 s46, s38, 8
s_add_u32 s46, s46, 160768
v_and_b32 v2, 31, v0
v_cmp_eq_u32 s[50:51], 28, v2
v_lshlrev_b32 v2, 2, v2
v_add_u32 v3, s46, v2
v_lshrrev_b32 v4, 5, v0
v_lshlrev_b32 v4, 4, v4
v_add_u32 v5, 157696, v4
v_add_u32 v4, s46, v4
v_add_u32 v2, 157696, v2
s_lshl_b32 s47, s37, 6
s_add_u32 s47, s47, s42
s_lshl_b32 s48, s47, 12
s_add_u32 s48, s48, 18087936
s_lshl_b32 s47, s47, 7
s_add_u32 s54, s47, 196608
s_lshl_b32 s49, s38, 12
s_add_u32 s49, s49, 140288
v_add_u32 v7, s49, v1
v_lshlrev_b32 v8, 3, v0
v_add_u32 v11, 107520, v1
s_lshl_b32 s46, s42, 7
s_add_u32 s46, s46, 32768
v_and_b32 v9, 31, v0
v_lshlrev_b32 v9, 4, v9
v_lshrrev_b32 v6, 5, v0
v_lshl_add_u32 v9, v6, 11, v9
s_mul_i32 s3, s42, 28672
s_add_u32 s3, s3, 2883584
s_lshl_b32 s43, s42, 12
s_add_u32 s43, s43, 327680
s_mov_b64 exec, 0xffff
L_poll_92:
buffer_load_dwordx2 v[12:13], v8, s[28:31], s46 offen sc1
s_sub_u32 s59, s59, 1
s_cbranch_scc1 L_fin
s_waitcnt vmcnt(0)
v_cmp_ne_u64 vcc, s[44:45], v[12:13]
s_cbranch_vccnz L_poll_92
s_mov_b64 exec, -1
s_add_u32 s44, s44, 1
s_addc_u32 s45, s45, 0
buffer_load_dwordx4 v[56:59], v1, s[28:31], s3 offen offset:0 sc1
buffer_load_dwordx4 v[60:63], v1, s[28:31], s3 offen offset:1024 sc1
buffer_load_dwordx4 v[64:67], v1, s[28:31], s3 offen offset:2048 sc1
buffer_load_dwordx4 v[68:71], v1, s[28:31], s3 offen offset:3072 sc1
s_add_u32 s3, s3, 4096
buffer_load_dwordx4 v[72:75], v1, s[28:31], s3 offen offset:0 sc1
buffer_load_dwordx4 v[76:79], v1, s[28:31], s3 offen offset:1024 sc1
buffer_load_dwordx4 v[200:203], v9, s[28:31], s43 offen offset:0 sc1
buffer_load_dwordx4 v[80:83], v1, s[28:31], s3 offen offset:2048 sc1
ds_read_b128 v[216:219], v1 offset:0
ds_read_b128 v[220:223], v1 offset:28672
ds_read_b128 v[224:227], v1 offset:1024
ds_read_b128 v[228:231], v1 offset:29696
ds_read_b128 v[232:235], v1 offset:2048
ds_read_b128 v[236:239], v1 offset:30720
s_waitcnt vmcnt(7) lgkmcnt(4)
v_mfma_f32_32x32x16_bf16 v[168:183], v[216:219], v[56:59], 0
ds_read_b128 v[240:243], v1 offset:3072
buffer_load_dwordx4 v[204:207], v9, s[28:31], s43 offen offset:512 sc1
v_mfma_f32_32x32x16_bf16 v[184:199], v[56:59], v[220:223], 0
ds_read_b128 v[244:247], v1 offset:31744
buffer_load_dwordx4 v[84:87], v1, s[28:31], s3 offen offset:3072 sc1
s_waitcnt vmcnt(8) lgkmcnt(4)
v_mfma_f32_32x32x16_bf16 v[168:183], v[224:227], v[60:63], v[168:183]
ds_read_b128 v[216:219], v1 offset:4096
buffer_load_dwordx4 v[208:211], v9, s[28:31], s43 offen offset:1024 sc1
v_mfma_f32_32x32x16_bf16 v[184:199], v[60:63], v[228:231], v[184:199]
ds_read_b128 v[220:223], v1 offset:32768
s_add_u32 s3, s3, 4096
buffer_load_dwordx4 v[88:91], v1, s[28:31], s3 offen offset:0 sc1
s_waitcnt vmcnt(9) lgkmcnt(4)
v_mfma_f32_32x32x16_bf16 v[168:183], v[232:235], v[64:67], v[168:183]
ds_read_b128 v[224:227], v1 offset:5120
buffer_load_dwordx4 v[212:215], v9, s[28:31], s43 offen offset:1536 sc1
v_mfma_f32_32x32x16_bf16 v[184:199], v[64:67], v[236:239], v[184:199]
ds_read_b128 v[228:231], v1 offset:33792
buffer_load_dwordx4 v[92:95], v1, s[28:31], s3 offen offset:1024 sc1
s_waitcnt vmcnt(10) lgkmcnt(4)
v_mfma_f32_32x32x16_bf16 v[168:183], v[240:243], v[68:71], v[168:183]
ds_read_b128 v[232:235], v1 offset:6144
buffer_load_dwordx4 v[96:99], v1, s[28:31], s3 offen offset:2048 sc1
v_mfma_f32_32x32x16_bf16 v[184:199], v[68:71], v[244:247], v[184:199]
ds_read_b128 v[236:239], v1 offset:34816
buffer_load_dwordx4 v[100:103], v1, s[28:31], s3 offen offset:3072 sc1
s_waitcnt vmcnt(11) lgkmcnt(4)
v_mfma_f32_32x32x16_bf16 v[168:183], v[216:219], v[72:75], v[168:183]
ds_read_b128 v[240:243], v1 offset:7168
s_add_u32 s3, s3, 4096
buffer_load_dwordx4 v[104:107], v1, s[28:31], s3 offen offset:0 sc1
v_mfma_f32_32x32x16_bf16 v[184:199], v[72:75], v[220:223], v[184:199]
ds_read_b128 v[244:247], v1 offset:35840
s_waitcnt vmcnt(11) lgkmcnt(4)
v_mfma_f32_32x32x16_bf16 v[168:183], v[224:227], v[76:79], v[168:183]
ds_read_b128 v[216:219], v1 offset:8192
buffer_load_dwordx4 v[108:111], v1, s[28:31], s3 offen offset:1024 sc1
v_mfma_f32_32x32x16_bf16 v[184:199], v[76:79], v[228:231], v[184:199]
ds_read_b128 v[220:223], v1 offset:36864
s_waitcnt vmcnt(10) lgkmcnt(4)
v_mfma_f32_32x32x16_bf16 v[168:183], v[232:235], v[80:83], v[168:183]
ds_read_b128 v[224:227], v1 offset:9216
buffer_load_dwordx4 v[112:115], v1, s[28:31], s3 offen offset:2048 sc1
v_mfma_f32_32x32x16_bf16 v[184:199], v[80:83], v[236:239], v[184:199]
ds_read_b128 v[228:231], v1 offset:37888
s_waitcnt vmcnt(9) lgkmcnt(4)
v_mfma_f32_32x32x16_bf16 v[168:183], v[240:243], v[84:87], v[168:183]
ds_read_b128 v[232:235], v1 offset:10240
buffer_load_dwordx4 v[116:119], v1, s[28:31], s3 offen offset:3072 sc1
v_mfma_f32_32x32x16_bf16 v[184:199], v[84:87], v[244:247], v[184:199]
ds_read_b128 v[236:239], v1 offset:38912
s_waitcnt vmcnt(8) lgkmcnt(4)
v_mfma_f32_32x32x16_bf16 v[168:183], v[216:219], v[88:91], v[168:183]
ds_read_b128 v[240:243], v1 offset:11264
s_add_u32 s3, s3, 4096
buffer_load_dwordx4 v[120:123], v1, s[28:31], s3 offen offset:0 sc1
v_mfma_f32_32x32x16_bf16 v[184:199], v[88:91], v[220:223], v[184:199]
ds_read_b128 v[244:247], v1 offset:39936
s_waitcnt vmcnt(7) lgkmcnt(4)
v_mfma_f32_32x32x16_bf16 v[168:183], v[224:227], v[92:95], v[168:183]
ds_read_b128 v[216:219], v1 offset:12288
buffer_load_dwordx4 v[124:127], v1, s[28:31], s3 offen offset:1024 sc1
v_mfma_f32_32x32x16_bf16 v[184:199], v[92:95], v[228:231], v[184:199]
ds_read_b128 v[220:223], v1 offset:40960
s_waitcnt vmcnt(7) lgkmcnt(4)
v_mfma_f32_32x32x16_bf16 v[168:183], v[232:235], v[96:99], v[168:183]
ds_read_b128 v[224:227], v1 offset:13312
buffer_load_dwordx4 v[128:131], v1, s[28:31], s3 offen offset:2048 sc1
v_add_f32 v200, v200, v202
v_add_f32 v204, v204, v206
v_mfma_f32_32x32x16_bf16 v[184:199], v[96:99], v[236:239], v[184:199]
ds_read_b128 v[228:231], v1 offset:41984
v_add_f32 v208, v208, v210
v_add_f32 v212, v212, v214
s_waitcnt vmcnt(7) lgkmcnt(4)
v_mfma_f32_32x32x16_bf16 v[168:183], v[240:243], v[100:103], v[168:183]
ds_read_b128 v[232:235], v1 offset:14336
buffer_load_dwordx4 v[132:135], v1, s[28:31], s3 offen offset:3072 sc1
v_add_f32 v201, v201, v203
v_add_f32 v205, v205, v207
v_mfma_f32_32x32x16_bf16 v[184:199], v[100:103], v[244:247], v[184:199]
ds_read_b128 v[236:239], v1 offset:43008
v_add_f32 v209, v209, v211
v_add_f32 v213, v213, v215
s_waitcnt vmcnt(7) lgkmcnt(4)
v_mfma_f32_32x32x16_bf16 v[168:183], v[216:219], v[104:107], v[168:183]
ds_read_b128 v[240:243], v1 offset:15360
s_add_u32 s3, s3, 4096
buffer_load_dwordx4 v[136:139], v1, s[28:31], s3 offen offset:0 sc1
v_add_f32 v200, v200, v204
v_add_f32 v208, v208, v212
v_mfma_f32_32x32x16_bf16 v[184:199], v[104:107], v[220:223], v[184:199]
ds_read_b128 v[244:247], v1 offset:44032
v_add_f32 v201, v201, v205
v_add_f32 v209, v209, v213
s_waitcnt vmcnt(7) lgkmcnt(4)
v_mfma_f32_32x32x16_bf16 v[168:183], v[224:227], v[108:111], v[168:183]
ds_read_b128 v[216:219], v1 offset:16384
buffer_load_dwordx4 v[140:143], v1, s[28:31], s3 offen offset:1024 sc1
v_add_f32 v200, v200, v208
v_add_f32 v201, v201, v209
v_mfma_f32_32x32x16_bf16 v[184:199], v[108:111], v[228:231], v[184:199]
ds_read_b128 v[220:223], v1 offset:45056
v_mov_b32 v202, v200
v_mov_b32 v203, v201
s_waitcnt vmcnt(7) lgkmcnt(4)
v_mfma_f32_32x32x16_bf16 v[168:183], v[232:235], v[112:115], v[168:183]
ds_read_b128 v[224:227], v1 offset:17408
buffer_load_dwordx4 v[144:147], v1, s[28:31], s3 offen offset:2048 sc1
v_permlane32_swap_b32 v200, v202
v_permlane32_swap_b32 v201, v203
v_mfma_f32_32x32x16_bf16 v[184:199], v[112:115], v[236:239], v[184:199]
ds_read_b128 v[228:231], v1 offset:46080
v_add_f32 v200, v200, v202
v_add_f32 v201, v201, v203
s_waitcnt vmcnt(7) lgkmcnt(4)
v_mfma_f32_32x32x16_bf16 v[168:183], v[240:243], v[116:119], v[168:183]
ds_read_b128 v[232:235], v1 offset:18432
buffer_load_dwordx4 v[148:151], v1, s[28:31], s3 offen offset:3072 sc1
v_mul_f32 v200, 0xbb124925, v200
v_mul_f32 v201, 0x3b124925, v201
v_mfma_f32_32x32x16_bf16 v[184:199], v[116:119], v[244:247], v[184:199]
ds_read_b128 v[236:239], v1 offset:47104
v_fma_f32 v201, -v200, v200, v201
v_max_f32 v201, 0, v201
s_waitcnt vmcnt(7) lgkmcnt(4)
v_mfma_f32_32x32x16_bf16 v[168:183], v[216:219], v[120:123], v[168:183]
ds_read_b128 v[240:243], v1 offset:19456
s_add_u32 s3, s3, 4096
buffer_load_dwordx4 v[152:155], v1, s[28:31], s3 offen offset:0 sc1
v_add_f32 v201, 0x3727c5ac, v201
v_rsq_f32 v12, v201
v_mfma_f32_32x32x16_bf16 v[184:199], v[120:123], v[220:223], v[184:199]
ds_read_b128 v[244:247], v1 offset:48128
v_mul_f32 v13, v200, v12
s_waitcnt vmcnt(7) lgkmcnt(4)
v_mfma_f32_32x32x16_bf16 v[168:183], v[224:227], v[124:127], v[168:183]
ds_read_b128 v[216:219], v1 offset:20480
buffer_load_dwordx4 v[156:159], v1, s[28:31], s3 offen offset:1024 sc1
v_mfma_f32_32x32x16_bf16 v[184:199], v[124:127], v[228:231], v[184:199]
ds_read_b128 v[220:223], v1 offset:49152
s_waitcnt vmcnt(7) lgkmcnt(4)
v_mfma_f32_32x32x16_bf16 v[168:183], v[232:235], v[128:131], v[168:183]
ds_read_b128 v[224:227], v1 offset:21504
buffer_load_dwordx4 v[160:163], v1, s[28:31], s3 offen offset:2048 sc1
v_mfma_f32_32x32x16_bf16 v[184:199], v[128:131], v[236:239], v[184:199]
ds_read_b128 v[228:231], v1 offset:50176
s_waitcnt vmcnt(7) lgkmcnt(4)
v_mfma_f32_32x32x16_bf16 v[168:183], v[240:243], v[132:135], v[168:183]
ds_read_b128 v[232:235], v1 offset:22528
buffer_load_dwordx4 v[164:167], v1, s[28:31], s3 offen offset:3072 sc1
v_mfma_f32_32x32x16_bf16 v[184:199], v[132:135], v[244:247], v[184:199]
ds_read_b128 v[236:239], v1 offset:51200
s_waitcnt vmcnt(7) lgkmcnt(4)
v_mfma_f32_32x32x16_bf16 v[168:183], v[216:219], v[136:139], v[168:183]
ds_read_b128 v[240:243], v1 offset:23552
v_mfma_f32_32x32x16_bf16 v[184:199], v[136:139], v[220:223], v[184:199]
ds_read_b128 v[244:247], v1 offset:52224
s_waitcnt vmcnt(6) lgkmcnt(4)
v_mfma_f32_32x32x16_bf16 v[168:183], v[224:227], v[140:143], v[168:183]
ds_read_b128 v[216:219], v1 offset:24576
v_mfma_f32_32x32x16_bf16 v[184:199], v[140:143], v[228:231], v[184:199]
ds_read_b128 v[220:223], v1 offset:53248
s_waitcnt vmcnt(5) lgkmcnt(4)
v_mfma_f32_32x32x16_bf16 v[168:183], v[232:235], v[144:147], v[168:183]
ds_read_b128 v[224:227], v1 offset:25600
v_mfma_f32_32x32x16_bf16 v[184:199], v[144:147], v[236:239], v[184:199]
ds_read_b128 v[228:231], v1 offset:54272
s_waitcnt vmcnt(4) lgkmcnt(4)
v_mfma_f32_32x32x16_bf16 v[168:183], v[240:243], v[148:151], v[168:183]
ds_read_b128 v[232:235], v1 offset:26624
v_mfma_f32_32x32x16_bf16 v[184:199], v[148:151], v[244:247], v[184:199]
ds_read_b128 v[236:239], v1 offset:55296
s_waitcnt vmcnt(3) lgkmcnt(4)
v_mfma_f32_32x32x16_bf16 v[168:183], v[216:219], v[152:155], v[168:183]
ds_read_b128 v[240:243], v1 offset:27648
v_mfma_f32_32x32x16_bf16 v[184:199], v[152:155], v[220:223], v[184:199]
ds_read_b128 v[244:247], v1 offset:56320
s_waitcnt vmcnt(2) lgkmcnt(4)
v_mfma_f32_32x32x16_bf16 v[168:183], v[224:227], v[156:159], v[168:183]
ds_write_b32 v3, v12
ds_write_b32 v3, v13 offset:128
v_mfma_f32_32x32x16_bf16 v[184:199], v[156:159], v[228:231], v[184:199]
ds_read_b32 v6, v2 offset:256
ds_read_b128 v[200:203], v4 offset:0
s_waitcnt vmcnt(1) lgkmcnt(6)
v_mfma_f32_32x32x16_bf16 v[168:183], v[232:235], v[160:163], v[168:183]
ds_read_b128 v[204:207], v4 offset:32
ds_read_b128 v[208:211], v4 offset:64
v_mfma_f32_32x32x16_bf16 v[184:199], v[160:163], v[236:239], v[184:199]
ds_read_b128 v[212:215], v4 offset:96
ds_read_b128 v[248:251], v5 offset:128
s_waitcnt vmcnt(0) lgkmcnt(8)
v_mfma_f32_32x32x16_bf16 v[168:183], v[240:243], v[164:167], v[168:183]
ds_read_b128 v[252:255], v5 offset:160
v_mfma_f32_32x32x16_bf16 v[184:199], v[164:167], v[244:247], v[184:199]
ds_read_b128 v[224:227], v5 offset:192
ds_read_b128 v[228:231], v5 offset:224
ds_read_b128 v[232:235], v4 offset:128
ds_read_b128 v[236:239], v4 offset:160
ds_read_b128 v[240:243], v4 offset:192
ds_read_b128 v[244:247], v4 offset:224
s_nop 3
v_pk_mul_f32 v[168:169], v[168:169], v[12:13] op_sel_hi:[1,0]
v_pk_mul_f32 v[170:171], v[170:171], v[12:13] op_sel_hi:[1,0]
v_pk_mul_f32 v[172:173], v[172:173], v[12:13] op_sel_hi:[1,0]
v_pk_mul_f32 v[174:175], v[174:175], v[12:13] op_sel_hi:[1,0]
v_pk_mul_f32 v[176:177], v[176:177], v[12:13] op_sel_hi:[1,0]
v_pk_mul_f32 v[178:179], v[178:179], v[12:13] op_sel_hi:[1,0]
v_pk_mul_f32 v[180:181], v[180:181], v[12:13] op_sel_hi:[1,0]
v_pk_mul_f32 v[182:183], v[182:183], v[12:13] op_sel_hi:[1,0]
s_waitcnt lgkmcnt(4)
v_pk_fma_f32 v[168:169], v[248:249], v[12:13], v[168:169] op_sel:[0,1,0] op_sel_hi:[1,1,1]
v_pk_fma_f32 v[170:171], v[250:251], v[12:13], v[170:171] op_sel:[0,1,0] op_sel_hi:[1,1,1]
v_pk_fma_f32 v[172:173], v[252:253], v[12:13], v[172:173] op_sel:[0,1,0] op_sel_hi:[1,1,1]
v_pk_fma_f32 v[174:175], v[254:255], v[12:13], v[174:175] op_sel:[0,1,0] op_sel_hi:[1,1,1]
v_pk_fma_f32 v[176:177], v[224:225], v[12:13], v[176:177] op_sel:[0,1,0] op_sel_hi:[1,1,1]
v_pk_fma_f32 v[178:179], v[226:227], v[12:13], v[178:179] op_sel:[0,1,0] op_sel_hi:[1,1,1]
v_pk_fma_f32 v[180:181], v[228:229], v[12:13], v[180:181] op_sel:[0,1,0] op_sel_hi:[1,1,1]
v_pk_fma_f32 v[182:183], v[230:231], v[12:13], v[182:183] op_sel:[0,1,0] op_sel_hi:[1,1,1]
v_cvt_pk_bf16_f32 v168, v168, v169
v_cvt_pk_bf16_f32 v169, v170, v171
v_cvt_pk_bf16_f32 v170, v172, v173
v_cvt_pk_bf16_f32 v171, v174, v175
v_cvt_pk_bf16_f32 v172, v176, v177
v_cvt_pk_bf16_f32 v173, v178, v179
v_cvt_pk_bf16_f32 v174, v180, v181
v_cvt_pk_bf16_f32 v175, v182, v183
s_mov_b32 exec_lo, 0
v_mov_b32 v174, 0
v_mov_b32 v175, 0
s_mov_b32 exec_lo, -1
buffer_store_dwordx4 v[168:171], v1, s[28:31], s48 offen offset:0 sc1
buffer_store_dwordx4 v[172:175], v1, s[28:31], s48 offen offset:1024 sc1
s_waitcnt lgkmcnt(0)
v_pk_mul_f32 v[232:233], v[232:233], v[6:7] op_sel_hi:[1,0]
v_pk_mul_f32 v[234:235], v[234:235], v[6:7] op_sel_hi:[1,0]
v_pk_mul_f32 v[236:237], v[236:237], v[6:7] op_sel_hi:[1,0]
v_pk_mul_f32 v[238:239], v[238:239], v[6:7] op_sel_hi:[1,0]
v_pk_mul_f32 v[240:241], v[240:241], v[6:7] op_sel_hi:[1,0]
v_pk_mul_f32 v[242:243], v[242:243], v[6:7] op_sel_hi:[1,0]
v_pk_mul_f32 v[244:245], v[244:245], v[6:7] op_sel_hi:[1,0]
v_pk_mul_f32 v[246:247], v[246:247], v[6:7] op_sel_hi:[1,0]
v_pk_fma_f32 v[232:233], v[184:185], v[200:201], v[232:233]
v_pk_fma_f32 v[234:235], v[186:187], v[202:203], v[234:235]
v_pk_fma_f32 v[236:237], v[188:189], v[204:205], v[236:237]
v_pk_fma_f32 v[238:239], v[190:191], v[206:207], v[238:239]
v_pk_fma_f32 v[240:241], v[192:193], v[208:209], v[240:241]
v_pk_fma_f32 v[242:243], v[194:195], v[210:211], v[242:243]
v_pk_fma_f32 v[244:245], v[196:197], v[212:213], v[244:245]
v_pk_fma_f32 v[246:247], v[198:199], v[214:215], v[246:247]
v_cvt_pk_bf16_f32 v184, v232, v233
v_cvt_pk_bf16_f32 v185, v234, v235
v_cvt_pk_bf16_f32 v186, v236, v237
v_cvt_pk_bf16_f32 v187, v238, v239
v_cvt_pk_bf16_f32 v188, v240, v241
v_cvt_pk_bf16_f32 v189, v242, v243
v_cvt_pk_bf16_f32 v190, v244, v245
v_cvt_pk_bf16_f32 v191, v246, v247
s_mov_b32 s46, s58
s_mov_b32 s47, s58
s_mov_b64 exec, s[50:51]
v_mov_b64 v[184:185], s[46:47]
v_mov_b64 v[186:187], s[46:47]
v_mov_b64 v[188:189], s[46:47]
v_mov_b64 v[190:191], s[46:47]
s_mov_b64 exec, -1
buffer_store_dwordx4 v[184:187], v1, s[28:31], s48 offen offset:2048 sc1
buffer_store_dwordx4 v[188:191], v1, s[28:31], s48 offen offset:3072 sc1
ds_write_b128 v7, v[168:171] offset:0
ds_write_b128 v7, v[184:187] offset:2048
ds_write_b128 v7, v[172:175] offset:1024
ds_write_b128 v7, v[188:191] offset:3072
ds_read_b128 v[248:251], v5 offset:0
ds_read_b128 v[252:255], v5 offset:32
ds_read_b128 v[192:195], v5 offset:64
ds_read_b128 v[196:199], v5 offset:96
s_waitcnt lgkmcnt(0)
s_barrier
ds_read_b128 v[216:219], v11 offset:0
ds_read_b128 v[220:223], v11 offset:1024
ds_read_b128 v[224:227], v11 offset:2048
ds_read_b128 v[228:231], v11 offset:3072
ds_read_b128 v[232:235], v11 offset:4096
ds_read_b128 v[236:239], v11 offset:5120
ds_read_b128 v[240:243], v11 offset:6144
s_waitcnt lgkmcnt(6)
v_mfma_f32_32x32x16_bf16 v[200:215], v[216:219], v[56:59], 0
ds_read_b128 v[244:247], v11 offset:7168
s_waitcnt lgkmcnt(6)
v_mfma_f32_32x32x16_bf16 v[200:215], v[220:223], v[60:63], v[200:215]
ds_read_b128 v[216:219], v11 offset:8192
s_waitcnt lgkmcnt(6)
v_mfma_f32_32x32x16_bf16 v[200:215], v[224:227], v[64:67], v[200:215]
ds_read_b128 v[220:223], v11 offset:9216
s_waitcnt lgkmcnt(6)
v_mfma_f32_32x32x16_bf16 v[200:215], v[228:231], v[68:71], v[200:215]
ds_read_b128 v[224:227], v11 offset:10240
s_waitcnt lgkmcnt(6)
v_mfma_f32_32x32x16_bf16 v[200:215], v[232:235], v[72:75], v[200:215]
ds_read_b128 v[228:231], v11 offset:11264
s_waitcnt lgkmcnt(6)
v_mfma_f32_32x32x16_bf16 v[200:215], v[236:239], v[76:79], v[200:215]
ds_read_b128 v[232:235], v11 offset:12288
s_waitcnt lgkmcnt(6)
v_mfma_f32_32x32x16_bf16 v[200:215], v[240:243], v[80:83], v[200:215]
ds_read_b128 v[236:239], v11 offset:13312
s_waitcnt lgkmcnt(6)
v_mfma_f32_32x32x16_bf16 v[200:215], v[244:247], v[84:87], v[200:215]
ds_read_b128 v[240:243], v11 offset:14336
s_waitcnt lgkmcnt(6)
v_mfma_f32_32x32x16_bf16 v[200:215], v[216:219], v[88:91], v[200:215]
ds_read_b128 v[244:247], v11 offset:15360
s_waitcnt lgkmcnt(6)
v_mfma_f32_32x32x16_bf16 v[200:215], v[220:223], v[92:95], v[200:215]
ds_read_b128 v[216:219], v11 offset:16384
s_waitcnt lgkmcnt(6)
v_mfma_f32_32x32x16_bf16 v[200:215], v[224:227], v[96:99], v[200:215]
ds_read_b128 v[220:223], v11 offset:17408
s_waitcnt lgkmcnt(6)
v_mfma_f32_32x32x16_bf16 v[200:215], v[228:231], v[100:103], v[200:215]
ds_read_b128 v[224:227], v11 offset:18432
s_waitcnt lgkmcnt(6)
v_mfma_f32_32x32x16_bf16 v[200:215], v[232:235], v[104:107], v[200:215]
ds_read_b128 v[228:231], v11 offset:19456
s_waitcnt lgkmcnt(6)
v_mfma_f32_32x32x16_bf16 v[200:215], v[236:239], v[108:111], v[200:215]
ds_read_b128 v[232:235], v11 offset:20480
s_waitcnt lgkmcnt(6)
v_mfma_f32_32x32x16_bf16 v[200:215], v[240:243], v[112:115], v[200:215]
ds_read_b128 v[236:239], v11 offset:21504
s_waitcnt lgkmcnt(6)
v_mfma_f32_32x32x16_bf16 v[200:215], v[244:247], v[116:119], v[200:215]
ds_read_b128 v[240:243], v11 offset:22528
s_waitcnt lgkmcnt(6)
v_mfma_f32_32x32x16_bf16 v[200:215], v[216:219], v[120:123], v[200:215]
ds_read_b128 v[244:247], v11 offset:23552
s_waitcnt lgkmcnt(6)
v_mfma_f32_32x32x16_bf16 v[200:215], v[220:223], v[124:127], v[200:215]
ds_read_b128 v[216:219], v11 offset:24576
s_waitcnt lgkmcnt(6)
v_mfma_f32_32x32x16_bf16 v[200:215], v[224:227], v[128:131], v[200:215]
ds_read_b128 v[220:223], v11 offset:25600
s_waitcnt lgkmcnt(6)
v_mfma_f32_32x32x16_bf16 v[200:215], v[228:231], v[132:135], v[200:215]
ds_read_b128 v[224:227], v11 offset:26624
s_waitcnt lgkmcnt(6)
v_mfma_f32_32x32x16_bf16 v[200:215], v[232:235], v[136:139], v[200:215]
ds_read_b128 v[228:231], v11 offset:27648
s_waitcnt lgkmcnt(6)
v_mfma_f32_32x32x16_bf16 v[200:215], v[236:239], v[140:143], v[200:215]
s_waitcnt lgkmcnt(5)
v_mfma_f32_32x32x16_bf16 v[200:215], v[240:243], v[144:147], v[200:215]
s_waitcnt lgkmcnt(4)
v_mfma_f32_32x32x16_bf16 v[200:215], v[244:247], v[148:151], v[200:215]
s_waitcnt lgkmcnt(3)
v_mfma_f32_32x32x16_bf16 v[200:215], v[216:219], v[152:155], v[200:215]
v_mov_b32 v2, s44
v_mov_b32 v3, s45
v_mov_b32 v4, s44
v_mov_b32 v5, s45
s_mov_b64 exec, 0xff
s_waitcnt vmcnt(0)
buffer_store_dwordx4 v[2:5], v1, s[28:31], s54 offen sc1
s_mov_b64 exec, -1
s_waitcnt lgkmcnt(2)
v_mfma_f32_32x32x16_bf16 v[200:215], v[220:223], v[156:159], v[200:215]
s_waitcnt lgkmcnt(1)
v_mfma_f32_32x32x16_bf16 v[200:215], v[224:227], v[160:163], v[200:215]
s_waitcnt lgkmcnt(0)
v_mfma_f32_32x32x16_bf16 v[200:215], v[228:231], v[164:167], v[200:215]
v_mul_f32 v12, 0x3e8b97f6, v12
v_mul_f32 v13, 0x3e8b97f6, v13
s_nop 9
v_pk_mul_f32 v[200:201], v[200:201], v[12:13] op_sel_hi:[1,0]
v_pk_mul_f32 v[202:203], v[202:203], v[12:13] op_sel_hi:[1,0]
v_pk_mul_f32 v[204:205], v[204:205], v[12:13] op_sel_hi:[1,0]
v_pk_mul_f32 v[206:207], v[206:207], v[12:13] op_sel_hi:[1,0]
v_pk_mul_f32 v[208:209], v[208:209], v[12:13] op_sel_hi:[1,0]
v_pk_mul_f32 v[210:211], v[210:211], v[12:13] op_sel_hi:[1,0]
v_pk_mul_f32 v[212:213], v[212:213], v[12:13] op_sel_hi:[1,0]
v_pk_mul_f32 v[214:215], v[214:215], v[12:13] op_sel_hi:[1,0]
s_barrier
v_pk_fma_f32 v[200:201], v[248:249], v[12:13], v[200:201] op_sel:[0,1,0] op_sel_hi:[1,1,1]
v_pk_fma_f32 v[202:203], v[250:251], v[12:13], v[202:203] op_sel:[0,1,0] op_sel_hi:[1,1,1]
v_pk_fma_f32 v[204:205], v[252:253], v[12:13], v[204:205] op_sel:[0,1,0] op_sel_hi:[1,1,1]
v_pk_fma_f32 v[206:207], v[254:255], v[12:13], v[206:207] op_sel:[0,1,0] op_sel_hi:[1,1,1]
v_pk_fma_f32 v[208:209], v[192:193], v[12:13], v[208:209] op_sel:[0,1,0] op_sel_hi:[1,1,1]
v_pk_fma_f32 v[210:211], v[194:195], v[12:13], v[210:211] op_sel:[0,1,0] op_sel_hi:[1,1,1]
v_pk_fma_f32 v[212:213], v[196:197], v[12:13], v[212:213] op_sel:[0,1,0] op_sel_hi:[1,1,1]
v_pk_fma_f32 v[214:215], v[198:199], v[12:13], v[214:215] op_sel:[0,1,0] op_sel_hi:[1,1,1]
v_cvt_pk_bf16_f32 v56, v200, v201
v_cvt_pk_bf16_f32 v57, v202, v203
v_cvt_pk_bf16_f32 v58, v204, v205
v_cvt_pk_bf16_f32 v59, v206, v207
v_cvt_pk_bf16_f32 v60, v208, v209
v_cvt_pk_bf16_f32 v61, v210, v211
v_cvt_pk_bf16_f32 v62, v212, v213
v_cvt_pk_bf16_f32 v63, v214, v215
s_mov_b32 exec_lo, 0
v_mov_b32 v62, 0
v_mov_b32 v63, 0
s_mov_b32 exec_lo, -1
s_add_u32 s46, s36, s38
s_cmp_lt_u32 s46, 2
s_cselect_b32 s49, 2, s38
s_cmp_ge_u32 s49, 2
s_cbranch_scc1 L_nw0_95
s_lshl_b32 s46, s46, 2
s_lshl_b32 s48, s37, 6
s_add_u32 s46, s46, s48
s_sub_u32 s46, s46, 8
s_lshl_b32 s48, s46, 7
s_add_u32 s48, s48, 196608
s_lshl_b32 s46, s46, 12
s_add_u32 s46, s46, 18087936
s_lshl_b32 s47, s38, 14
s_add_u32 s47, s47, 107520
v_lshlrev_b32 v2, 7, v0
s_mov_b64 exec, 15
buffer_load_dwordx2 v[4:5], v2, s[28:31], s48 offen sc1
s_mov_b64 exec, -1
L_nw0_95:
s_lshl_b32 s52, s38, 12
s_add_u32 s52, s52, 128000
s_add_u32 s53, s38, 1
v_add_u32 v236, s52, v1
ds_read_b128 v[144:147], v236 offset:12288
ds_read_b128 v[148:151], v236 offset:13312
ds_read_b128 v[152:155], v236 offset:8192
ds_read_b128 v[156:159], v236 offset:9216
ds_read_b128 v[160:163], v236 offset:4096
ds_read_b128 v[164:167], v236 offset:5120
ds_read_b128 v[168:171], v236 offset:0
ds_read_b128 v[172:175], v236 offset:1024
v_mov_b32 v233, 0xf149f2ca
v_mov_b32 v232, v233
s_waitcnt lgkmcnt(6)
v_mfma_f32_32x32x16_bf16 v[96:111], v[144:147], v[56:59], 0
v_mfma_f32_32x32x16_bf16 v[96:111], v[148:151], v[60:63], v[96:111]
s_waitcnt lgkmcnt(4)
v_mfma_f32_32x32x16_bf16 v[112:127], v[152:155], v[56:59], 0
v_mfma_f32_32x32x16_bf16 v[112:127], v[156:159], v[60:63], v[112:127]
s_nop 8
v_cndmask_b32 v96, v233, v96, s[64:65]
v_cndmask_b32 v97, v233, v97, s[66:67]
v_cndmask_b32 v98, v233, v98, s[68:69]
v_cndmask_b32 v99, v233, v99, s[70:71]
v_cndmask_b32 v100, v233, v100, s[72:73]
v_cndmask_b32 v101, v233, v101, s[74:75]
v_cndmask_b32 v102, v233, v102, s[76:77]
v_cndmask_b32 v103, v233, v103, s[78:79]
v_cndmask_b32 v104, v233, v104, s[80:81]
v_cndmask_b32 v105, v233, v105, s[82:83]
v_cndmask_b32 v106, v233, v106, s[84:85]
v_cndmask_b32 v107, v233, v107, s[86:87]
v_cndmask_b32 v108, v233, v108, s[88:89]
v_cndmask_b32 v109, v233, v109, s[90:91]
v_cndmask_b32 v110, v233, v110, s[92:93]
v_cndmask_b32 v111, v233, v111, s[94:95]
L_nomask_97:
v_max3_f32 v232, v96, v97, v232
v_max3_f32 v232, v98, v99, v232
v_max3_f32 v232, v100, v101, v232
v_max3_f32 v232, v102, v103, v232
v_max3_f32 v232, v104, v105, v232
v_max3_f32 v232, v106, v107, v232
v_max3_f32 v232, v108, v109, v232
v_max3_f32 v232, v110, v111, v232
s_cmp_eq_u32 s53, 1
s_cbranch_scc1 L_p1x_96
s_waitcnt lgkmcnt(2)
v_mfma_f32_32x32x16_bf16 v[96:111], v[160:163], v[56:59], 0
v_max3_f32 v232, v112, v113, v232
v_max3_f32 v232, v114, v115, v232
v_max3_f32 v232, v116, v117, v232
v_max3_f32 v232, v118, v119, v232
v_mfma_f32_32x32x16_bf16 v[96:111], v[164:167], v[60:63], v[96:111]
v_max3_f32 v232, v120, v121, v232
v_max3_f32 v232, v122, v123, v232
v_max3_f32 v232, v124, v125, v232
v_max3_f32 v232, v126, v127, v232
s_cmp_eq_u32 s53, 2
s_cbranch_scc1 L_p1x_96
s_waitcnt lgkmcnt(0)
v_mfma_f32_32x32x16_bf16 v[112:127], v[168:171], v[56:59], 0
s_nop 3
v_max3_f32 v232, v96, v97, v232
v_max3_f32 v232, v98, v99, v232
v_max3_f32 v232, v100, v101, v232
v_max3_f32 v232, v102, v103, v232
v_mfma_f32_32x32x16_bf16 v[112:127], v[172:175], v[60:63], v[112:127]
v_max3_f32 v232, v104, v105, v232
v_max3_f32 v232, v106, v107, v232
v_max3_f32 v232, v108, v109, v232
v_max3_f32 v232, v110, v111, v232
s_cmp_eq_u32 s53, 3
s_cbranch_scc1 L_p1x_96
s_nop 5
v_max3_f32 v232, v112, v113, v232
v_max3_f32 v232, v114, v115, v232
v_max3_f32 v232, v116, v117, v232
v_max3_f32 v232, v118, v119, v232
v_max3_f32 v232, v120, v121, v232
v_max3_f32 v232, v122, v123, v232
v_max3_f32 v232, v124, v125, v232
v_max3_f32 v232, v126, v127, v232
L_p1x_96:
v_mov_b32 v235, v232
s_nop 1
v_permlane32_swap_b32 v232, v235
v_max_f32 v232, v232, v235
v_pk_mul_f32 v[80:81], v[232:233], -1.0 op_sel_hi:[0,0]
v_pk_mul_f32 v[82:83], v[232:233], -1.0 op_sel_hi:[0,0]
v_pk_mul_f32 v[84:85], v[232:233], -1.0 op_sel_hi:[0,0]
v_pk_mul_f32 v[86:87], v[232:233], -1.0 op_sel_hi:[0,0]
v_pk_mul_f32 v[88:89], v[232:233], -1.0 op_sel_hi:[0,0]
v_pk_mul_f32 v[90:91], v[232:233], -1.0 op_sel_hi:[0,0]
v_pk_mul_f32 v[92:93], v[232:233], -1.0 op_sel_hi:[0,0]
v_pk_mul_f32 v[94:95], v[232:233], -1.0 op_sel_hi:[0,0]
s_cmp_ge_u32 s49, 2
s_cbranch_scc1 L_nw1_98
s_waitcnt vmcnt(0)
s_mov_b64 exec, 15
v_cmp_ne_u64 vcc, s[44:45], v[4:5]
s_cbranch_vccnz L_chk_99
L_chkok_100:
s_mov_b64 exec, -1
s_add_u32 s57, s46, 0
s_add_u32 m0, s47, 0
s_nop 0
buffer_load_dwordx4 v1, s[28:31], s57 offen sc1 lds
s_add_u32 s57, s46, 1024
s_add_u32 m0, s47, 1024
s_nop 0
buffer_load_dwordx4 v1, s[28:31], s57 offen sc1 lds
s_add_u32 s57, s46, 2048
s_add_u32 m0, s47, 2048
s_nop 0
buffer_load_dwordx4 v1, s[28:31], s57 offen sc1 lds
s_add_u32 s57, s46, 3072
s_add_u32 m0, s47, 3072
s_nop 0
buffer_load_dwordx4 v1, s[28:31], s57 offen sc1 lds
s_add_u32 s57, s46, 4096
s_add_u32 m0, s47, 4096
s_nop 0
buffer_load_dwordx4 v1, s[28:31], s57 offen sc1 lds
s_add_u32 s57, s46, 5120
s_add_u32 m0, s47, 5120
s_nop 0
buffer_load_dwordx4 v1, s[28:31], s57 offen sc1 lds
s_add_u32 s57, s46, 6144
s_add_u32 m0, s47, 6144
s_nop 0
buffer_load_dwordx4 v1, s[28:31], s57 offen sc1 lds
s_add_u32 s57, s46, 7168
s_add_u32 m0, s47, 7168
s_nop 0
buffer_load_dwordx4 v1, s[28:31], s57 offen sc1 lds
s_add_u32 s57, s46, 8192
s_add_u32 m0, s47, 8192
s_nop 0
buffer_load_dwordx4 v1, s[28:31], s57 offen sc1 lds
s_add_u32 s57, s46, 9216
s_add_u32 m0, s47, 9216
s_nop 0
buffer_load_dwordx4 v1, s[28:31], s57 offen sc1 lds
s_add_u32 s57, s46, 10240
s_add_u32 m0, s47, 10240
s_nop 0
buffer_load_dwordx4 v1, s[28:31], s57 offen sc1 lds
s_add_u32 s57, s46, 11264
s_add_u32 m0, s47, 11264
s_nop 0
buffer_load_dwordx4 v1, s[28:31], s57 offen sc1 lds
s_add_u32 s57, s46, 12288
s_add_u32 m0, s47, 12288
s_nop 0
buffer_load_dwordx4 v1, s[28:31], s57 offen sc1 lds
s_add_u32 s57, s46, 13312
s_add_u32 m0, s47, 13312
s_nop 0
buffer_load_dwordx4 v1, s[28:31], s57 offen sc1 lds
s_add_u32 s57, s46, 14336
s_add_u32 m0, s47, 14336
s_nop 0
buffer_load_dwordx4 v1, s[28:31], s57 offen sc1 lds
s_add_u32 s57, s46, 15360
s_add_u32 m0, s47, 15360
s_nop 0
buffer_load_dwordx4 v1, s[28:31], s57 offen sc1 lds
L_nw1_98:
s_waitcnt lgkmcnt(0)
v_mfma_f32_32x32x16_bf16 v[96:111], v[144:147], v[56:59], v[80:95]
v_mfma_f32_32x32x16_bf16 v[96:111], v[148:151], v[60:63], v[96:111]
v_mfma_f32_32x32x16_bf16 v[112:127], v[152:155], v[56:59], v[80:95]
v_mfma_f32_32x32x16_bf16 v[112:127], v[156:159], v[60:63], v[112:127]
ds_read_b128 v[208:211], v236 offset:14336
ds_read_b128 v[212:215], v236 offset:15360
ds_read_b128 v[216:219], v236 offset:10240
ds_read_b128 v[220:223], v236 offset:11264
s_nop 5
v_cndmask_b32 v96, v233, v96, s[64:65]
v_cndmask_b32 v97, v233, v97, s[66:67]
v_cndmask_b32 v98, v233, v98, s[68:69]
v_cndmask_b32 v99, v233, v99, s[70:71]
v_cndmask_b32 v100, v233, v100, s[72:73]
v_cndmask_b32 v101, v233, v101, s[74:75]
v_cndmask_b32 v102, v233, v102, s[76:77]
v_cndmask_b32 v103, v233, v103, s[78:79]
v_cndmask_b32 v104, v233, v104, s[80:81]
v_cndmask_b32 v105, v233, v105, s[82:83]
v_cndmask_b32 v106, v233, v106, s[84:85]
v_cndmask_b32 v107, v233, v107, s[86:87]
v_cndmask_b32 v108, v233, v108, s[88:89]
v_cndmask_b32 v109, v233, v109, s[90:91]
v_cndmask_b32 v110, v233, v110, s[92:93]
v_cndmask_b32 v111, v233, v111, s[94:95]
L_nomask_102:
v_exp_f32 v96, v96
v_exp_f32 v97, v97
v_exp_f32 v98, v98
v_exp_f32 v99, v99
v_exp_f32 v100, v100
v_exp_f32 v101, v101
v_exp_f32 v102, v102
v_exp_f32 v103, v103
v_cvt_pk_bf16_f32 v128, v96, v97
v_cvt_pk_bf16_f32 v129, v98, v99
v_exp_f32 v104, v104
v_exp_f32 v105, v105
v_exp_f32 v106, v106
v_exp_f32 v107, v107
v_cvt_pk_bf16_f32 v130, v100, v101
v_cvt_pk_bf16_f32 v131, v102, v103
v_exp_f32 v108, v108
v_exp_f32 v109, v109
v_exp_f32 v110, v110
v_exp_f32 v111, v111
v_cvt_pk_bf16_f32 v132, v104, v105
v_cvt_pk_bf16_f32 v133, v106, v107
v_cvt_pk_bf16_f32 v134, v108, v109
v_cvt_pk_bf16_f32 v135, v110, v111
s_cmp_eq_u32 s53, 1
s_cbranch_scc1 L_p2s_103
v_mfma_f32_32x32x16_bf16 v[96:111], v[160:163], v[56:59], v[80:95]
v_exp_f32 v112, v112
v_exp_f32 v113, v113
v_exp_f32 v114, v114
v_exp_f32 v115, v115
v_mfma_f32_32x32x16_bf16 v[96:111], v[164:167], v[60:63], v[96:111]
v_exp_f32 v116, v116
v_exp_f32 v117, v117
v_exp_f32 v118, v118
v_exp_f32 v119, v119
v_cvt_pk_bf16_f32 v136, v112, v113
v_cvt_pk_bf16_f32 v137, v114, v115
s_waitcnt lgkmcnt(2)
v_mfma_f32_32x32x16_bf16 v[64:79], v[208:211], v[128:131], 0
v_exp_f32 v120, v120
v_exp_f32 v121, v121
v_exp_f32 v122, v122
v_exp_f32 v123, v123
v_cvt_pk_bf16_f32 v138, v116, v117
v_cvt_pk_bf16_f32 v139, v118, v119
v_mfma_f32_32x32x16_bf16 v[64:79], v[212:215], v[132:135], v[64:79]
ds_read_b128 v[224:227], v236 offset:6144
ds_read_b128 v[228:231], v236 offset:7168
v_exp_f32 v124, v124
v_exp_f32 v125, v125
v_exp_f32 v126, v126
v_exp_f32 v127, v127
v_cvt_pk_bf16_f32 v140, v120, v121
v_cvt_pk_bf16_f32 v141, v122, v123
v_cvt_pk_bf16_f32 v142, v124, v125
v_cvt_pk_bf16_f32 v143, v126, v127
s_cmp_eq_u32 s53, 2
s_cbranch_scc1 L_p2s_104
v_mfma_f32_32x32x16_bf16 v[112:127], v[168:171], v[56:59], v[80:95]
v_exp_f32 v96, v96
v_exp_f32 v97, v97
v_exp_f32 v98, v98
v_exp_f32 v99, v99
v_mfma_f32_32x32x16_bf16 v[112:127], v[172:175], v[60:63], v[112:127]
v_exp_f32 v100, v100
v_exp_f32 v101, v101
v_exp_f32 v102, v102
v_exp_f32 v103, v103
v_cvt_pk_bf16_f32 v128, v96, v97
v_cvt_pk_bf16_f32 v129, v98, v99
s_waitcnt lgkmcnt(2)
v_mfma_f32_32x32x16_bf16 v[64:79], v[216:219], v[136:139], v[64:79]
v_exp_f32 v104, v104
v_exp_f32 v105, v105
v_exp_f32 v106, v106
v_exp_f32 v107, v107
v_cvt_pk_bf16_f32 v130, v100, v101
v_cvt_pk_bf16_f32 v131, v102, v103
v_mfma_f32_32x32x16_bf16 v[64:79], v[220:223], v[140:143], v[64:79]
ds_read_b128 v[208:211], v236 offset:2048
ds_read_b128 v[212:215], v236 offset:3072
v_exp_f32 v108, v108
v_exp_f32 v109, v109
v_exp_f32 v110, v110
v_exp_f32 v111, v111
v_cvt_pk_bf16_f32 v132, v104, v105
v_cvt_pk_bf16_f32 v133, v106, v107
v_cvt_pk_bf16_f32 v134, v108, v109
v_cvt_pk_bf16_f32 v135, v110, v111
s_cmp_eq_u32 s53, 3
s_cbranch_scc1 L_p2s_105
s_waitcnt lgkmcnt(2)
v_mfma_f32_32x32x16_bf16 v[64:79], v[224:227], v[128:131], v[64:79]
v_exp_f32 v112, v112
v_exp_f32 v113, v113
v_exp_f32 v114, v114
v_exp_f32 v115, v115
v_exp_f32 v116, v116
v_exp_f32 v117, v117
v_exp_f32 v118, v118
v_exp_f32 v119, v119
v_cvt_pk_bf16_f32 v136, v112, v113
v_cvt_pk_bf16_f32 v137, v114, v115
v_mfma_f32_32x32x16_bf16 v[64:79], v[228:231], v[132:135], v[64:79]
v_exp_f32 v120, v120
v_exp_f32 v121, v121
v_exp_f32 v122, v122
v_exp_f32 v123, v123
v_cvt_pk_bf16_f32 v138, v116, v117
v_cvt_pk_bf16_f32 v139, v118, v119
v_exp_f32 v124, v124
v_exp_f32 v125, v125
v_exp_f32 v126, v126
v_exp_f32 v127, v127
v_cvt_pk_bf16_f32 v140, v120, v121
v_cvt_pk_bf16_f32 v141, v122, v123
v_cvt_pk_bf16_f32 v142, v124, v125
v_cvt_pk_bf16_f32 v143, v126, v127
s_waitcnt lgkmcnt(0)
v_mfma_f32_32x32x16_bf16 v[64:79], v[208:211], v[136:139], v[64:79]
v_mfma_f32_32x32x16_bf16 v[64:79], v[212:215], v[140:143], v[64:79]
s_branch L_p2x_101
L_p2s_103:
s_waitcnt lgkmcnt(0)
v_mfma_f32_32x32x16_bf16 v[64:79], v[208:211], v[128:131], 0
v_mfma_f32_32x32x16_bf16 v[64:79], v[212:215], v[132:135], v[64:79]
s_branch L_p2x_101
L_p2s_104:
s_waitcnt lgkmcnt(0)
v_mfma_f32_32x32x16_bf16 v[64:79], v[216:219], v[136:139], v[64:79]
v_mfma_f32_32x32x16_bf16 v[64:79], v[220:223], v[140:143], v[64:79]
s_branch L_p2x_101
L_p2s_105:
s_waitcnt lgkmcnt(0)
v_mfma_f32_32x32x16_bf16 v[64:79], v[224:227], v[128:131], v[64:79]
v_mfma_f32_32x32x16_bf16 v[64:79], v[228:231], v[132:135], v[64:79]
L_p2x_101:
s_mul_i32 s46, s37, 7
v_lshrrev_b32 v4, 5, v0
v_add_u32 v4, s46, v4
v_and_b32 v5, 1, v4
v_lshrrev_b32 v4, 1, v4
v_lshlrev_b32 v4, 9, v4
v_lshl_add_u32 v4, v5, 3, v4
v_and_b32 v5, 31, v0
v_lshl_add_u32 v7, v5, 4, v4
s_mul_i32 s46, s42, 28672
s_add_u32 s46, s46, 1048576
s_lshl_b32 s47, s42, 7
s_lshl_b32 s49, s37, 3
s_add_u32 s47, s47, s49
s_add_u32 s47, s47, 8192
s_cmp_ge_u32 s36, 2
s_cselect_b32 s54, 1, 0
s_cselect_b32 s52, s38, 4
s_sub_u32 s53, 8, s52
s_lshl_b32 s52, s52, 12
s_add_u32 s52, s52, 107520
v_add_u32 v236, s52, v1
s_mov_b32 s55, 0
s_cmp_ge_u32 s38, 2
s_cbranch_scc1 L_hdone_94
s_waitcnt vmcnt(0)
L_hdone_94:
s_barrier
s_cmp_eq_u32 s36, 0
s_cbranch_scc1 L_nosegb_106
ds_read_b128 v[144:147], v236 offset:0
ds_read_b128 v[148:151], v236 offset:1024
ds_read_b128 v[152:155], v236 offset:4096
ds_read_b128 v[156:159], v236 offset:5120
s_waitcnt lgkmcnt(2)
v_mfma_f32_32x32x16_bf16 v[96:111], v[144:147], v[56:59], v[80:95]
v_mfma_f32_32x32x16_bf16 v[96:111], v[148:151], v[60:63], v[96:111]
ds_read_b128 v[160:163], v236 offset:8192
ds_read_b128 v[164:167], v236 offset:9216
ds_read_b128 v[168:171], v236 offset:12288
ds_read_b128 v[172:175], v236 offset:13312
ds_read_b128 v[176:179], v236 offset:16384
ds_read_b128 v[180:183], v236 offset:17408
ds_read_b128 v[184:187], v236 offset:20480
ds_read_b128 v[188:191], v236 offset:21504
ds_read_b128 v[192:195], v236 offset:24576
ds_read_b128 v[196:199], v236 offset:25600
ds_read_b128 v[200:203], v236 offset:28672
ds_read_b128 v[204:207], v236 offset:29696
s_waitcnt lgkmcnt(12)
v_mfma_f32_32x32x16_bf16 v[112:127], v[152:155], v[56:59], v[80:95]
v_mfma_f32_32x32x16_bf16 v[112:127], v[156:159], v[60:63], v[112:127]
ds_read_b128 v[208:211], v236 offset:2048
ds_read_b128 v[212:215], v236 offset:3072
ds_read_b128 v[216:219], v236 offset:6144
ds_read_b128 v[220:223], v236 offset:7168
s_cmp_eq_u32 s54, 0
s_cbranch_scc1 L_nomask_111
v_cndmask_b32 v96, v96, v233, s[64:65]
v_cndmask_b32 v97, v97, v233, s[66:67]
v_cndmask_b32 v98, v98, v233, s[68:69]
v_cndmask_b32 v99, v99, v233, s[70:71]
v_cndmask_b32 v100, v100, v233, s[72:73]
v_cndmask_b32 v101, v101, v233, s[74:75]
v_cndmask_b32 v102, v102, v233, s[76:77]
v_cndmask_b32 v103, v103, v233, s[78:79]
v_cndmask_b32 v104, v104, v233, s[80:81]
v_cndmask_b32 v105, v105, v233, s[82:83]
v_cndmask_b32 v106, v106, v233, s[84:85]
v_cndmask_b32 v107, v107, v233, s[86:87]
v_cndmask_b32 v108, v108, v233, s[88:89]
v_cndmask_b32 v109, v109, v233, s[90:91]
v_cndmask_b32 v110, v110, v233, s[92:93]
v_cndmask_b32 v111, v111, v233, s[94:95]
L_nomask_111:
v_exp_f32 v96, v96
v_exp_f32 v97, v97
v_exp_f32 v98, v98
v_exp_f32 v99, v99
s_and_b32 s56, s36, 1
s_lshl_b32 s56, s56, 2
s_add_u32 s56, s56, s38
s_mul_i32 s56, s56, 6272
s_mul_i32 s57, s37, 100352
s_add_u32 s56, s56, s57
s_add_u32 s56, s56, 24691712
v_mul_u32_u24 v14, 128, v0
s_mov_b32 exec_lo, 0xffffffff
s_mov_b32 exec_hi, 0x1ffff
buffer_load_dword v14, v14, s[28:31], s56 offen
s_mov_b64 exec, -1
v_exp_f32 v100, v100
v_exp_f32 v101, v101
v_exp_f32 v102, v102
v_exp_f32 v103, v103
v_cvt_pk_bf16_f32 v128, v96, v97
v_cvt_pk_bf16_f32 v129, v98, v99
v_exp_f32 v104, v104
v_exp_f32 v105, v105
v_exp_f32 v106, v106
v_exp_f32 v107, v107
v_cvt_pk_bf16_f32 v130, v100, v101
v_cvt_pk_bf16_f32 v131, v102, v103
v_exp_f32 v108, v108
v_exp_f32 v109, v109
v_exp_f32 v110, v110
v_exp_f32 v111, v111
v_cvt_pk_bf16_f32 v132, v104, v105
v_cvt_pk_bf16_f32 v133, v106, v107
v_cvt_pk_bf16_f32 v134, v108, v109
v_cvt_pk_bf16_f32 v135, v110, v111
s_waitcnt lgkmcnt(4)
v_mfma_f32_32x32x16_bf16 v[96:111], v[160:163], v[56:59], v[80:95]
v_exp_f32 v112, v112
v_exp_f32 v113, v113
v_exp_f32 v114, v114
v_exp_f32 v115, v115
v_mfma_f32_32x32x16_bf16 v[96:111], v[164:167], v[60:63], v[96:111]
v_exp_f32 v116, v116
v_exp_f32 v117, v117
v_exp_f32 v118, v118
v_exp_f32 v119, v119
v_cvt_pk_bf16_f32 v136, v112, v113
v_cvt_pk_bf16_f32 v137, v114, v115
s_waitcnt lgkmcnt(2)
v_mfma_f32_32x32x16_bf16 v[240:255], v[208:211], v[128:131], v[64:79]
v_exp_f32 v120, v120
v_exp_f32 v121, v121
v_exp_f32 v122, v122
v_exp_f32 v123, v123
v_cvt_pk_bf16_f32 v138, v116, v117
v_cvt_pk_bf16_f32 v139, v118, v119
v_mfma_f32_32x32x16_bf16 v[240:255], v[212:215], v[132:135], v[240:255]
ds_read_b128 v[224:227], v236 offset:10240
ds_read_b128 v[228:231], v236 offset:11264
v_exp_f32 v124, v124
v_exp_f32 v125, v125
v_exp_f32 v126, v126
v_exp_f32 v127, v127
v_cvt_pk_bf16_f32 v140, v120, v121
v_cvt_pk_bf16_f32 v141, v122, v123
v_cvt_pk_bf16_f32 v142, v124, v125
v_cvt_pk_bf16_f32 v143, v126, v127
v_mfma_f32_32x32x16_bf16 v[112:127], v[168:171], v[56:59], v[80:95]
v_exp_f32 v96, v96
v_exp_f32 v97, v97
v_exp_f32 v98, v98
v_exp_f32 v99, v99
v_mfma_f32_32x32x16_bf16 v[112:127], v[172:175], v[60:63], v[112:127]
v_exp_f32 v100, v100
v_exp_f32 v101, v101
v_exp_f32 v102, v102
v_exp_f32 v103, v103
v_cvt_pk_bf16_f32 v128, v96, v97
v_cvt_pk_bf16_f32 v129, v98, v99
s_waitcnt lgkmcnt(2)
v_mfma_f32_32x32x16_bf16 v[240:255], v[216:219], v[136:139], v[240:255]
v_exp_f32 v104, v104
v_exp_f32 v105, v105
v_exp_f32 v106, v106
v_exp_f32 v107, v107
v_cvt_pk_bf16_f32 v130, v100, v101
v_cvt_pk_bf16_f32 v131, v102, v103
v_mfma_f32_32x32x16_bf16 v[240:255], v[220:223], v[140:143], v[240:255]
ds_read_b128 v[208:211], v236 offset:14336
ds_read_b128 v[212:215], v236 offset:15360
v_exp_f32 v108, v108
v_exp_f32 v109, v109
v_exp_f32 v110, v110
v_exp_f32 v111, v111
v_cvt_pk_bf16_f32 v132, v104, v105
v_cvt_pk_bf16_f32 v133, v106, v107
v_cvt_pk_bf16_f32 v134, v108, v109
v_cvt_pk_bf16_f32 v135, v110, v111
v_mfma_f32_32x32x16_bf16 v[96:111], v[176:179], v[56:59], v[80:95]
v_exp_f32 v112, v112
v_exp_f32 v113, v113
v_exp_f32 v114, v114
v_exp_f32 v115, v115
v_mfma_f32_32x32x16_bf16 v[96:111], v[180:183], v[60:63], v[96:111]
v_exp_f32 v116, v116
v_exp_f32 v117, v117
v_exp_f32 v118, v118
v_exp_f32 v119, v119
v_cvt_pk_bf16_f32 v136, v112, v113
v_cvt_pk_bf16_f32 v137, v114, v115
s_waitcnt lgkmcnt(2)
v_mfma_f32_32x32x16_bf16 v[240:255], v[224:227], v[128:131], v[240:255]
v_exp_f32 v120, v120
v_exp_f32 v121, v121
v_exp_f32 v122, v122
v_exp_f32 v123, v123
v_cvt_pk_bf16_f32 v138, v116, v117
v_cvt_pk_bf16_f32 v139, v118, v119
v_mfma_f32_32x32x16_bf16 v[240:255], v[228:231], v[132:135], v[240:255]
ds_read_b128 v[216:219], v236 offset:18432
ds_read_b128 v[220:223], v236 offset:19456
v_exp_f32 v124, v124
v_exp_f32 v125, v125
v_exp_f32 v126, v126
v_exp_f32 v127, v127
v_cvt_pk_bf16_f32 v140, v120, v121
v_cvt_pk_bf16_f32 v141, v122, v123
v_cvt_pk_bf16_f32 v142, v124, v125
v_cvt_pk_bf16_f32 v143, v126, v127
s_cmp_eq_u32 s53, 4
s_cbranch_scc1 L_p2s_112
v_mfma_f32_32x32x16_bf16 v[112:127], v[184:187], v[56:59], v[80:95]
v_exp_f32 v96, v96
v_exp_f32 v97, v97
v_exp_f32 v98, v98
v_exp_f32 v99, v99
v_mfma_f32_32x32x16_bf16 v[112:127], v[188:191], v[60:63], v[112:127]
v_exp_f32 v100, v100
v_exp_f32 v101, v101
v_exp_f32 v102, v102
v_exp_f32 v103, v103
v_cvt_pk_bf16_f32 v128, v96, v97
v_cvt_pk_bf16_f32 v129, v98, v99
s_waitcnt lgkmcnt(2)
v_mfma_f32_32x32x16_bf16 v[240:255], v[208:211], v[136:139], v[240:255]
v_exp_f32 v104, v104
v_exp_f32 v105, v105
v_exp_f32 v106, v106
v_exp_f32 v107, v107
v_cvt_pk_bf16_f32 v130, v100, v101
v_cvt_pk_bf16_f32 v131, v102, v103
v_mfma_f32_32x32x16_bf16 v[240:255], v[212:215], v[140:143], v[240:255]
ds_read_b128 v[224:227], v236 offset:22528
ds_read_b128 v[228:231], v236 offset:23552
v_exp_f32 v108, v108
v_exp_f32 v109, v109
v_exp_f32 v110, v110
v_exp_f32 v111, v111
v_cvt_pk_bf16_f32 v132, v104, v105
v_cvt_pk_bf16_f32 v133, v106, v107
v_cvt_pk_bf16_f32 v134, v108, v109
v_cvt_pk_bf16_f32 v135, v110, v111
s_cmp_eq_u32 s53, 5
s_cbranch_scc1 L_p2s_113
v_mfma_f32_32x32x16_bf16 v[96:111], v[192:195], v[56:59], v[80:95]
v_exp_f32 v112, v112
v_exp_f32 v113, v113
v_exp_f32 v114, v114
v_exp_f32 v115, v115
v_mfma_f32_32x32x16_bf16 v[96:111], v[196:199], v[60:63], v[96:111]
v_exp_f32 v116, v116
v_exp_f32 v117, v117
v_exp_f32 v118, v118
v_exp_f32 v119, v119
v_cvt_pk_bf16_f32 v136, v112, v113
v_cvt_pk_bf16_f32 v137, v114, v115
s_waitcnt lgkmcnt(2)
v_mfma_f32_32x32x16_bf16 v[240:255], v[216:219], v[128:131], v[240:255]
v_exp_f32 v120, v120
v_exp_f32 v121, v121
v_exp_f32 v122, v122
v_exp_f32 v123, v123
v_cvt_pk_bf16_f32 v138, v116, v117
v_cvt_pk_bf16_f32 v139, v118, v119
v_mfma_f32_32x32x16_bf16 v[240:255], v[220:223], v[132:135], v[240:255]
ds_read_b128 v[208:211], v236 offset:26624
ds_read_b128 v[212:215], v236 offset:27648
v_exp_f32 v124, v124
v_exp_f32 v125, v125
v_exp_f32 v126, v126
v_exp_f32 v127, v127
v_cvt_pk_bf16_f32 v140, v120, v121
v_cvt_pk_bf16_f32 v141, v122, v123
v_cvt_pk_bf16_f32 v142, v124, v125
v_cvt_pk_bf16_f32 v143, v126, v127
s_cmp_eq_u32 s53, 6
s_cbranch_scc1 L_p2s_114
v_mfma_f32_32x32x16_bf16 v[112:127], v[200:203], v[56:59], v[80:95]
v_exp_f32 v96, v96
v_exp_f32 v97, v97
v_exp_f32 v98, v98
v_exp_f32 v99, v99
v_mfma_f32_32x32x16_bf16 v[112:127], v[204:207], v[60:63], v[112:127]
v_exp_f32 v100, v100
v_exp_f32 v101, v101
v_exp_f32 v102, v102
v_exp_f32 v103, v103
v_cvt_pk_bf16_f32 v128, v96, v97
v_cvt_pk_bf16_f32 v129, v98, v99
s_waitcnt lgkmcnt(2)
v_mfma_f32_32x32x16_bf16 v[240:255], v[224:227], v[136:139], v[240:255]
v_exp_f32 v104, v104
v_exp_f32 v105, v105
v_exp_f32 v106, v106
v_exp_f32 v107, v107
v_cvt_pk_bf16_f32 v130, v100, v101
v_cvt_pk_bf16_f32 v131, v102, v103
v_mfma_f32_32x32x16_bf16 v[240:255], v[228:231], v[140:143], v[240:255]
ds_read_b128 v[216:219], v236 offset:30720
ds_read_b128 v[220:223], v236 offset:31744
v_exp_f32 v108, v108
v_exp_f32 v109, v109
v_exp_f32 v110, v110
v_exp_f32 v111, v111
v_cvt_pk_bf16_f32 v132, v104, v105
v_cvt_pk_bf16_f32 v133, v106, v107
v_cvt_pk_bf16_f32 v134, v108, v109
v_cvt_pk_bf16_f32 v135, v110, v111
s_cmp_eq_u32 s53, 7
s_cbranch_scc1 L_p2s_115
s_waitcnt lgkmcnt(2)
v_mfma_f32_32x32x16_bf16 v[240:255], v[208:211], v[128:131], v[240:255]
v_exp_f32 v112, v112
v_exp_f32 v113, v113
v_exp_f32 v114, v114
v_exp_f32 v115, v115
v_exp_f32 v116, v116
v_exp_f32 v117, v117
v_exp_f32 v118, v118
v_exp_f32 v119, v119
v_cvt_pk_bf16_f32 v136, v112, v113
v_cvt_pk_bf16_f32 v137, v114, v115
v_mfma_f32_32x32x16_bf16 v[240:255], v[212:215], v[132:135], v[240:255]
v_exp_f32 v120, v120
v_exp_f32 v121, v121
v_exp_f32 v122, v122
v_exp_f32 v123, v123
v_cvt_pk_bf16_f32 v138, v116, v117
v_cvt_pk_bf16_f32 v139, v118, v119
v_exp_f32 v124, v124
v_exp_f32 v125, v125
v_exp_f32 v126, v126
v_exp_f32 v127, v127
v_cvt_pk_bf16_f32 v140, v120, v121
v_cvt_pk_bf16_f32 v141, v122, v123
v_cvt_pk_bf16_f32 v142, v124, v125
v_cvt_pk_bf16_f32 v143, v126, v127
s_waitcnt lgkmcnt(0)
v_mfma_f32_32x32x16_bf16 v[240:255], v[216:219], v[136:139], v[240:255]
v_mfma_f32_32x32x16_bf16 v[240:255], v[220:223], v[140:143], v[240:255]
s_branch L_p2x_110
L_p2s_112:
s_waitcnt lgkmcnt(0)
v_mfma_f32_32x32x16_bf16 v[240:255], v[208:211], v[136:139], v[240:255]
v_mfma_f32_32x32x16_bf16 v[240:255], v[212:215], v[140:143], v[240:255]
s_branch L_p2x_110
L_p2s_113:
s_waitcnt lgkmcnt(0)
v_mfma_f32_32x32x16_bf16 v[240:255], v[216:219], v[128:131], v[240:255]
v_mfma_f32_32x32x16_bf16 v[240:255], v[220:223], v[132:135], v[240:255]
s_branch L_p2x_110
L_p2s_114:
s_waitcnt lgkmcnt(0)
v_mfma_f32_32x32x16_bf16 v[240:255], v[224:227], v[136:139], v[240:255]
v_mfma_f32_32x32x16_bf16 v[240:255], v[228:231], v[140:143], v[240:255]
s_branch L_p2x_110
L_p2s_115:
s_waitcnt lgkmcnt(0)
v_mfma_f32_32x32x16_bf16 v[240:255], v[208:211], v[128:131], v[240:255]
v_mfma_f32_32x32x16_bf16 v[240:255], v[212:215], v[132:135], v[240:255]
L_p2x_110:
v_mov_b32 v2, 0x5d800000
s_nop 10
v_cmp_nle_f32 vcc, v252, v2
s_nop 0
s_and_b64 vcc, vcc, s[62:63]
s_cbranch_scc1 L_redo_109
L_segbdone_107:
s_nop 10
v_rcp_f32 v2, v252
s_nop 0
v_mov_b32 v3, v2
s_nop 1
v_permlane32_swap_b32 v3, v2
v_pk_mul_f32 v[240:241], v[240:241], v[2:3] op_sel_hi:[1,0]
v_pk_mul_f32 v[242:243], v[242:243], v[2:3] op_sel_hi:[1,0]
v_pk_mul_f32 v[244:245], v[244:245], v[2:3] op_sel_hi:[1,0]
v_pk_mul_f32 v[246:247], v[246:247], v[2:3] op_sel_hi:[1,0]
v_pk_mul_f32 v[248:249], v[248:249], v[2:3] op_sel_hi:[1,0]
v_pk_mul_f32 v[250:251], v[250:251], v[2:3] op_sel_hi:[1,0]
v_pk_mul_f32 v[252:253], v[252:253], v[2:3] op_sel_hi:[1,0]
v_pk_mul_f32 v[254:255], v[254:255], v[2:3] op_sel_hi:[1,0]
v_cvt_pk_bf16_f32 v240, v240, v241
v_cvt_pk_bf16_f32 v241, v242, v243
v_cvt_pk_bf16_f32 v242, v244, v245
v_cvt_pk_bf16_f32 v243, v246, v247
v_cvt_pk_bf16_f32 v244, v248, v249
v_cvt_pk_bf16_f32 v245, v250, v251
v_cvt_pk_bf16_f32 v246, v252, v253
v_cvt_pk_bf16_f32 v247, v254, v255
s_cmp_eq_u32 s39, 0
s_cbranch_scc1 L_slow_116
buffer_store_dwordx2 v[240:241], v7, s[28:31], s46 offen offset:0
buffer_store_dwordx2 v[242:243], v7, s[28:31], s46 offen offset:512
buffer_store_dwordx2 v[244:245], v7, s[28:31], s46 offen offset:1024
s_mov_b32 exec_hi, 0
buffer_store_dwordx2 v[246:247], v7, s[28:31], s46 offen offset:1536
s_mov_b32 exec_hi, -1
L_stored_117:
v_mov_b32 v2, s44
v_mov_b32 v3, s45
v_mov_b32 v4, 0
s_mov_b64 exec, 1
s_cmp_eq_u32 s39, 0
s_cbranch_scc1 L_slow_118
s_waitcnt vmcnt(0)
buffer_store_dwordx2 v[2:3], v4, s[28:31], s47 offen
L_stored_119:
s_mov_b64 exec, -1
s_barrier
s_xor_b32 s52, s98, 1
s_mul_i32 s52, s52, 28672
s_mul_i32 s53, s98, 28672
s_mul_i32 s54, s38, 7168
s_add_u32 s54, s54, 1048576
s_add_u32 s52, s52, s54
s_add_u32 s53, s53, s54
v_and_b32 v7, 31, v0
v_lshrrev_b32 v4, 5, v0
s_mul_i32 s3, s41, 7
s_lshl_b32 s48, s99, 2
s_add_u32 s3, s3, s48
v_lshrrev_b32 v5, 4, v7
v_mul_u32_u24 v5, 14336, v5
v_and_b32 v6, 15, v7
v_lshl_add_u32 v5, v6, 4, v5
v_lshl_add_u32 v5, v4, 3, v5
s_lshl_b32 s3, s3, 8
s_mul_i32 s48, s98, 28672
s_add_u32 s3, s3, s48
s_add_u32 s3, s3, 2883584
v_lshlrev_b32 v7, 4, v7
s_lshl_b32 s43, s98, 12
s_lshl_b32 s49, s41, 9
s_add_u32 s43, s43, s49
s_lshl_b32 s49, s99, 3
s_add_u32 s43, s43, s49
s_add_u32 s43, s43, 327680
s_lshl_b32 s55, s98, 7
s_lshl_b32 s48, s41, 4
s_add_u32 s55, s55, s48
s_add_u32 s55, s55, s49
s_add_u32 s55, s55, 16384
s_mul_i32 s48, s38, 12288
s_add_u32 s48, s48, 107520
v_add_u32 v8, s48, v1
s_sub_u32 s50, s99, 1
s_mov_b32 s51, s50
v_and_b32 v9, 3, v0
v_lshlrev_b32 v9, 3, v9
v_bfe_u32 v3, v0, 2, 1
v_lshl_add_u32 v9, v3, 7, v9
s_andn2_b32 s47, s98, 1
s_lshl_b32 s47, s47, 7
s_lshl_b32 s48, s38, 5
s_add_u32 s47, s47, s48
s_add_u32 s47, s47, 8192
s_mov_b64 exec, 0xff
L_poll_120:
buffer_load_dwordx2 v[10:11], v9, s[28:31], s47 offen sc1
s_sub_u32 s59, s59, 1
s_cbranch_scc1 L_fin
s_waitcnt vmcnt(0)
v_cmp_ne_u64 vcc, s[44:45], v[10:11]
s_cbranch_vccnz L_poll_120
s_mov_b64 exec, -1
s_add_u32 s57, s52, 0
buffer_load_dwordx4 v[120:123], v1, s[28:31], s57 offen offset:0 sc1
s_add_u32 s57, s52, 0
buffer_load_dwordx4 v[124:127], v1, s[28:31], s57 offen offset:1024 sc1
s_add_u32 s57, s52, 0
buffer_load_dwordx4 v[128:131], v1, s[28:31], s57 offen offset:2048 sc1
s_add_u32 s57, s52, 0
buffer_load_dwordx4 v[132:135], v1, s[28:31], s57 offen offset:3072 sc1
s_add_u32 s57, s52, 4096
buffer_load_dwordx4 v[136:139], v1, s[28:31], s57 offen offset:0 sc1
s_add_u32 s57, s52, 4096
buffer_load_dwordx4 v[140:143], v1, s[28:31], s57 offen offset:1024 sc1
s_add_u32 s57, s52, 4096
buffer_load_dwordx4 v[144:147], v1, s[28:31], s57 offen offset:2048 sc1
s_waitcnt vmcnt(6)
v_mfma_f32_32x32x16_bf16 v[88:103], a[224:227], v[120:123], 0
s_add_u32 s57, s53, 0
buffer_load_dwordx4 v[148:151], v1, s[28:31], s57 offen offset:0 sc1
v_mfma_f32_32x32x16_bf16 v[104:119], a[228:231], v[120:123], 0
s_waitcnt vmcnt(6)
v_mfma_f32_32x32x16_bf16 v[88:103], a[232:235], v[124:127], v[88:103]
s_add_u32 s57, s53, 0
buffer_load_dwordx4 v[152:155], v1, s[28:31], s57 offen offset:1024 sc1
v_mfma_f32_32x32x16_bf16 v[104:119], a[236:239], v[124:127], v[104:119]
s_waitcnt vmcnt(6)
v_mfma_f32_32x32x16_bf16 v[88:103], a[240:243], v[128:131], v[88:103]
s_add_u32 s57, s53, 0
buffer_load_dwordx4 v[156:159], v1, s[28:31], s57 offen offset:2048 sc1
v_mfma_f32_32x32x16_bf16 v[104:119], a[244:247], v[128:131], v[104:119]
s_waitcnt vmcnt(6)
v_mfma_f32_32x32x16_bf16 v[88:103], a[248:251], v[132:135], v[88:103]
s_add_u32 s57, s53, 0
buffer_load_dwordx4 v[160:163], v1, s[28:31], s57 offen offset:3072 sc1
v_mfma_f32_32x32x16_bf16 v[104:119], a[252:255], v[132:135], v[104:119]
s_waitcnt vmcnt(6)
v_mfma_f32_32x32x16_bf16 v[88:103], v[32:35], v[136:139], v[88:103]
s_add_u32 s57, s53, 4096
buffer_load_dwordx4 v[164:167], v1, s[28:31], s57 offen offset:0 sc1
v_mfma_f32_32x32x16_bf16 v[104:119], v[36:39], v[136:139], v[104:119]
s_waitcnt vmcnt(6)
v_mfma_f32_32x32x16_bf16 v[88:103], v[40:43], v[140:143], v[88:103]
s_add_u32 s57, s53, 4096
buffer_load_dwordx4 v[168:171], v1, s[28:31], s57 offen offset:1024 sc1
v_mfma_f32_32x32x16_bf16 v[104:119], v[44:47], v[140:143], v[104:119]
s_waitcnt vmcnt(6)
v_mfma_f32_32x32x16_bf16 v[88:103], v[48:51], v[144:147], v[88:103]
s_add_u32 s57, s53, 4096
buffer_load_dwordx4 v[172:175], v1, s[28:31], s57 offen offset:2048 sc1
v_mfma_f32_32x32x16_bf16 v[104:119], v[52:55], v[144:147], v[104:119]
s_waitcnt vmcnt(6)
s_xor_b32 s46, s38, 2
s_mul_i32 s46, s46, 12288
s_add_u32 s46, s46, 111616
v_add_u32 v2, s46, v1
v_mfma_f32_32x32x16_bf16 v[56:71], a[224:227], v[148:151], 0
s_nop 2
ds_write_b128 v2, v[88:91] offset:0
ds_write_b128 v2, v[92:95] offset:1024
v_mfma_f32_32x32x16_bf16 v[72:87], a[228:231], v[148:151], 0
ds_write_b128 v2, v[96:99] offset:2048
ds_write_b128 v2, v[100:103] offset:3072
s_waitcnt vmcnt(5)
s_xor_b32 s46, s38, 3
s_mul_i32 s46, s46, 12288
s_add_u32 s46, s46, 115712
v_add_u32 v2, s46, v1
v_mfma_f32_32x32x16_bf16 v[56:71], a[232:235], v[152:155], v[56:71]
ds_write_b128 v2, v[104:107] offset:0
ds_write_b128 v2, v[108:111] offset:1024
v_mfma_f32_32x32x16_bf16 v[72:87], a[236:239], v[152:155], v[72:87]
ds_write_b128 v2, v[112:115] offset:2048
ds_write_b128 v2, v[116:119] offset:3072
s_waitcnt vmcnt(4)
v_mfma_f32_32x32x16_bf16 v[56:71], a[240:243], v[156:159], v[56:71]
s_waitcnt lgkmcnt(0)
s_barrier
ds_read_b128 v[184:187], v8 offset:4096
ds_read_b128 v[188:191], v8 offset:5120
ds_read_b128 v[192:195], v8 offset:6144
v_mfma_f32_32x32x16_bf16 v[72:87], a[244:247], v[156:159], v[72:87]
ds_read_b128 v[196:199], v8 offset:7168
ds_read_b128 v[200:203], v8 offset:8192
ds_read_b128 v[204:207], v8 offset:9216
ds_read_b128 v[208:211], v8 offset:10240
ds_read_b128 v[212:215], v8 offset:11264
s_waitcnt vmcnt(3)
v_mfma_f32_32x32x16_bf16 v[56:71], a[248:251], v[160:163], v[56:71]
v_mfma_f32_32x32x16_bf16 v[72:87], a[252:255], v[160:163], v[72:87]
s_waitcnt vmcnt(2)
v_mfma_f32_32x32x16_bf16 v[56:71], v[32:35], v[164:167], v[56:71]
s_waitcnt lgkmcnt(0)
v_add_f32 v184, v184, v200
v_add_f32 v185, v185, v201
v_add_f32 v186, v186, v202
v_add_f32 v187, v187, v203
v_mfma_f32_32x32x16_bf16 v[72:87], v[36:39], v[164:167], v[72:87]
v_add_f32 v188, v188, v204
v_add_f32 v189, v189, v205
v_add_f32 v190, v190, v206
v_add_f32 v191, v191, v207
s_waitcnt vmcnt(1)
v_mfma_f32_32x32x16_bf16 v[56:71], v[40:43], v[168:171], v[56:71]
v_add_f32 v192, v192, v208
v_add_f32 v193, v193, v209
v_add_f32 v194, v194, v210
v_add_f32 v195, v195, v211
v_mfma_f32_32x32x16_bf16 v[72:87], v[44:47], v[168:171], v[72:87]
v_add_f32 v196, v196, v212
v_add_f32 v197, v197, v213
v_add_f32 v198, v198, v214
v_add_f32 v199, v199, v215
s_waitcnt vmcnt(0)
s_xor_b32 s46, s38, 1
s_mul_i32 s46, s46, 12288
s_add_u32 s46, s46, 107520
v_add_u32 v2, s46, v1
v_mfma_f32_32x32x16_bf16 v[72:87], v[52:55], v[172:175], v[72:87]
v_mfma_f32_32x32x16_bf16 v[56:71], v[48:51], v[172:175], v[56:71]
s_nop 10
ds_write_b128 v2, v[72:75] offset:0
ds_write_b128 v2, v[76:79] offset:1024
ds_write_b128 v2, v[80:83] offset:2048
ds_write_b128 v2, v[84:87] offset:3072
v_pk_add_f32 v[56:57], v[56:57], v[184:185]
v_pk_add_f32 v[58:59], v[58:59], v[186:187]
v_pk_add_f32 v[60:61], v[60:61], v[188:189]
v_pk_add_f32 v[62:63], v[62:63], v[190:191]
v_pk_add_f32 v[64:65], v[64:65], v[192:193]
v_pk_add_f32 v[66:67], v[66:67], v[194:195]
v_pk_add_f32 v[68:69], v[68:69], v[196:197]
v_pk_add_f32 v[70:71], v[70:71], v[198:199]
s_waitcnt lgkmcnt(0)
s_barrier
ds_read_b128 v[184:187], v8 offset:0
ds_read_b128 v[188:191], v8 offset:1024
ds_read_b128 v[192:195], v8 offset:2048
ds_read_b128 v[196:199], v8 offset:3072
v_pk_add_f32 v[56:57], v[56:57], v[16:17]
v_pk_add_f32 v[58:59], v[58:59], v[18:19]
v_pk_add_f32 v[60:61], v[60:61], v[20:21]
v_pk_add_f32 v[62:63], v[62:63], v[22:23]
v_pk_add_f32 v[64:65], v[64:65], v[24:25]
v_pk_add_f32 v[66:67], v[66:67], v[26:27]
v_pk_add_f32 v[68:69], v[68:69], v[28:29]
v_pk_add_f32 v[70:71], v[70:71], v[30:31]
s_waitcnt lgkmcnt(3)
v_pk_add_f32 v[56:57], v[56:57], v[184:185]
v_pk_add_f32 v[58:59], v[58:59], v[186:187]
v_cvt_pk_bf16_f32 v88, v56, v57
v_cvt_pk_bf16_f32 v89, v58, v59
s_waitcnt lgkmcnt(2)
v_pk_add_f32 v[60:61], v[60:61], v[188:189]
v_pk_add_f32 v[62:63], v[62:63], v[190:191]
v_cvt_pk_bf16_f32 v90, v60, v61
v_cvt_pk_bf16_f32 v91, v62, v63
s_waitcnt lgkmcnt(1)
v_pk_add_f32 v[64:65], v[64:65], v[192:193]
v_pk_add_f32 v[66:67], v[66:67], v[194:195]
v_cvt_pk_bf16_f32 v92, v64, v65
v_cvt_pk_bf16_f32 v93, v66, v67
s_waitcnt lgkmcnt(0)
v_pk_add_f32 v[68:69], v[68:69], v[196:197]
v_pk_add_f32 v[70:71], v[70:71], v[198:199]
v_cvt_pk_bf16_f32 v94, v68, v69
v_cvt_pk_bf16_f32 v95, v70, v71
s_cmp_eq_u32 s39, 0
s_cbranch_scc1 L_slow_122
buffer_store_dwordx2 v[88:89], v5, s[28:31], s3 offen offset:0
buffer_store_dwordx2 v[90:91], v5, s[28:31], s3 offen offset:256
buffer_store_dwordx2 v[92:93], v5, s[28:31], s3 offen offset:512
s_mov_b64 exec, s[50:51]
buffer_store_dwordx2 v[94:95], v5, s[28:31], s3 offen offset:768
s_mov_b64 exec, -1
L_stored_123:
v_and_b32 v96, s50, v94
v_and_b32 v97, s50, v95
v_mov_b32 v98, 0
v_mov_b32 v99, 0
v_mov_b32 v100, 0
v_mov_b32 v101, 0
v_dot2c_f32_bf16 v98, s58, v88
v_dot2c_f32_bf16 v99, v88, v88
v_dot2c_f32_bf16 v100, s58, v89
v_dot2c_f32_bf16 v101, v89, v89
v_dot2c_f32_bf16 v98, s58, v90
v_dot2c_f32_bf16 v99, v90, v90
v_dot2c_f32_bf16 v100, s58, v91
v_dot2c_f32_bf16 v101, v91, v91
v_dot2c_f32_bf16 v98, s58, v92
v_dot2c_f32_bf16 v99, v92, v92
v_dot2c_f32_bf16 v100, s58, v93
v_dot2c_f32_bf16 v101, v93, v93
v_dot2c_f32_bf16 v98, s58, v96
v_dot2c_f32_bf16 v99, v96, v96
v_dot2c_f32_bf16 v100, s58, v97
v_dot2c_f32_bf16 v101, v97, v97
s_nop 2
v_pk_add_f32 v[98:99], v[98:99], v[100:101]
v_mov_b32 v100, v98
v_mov_b32 v101, v99
s_nop 0
v_permlane32_swap_b32 v98, v100
v_permlane32_swap_b32 v99, v101
v_pk_add_f32 v[98:99], v[98:99], v[100:101]
s_cmp_eq_u32 s39, 0
s_cbranch_scc1 L_slow_124
s_mov_b32 exec_hi, 0
buffer_store_dwordx2 v[98:99], v7, s[28:31], s43 offen
s_mov_b32 exec_hi, -1
L_stored_125:
v_lshlrev_b32 v16, 16, v88
v_and_b32 v17, 0xffff0000, v88
v_lshlrev_b32 v18, 16, v89
v_and_b32 v19, 0xffff0000, v89
v_lshlrev_b32 v20, 16, v90
v_and_b32 v21, 0xffff0000, v90
v_lshlrev_b32 v22, 16, v91
v_and_b32 v23, 0xffff0000, v91
v_lshlrev_b32 v24, 16, v92
v_and_b32 v25, 0xffff0000, v92
v_lshlrev_b32 v26, 16, v93
v_and_b32 v27, 0xffff0000, v93
v_lshlrev_b32 v28, 16, v94
v_and_b32 v29, 0xffff0000, v94
v_lshlrev_b32 v30, 16, v95
v_and_b32 v31, 0xffff0000, v95
v_mov_b32 v2, s44
v_mov_b32 v3, s45
v_mov_b32 v4, 0
s_mov_b64 exec, 1
s_cmp_eq_u32 s39, 0
s_cbranch_scc1 L_slow_126
s_waitcnt vmcnt(0)
buffer_store_dwordx2 v[2:3], v4, s[28:31], s55 offen
L_stored_127:
s_mov_b64 exec, -1
s_barrier
s_mul_i32 s3, s37, 100352
s_add_u32 s3, s3, 24691712
s_lshl_b32 s43, s38, 10
s_add_u32 s3, s3, s43
s_add_u32 s57, s3, 0
s_add_u32 m0, s43, 107520
s_nop 0
buffer_load_dwordx4 v1, s[28:31], s57 offen lds
s_add_u32 s57, s3, 4096
s_add_u32 m0, s43, 111616
s_nop 0
buffer_load_dwordx4 v1, s[28:31], s57 offen lds
s_add_u32 s57, s3, 8192
s_add_u32 m0, s43, 115712
s_nop 0
buffer_load_dwordx4 v1, s[28:31], s57 offen lds
s_add_u32 s57, s3, 12288
s_add_u32 m0, s43, 119808
s_nop 0
buffer_load_dwordx4 v1, s[28:31], s57 offen lds
s_add_u32 s57, s3, 16384
s_add_u32 m0, s43, 123904
s_nop 0
buffer_load_dwordx4 v1, s[28:31], s57 offen lds
s_add_u32 s57, s3, 20480
s_add_u32 m0, s43, 128000
s_nop 0
buffer_load_dwordx4 v1, s[28:31], s57 offen lds
s_add_u32 s57, s3, 24576
s_add_u32 m0, s43, 132096
s_nop 0
buffer_load_dwordx4 v1, s[28:31], s57 offen lds
s_add_u32 s57, s3, 28672
s_add_u32 m0, s43, 136192
s_nop 0
buffer_load_dwordx4 v1, s[28:31], s57 offen lds
s_add_u32 s57, s3, 32768
s_add_u32 m0, s43, 140288
s_nop 0
buffer_load_dwordx4 v1, s[28:31], s57 offen lds
s_add_u32 s57, s3, 36864
s_add_u32 m0, s43, 144384
s_nop 0
buffer_load_dwordx4 v1, s[28:31], s57 offen lds
s_add_u32 s57, s3, 40960
s_add_u32 m0, s43, 148480
s_nop 0
buffer_load_dwordx4 v1, s[28:31], s57 offen lds
s_add_u32 s57, s3, 45056
s_add_u32 m0, s43, 152576
s_nop 0
buffer_load_dwordx4 v1, s[28:31], s57 offen lds
s_sub_u32 s3, s3, s43
s_mov_b32 s43, 0
s_add_u32 s57, s3, 49152
s_add_u32 m0, s43, 156672
s_nop 0
buffer_load_dwordx4 v1, s[28:31], s57 offen lds
v_add_u32 v12, 57344, v1
v_lshlrev_b32 v2, 3, v0
s_lshl_b32 s46, s42, 7
s_add_u32 s46, s46, 16384
s_mul_i32 s3, s42, 28672
s_add_u32 s3, s3, 2883584
s_add_u32 s43, s3, 14336
s_lshl_b32 s48, s42, 12
s_add_u32 s48, s48, 327680
v_and_b32 v6, 15, v0
v_lshlrev_b32 v3, 4, v6
v_lshrrev_b32 v7, 4, v0
v_lshl_add_u32 v6, v7, 10, v3
s_lshl_b32 s49, s38, 8
s_add_u32 s49, s49, 160768
v_lshrrev_b32 v8, 2, v3
v_add_u32 v8, s49, v8
s_and_b32 s49, s98, 3
s_lshl_b32 s49, s49, 8
s_add_u32 s49, s49, 160768
v_and_b32 v9, 31, v0
v_lshl_add_u32 v9, v9, 2, s49
v_lshl_add_u32 v10, v7, 9, v3
v_lshrrev_b32 v11, 1, v7
v_lshl_add_u32 v11, v11, 9, v3
v_and_b32 v7, 1, v7
v_lshl_add_u32 v11, v7, 3, v11
s_mul_i32 s50, s42, 114688
s_mul_i32 s51, s37, 7168
s_add_u32 s50, s50, s51
s_add_u32 s50, s50, 33554432
s_add_u32 s51, s50, 4096
s_lshl_b32 s55, s42, 7
s_lshl_b32 s54, s37, 3
s_add_u32 s55, s55, s54
s_add_u32 s55, s55, 24576
s_mov_b64 exec, 0xffff
L_poll_128:
buffer_load_dwordx2 v[4:5], v2, s[28:31], s46 offen sc1
s_sub_u32 s59, s59, 1
s_cbranch_scc1 L_fin
s_waitcnt vmcnt(0)
v_cmp_ne_u64 vcc, s[44:45], v[4:5]
s_cbranch_vccnz L_poll_128
s_mov_b64 exec, -1
buffer_load_dwordx4 v[56:59], v1, s[28:31], s3 offen offset:0 sc1
buffer_load_dwordx4 v[60:63], v1, s[28:31], s43 offen offset:0 sc1
buffer_load_dwordx4 v[64:67], v1, s[28:31], s3 offen offset:1024 sc1
buffer_load_dwordx4 v[68:71], v1, s[28:31], s43 offen offset:1024 sc1
buffer_load_dwordx4 v[72:75], v1, s[28:31], s3 offen offset:2048 sc1
buffer_load_dwordx4 v[76:79], v1, s[28:31], s43 offen offset:2048 sc1
buffer_load_dwordx4 v[200:203], v6, s[28:31], s48 offen offset:0 sc1
buffer_load_dwordx4 v[80:83], v1, s[28:31], s3 offen offset:3072 sc1
ds_read_b128 v[224:227], v12 offset:0
ds_read_b128 v[228:231], v12 offset:1024
ds_read_b128 v[232:235], v12 offset:2048
ds_read_b128 v[236:239], v12 offset:3072
ds_read_b128 v[240:243], v12 offset:4096
ds_read_b128 v[244:247], v12 offset:5120
ds_read_b128 v[248:251], v12 offset:6144
s_waitcnt vmcnt(6) lgkmcnt(6)
v_mfma_f32_16x16x32_bf16 v[168:171], v[224:227], v[56:59], 0
ds_read_b128 v[252:255], v12 offset:7168
buffer_load_dwordx4 v[84:87], v1, s[28:31], s43 offen offset:3072 sc1
v_mfma_f32_16x16x32_bf16 v[184:187], v[224:227], v[60:63], 0
s_waitcnt lgkmcnt(6)
v_mfma_f32_16x16x32_bf16 v[172:175], v[228:231], v[56:59], 0
ds_read_b128 v[224:227], v12 offset:8192
buffer_load_dwordx4 v[204:207], v6, s[28:31], s48 offen offset:512 sc1
v_mfma_f32_16x16x32_bf16 v[188:191], v[228:231], v[60:63], 0
s_waitcnt lgkmcnt(6)
v_mfma_f32_16x16x32_bf16 v[176:179], v[232:235], v[56:59], 0
ds_read_b128 v[228:231], v12 offset:9216
s_add_u32 s3, s3, 4096
buffer_load_dwordx4 v[88:91], v1, s[28:31], s3 offen offset:0 sc1
v_mfma_f32_16x16x32_bf16 v[192:195], v[232:235], v[60:63], 0
s_waitcnt lgkmcnt(6)
v_mfma_f32_16x16x32_bf16 v[180:183], v[236:239], v[56:59], 0
ds_read_b128 v[232:235], v12 offset:10240
s_add_u32 s43, s43, 4096
buffer_load_dwordx4 v[92:95], v1, s[28:31], s43 offen offset:0 sc1
v_mfma_f32_16x16x32_bf16 v[196:199], v[236:239], v[60:63], 0
s_waitcnt vmcnt(8) lgkmcnt(6)
v_mfma_f32_16x16x32_bf16 v[168:171], v[240:243], v[64:67], v[168:171]
ds_read_b128 v[236:239], v12 offset:11264
buffer_load_dwordx4 v[208:211], v6, s[28:31], s48 offen offset:256 sc1
v_mfma_f32_16x16x32_bf16 v[184:187], v[240:243], v[68:71], v[184:187]
s_waitcnt lgkmcnt(6)
v_mfma_f32_16x16x32_bf16 v[172:175], v[244:247], v[64:67], v[172:175]
ds_read_b128 v[240:243], v12 offset:12288
buffer_load_dwordx4 v[96:99], v1, s[28:31], s3 offen offset:1024 sc1
v_mfma_f32_16x16x32_bf16 v[188:191], v[244:247], v[68:71], v[188:191]
s_waitcnt lgkmcnt(6)
v_mfma_f32_16x16x32_bf16 v[176:179], v[248:251], v[64:67], v[176:179]
ds_read_b128 v[244:247], v12 offset:13312
buffer_load_dwordx4 v[100:103], v1, s[28:31], s43 offen offset:1024 sc1
v_mfma_f32_16x16x32_bf16 v[192:195], v[248:251], v[68:71], v[192:195]
s_waitcnt lgkmcnt(6)
v_mfma_f32_16x16x32_bf16 v[180:183], v[252:255], v[64:67], v[180:183]
ds_read_b128 v[248:251], v12 offset:14336
v_mfma_f32_16x16x32_bf16 v[196:199], v[252:255], v[68:71], v[196:199]
s_waitcnt vmcnt(9) lgkmcnt(6)
v_mfma_f32_16x16x32_bf16 v[168:171], v[224:227], v[72:75], v[168:171]
ds_read_b128 v[252:255], v12 offset:15360
buffer_load_dwordx4 v[212:215], v6, s[28:31], s48 offen offset:768 sc1
v_mfma_f32_16x16x32_bf16 v[184:187], v[224:227], v[76:79], v[184:187]
s_waitcnt lgkmcnt(6)
v_mfma_f32_16x16x32_bf16 v[172:175], v[228:231], v[72:75], v[172:175]
ds_read_b128 v[224:227], v12 offset:16384
buffer_load_dwordx4 v[104:107], v1, s[28:31], s3 offen offset:2048 sc1
v_mfma_f32_16x16x32_bf16 v[188:191], v[228:231], v[76:79], v[188:191]
s_waitcnt lgkmcnt(6)
v_mfma_f32_16x16x32_bf16 v[176:179], v[232:235], v[72:75], v[176:179]
ds_read_b128 v[228:231], v12 offset:17408
buffer_load_dwordx4 v[108:111], v1, s[28:31], s43 offen offset:2048 sc1
v_mfma_f32_16x16x32_bf16 v[192:195], v[232:235], v[76:79], v[192:195]
s_waitcnt lgkmcnt(6)
v_mfma_f32_16x16x32_bf16 v[180:183], v[236:239], v[72:75], v[180:183]
ds_read_b128 v[232:235], v12 offset:18432
v_mfma_f32_16x16x32_bf16 v[196:199], v[236:239], v[76:79], v[196:199]
s_waitcnt vmcnt(9) lgkmcnt(6)
v_mfma_f32_16x16x32_bf16 v[168:171], v[240:243], v[80:83], v[168:171]
ds_read_b128 v[236:239], v12 offset:19456
buffer_load_dwordx4 v[112:115], v1, s[28:31], s3 offen offset:3072 sc1
v_mfma_f32_16x16x32_bf16 v[184:187], v[240:243], v[84:87], v[184:187]
s_waitcnt lgkmcnt(6)
v_mfma_f32_16x16x32_bf16 v[172:175], v[244:247], v[80:83], v[172:175]
ds_read_b128 v[240:243], v12 offset:20480
buffer_load_dwordx4 v[116:119], v1, s[28:31], s43 offen offset:3072 sc1
v_mfma_f32_16x16x32_bf16 v[188:191], v[244:247], v[84:87], v[188:191]
s_waitcnt lgkmcnt(6)
v_mfma_f32_16x16x32_bf16 v[176:179], v[248:251], v[80:83], v[176:179]
ds_read_b128 v[244:247], v12 offset:21504
v_mfma_f32_16x16x32_bf16 v[192:195], v[248:251], v[84:87], v[192:195]
s_waitcnt lgkmcnt(6)
v_mfma_f32_16x16x32_bf16 v[180:183], v[252:255], v[80:83], v[180:183]
ds_read_b128 v[248:251], v12 offset:22528
v_mfma_f32_16x16x32_bf16 v[196:199], v[252:255], v[84:87], v[196:199]
s_waitcnt vmcnt(8) lgkmcnt(6)
v_mfma_f32_16x16x32_bf16 v[168:171], v[224:227], v[88:91], v[168:171]
ds_read_b128 v[252:255], v12 offset:23552
s_add_u32 s3, s3, 4096
buffer_load_dwordx4 v[120:123], v1, s[28:31], s3 offen offset:0 sc1
v_mfma_f32_16x16x32_bf16 v[184:187], v[224:227], v[92:95], v[184:187]
s_waitcnt lgkmcnt(6)
v_mfma_f32_16x16x32_bf16 v[172:175], v[228:231], v[88:91], v[172:175]
ds_read_b128 v[224:227], v12 offset:24576
s_add_u32 s43, s43, 4096
buffer_load_dwordx4 v[124:127], v1, s[28:31], s43 offen offset:0 sc1
v_mfma_f32_16x16x32_bf16 v[188:191], v[228:231], v[92:95], v[188:191]
s_waitcnt lgkmcnt(6)
v_mfma_f32_16x16x32_bf16 v[176:179], v[232:235], v[88:91], v[176:179]
ds_read_b128 v[228:231], v12 offset:25600
v_mfma_f32_16x16x32_bf16 v[192:195], v[232:235], v[92:95], v[192:195]
s_waitcnt lgkmcnt(6)
v_mfma_f32_16x16x32_bf16 v[180:183], v[236:239], v[88:91], v[180:183]
ds_read_b128 v[232:235], v12 offset:26624
v_mfma_f32_16x16x32_bf16 v[196:199], v[236:239], v[92:95], v[196:199]
s_waitcnt vmcnt(7) lgkmcnt(6)
v_mfma_f32_16x16x32_bf16 v[168:171], v[240:243], v[96:99], v[168:171]
ds_read_b128 v[236:239], v12 offset:27648
buffer_load_dwordx4 v[128:131], v1, s[28:31], s3 offen offset:1024 sc1
v_mfma_f32_16x16x32_bf16 v[184:187], v[240:243], v[100:103], v[184:187]
s_waitcnt lgkmcnt(6)
v_mfma_f32_16x16x32_bf16 v[172:175], v[244:247], v[96:99], v[172:175]
ds_read_b128 v[240:243], v12 offset:28672
buffer_load_dwordx4 v[132:135], v1, s[28:31], s43 offen offset:1024 sc1
v_mfma_f32_16x16x32_bf16 v[188:191], v[244:247], v[100:103], v[188:191]
s_waitcnt lgkmcnt(6)
v_mfma_f32_16x16x32_bf16 v[176:179], v[248:251], v[96:99], v[176:179]
ds_read_b128 v[244:247], v12 offset:29696
v_mfma_f32_16x16x32_bf16 v[192:195], v[248:251], v[100:103], v[192:195]
s_waitcnt lgkmcnt(6)
v_mfma_f32_16x16x32_bf16 v[180:183], v[252:255], v[96:99], v[180:183]
ds_read_b128 v[248:251], v12 offset:30720
v_mfma_f32_16x16x32_bf16 v[196:199], v[252:255], v[100:103], v[196:199]
s_waitcnt vmcnt(6) lgkmcnt(6)
v_mfma_f32_16x16x32_bf16 v[168:171], v[224:227], v[104:107], v[168:171]
ds_read_b128 v[252:255], v12 offset:31744
buffer_load_dwordx4 v[136:139], v1, s[28:31], s3 offen offset:2048 sc1
v_mfma_f32_16x16x32_bf16 v[184:187], v[224:227], v[108:111], v[184:187]
v_add_f32 v200, v200, v202
v_add_f32 v204, v204, v206
s_waitcnt lgkmcnt(6)
v_mfma_f32_16x16x32_bf16 v[172:175], v[228:231], v[104:107], v[172:175]
ds_read_b128 v[224:227], v12 offset:32768
buffer_load_dwordx4 v[140:143], v1, s[28:31], s43 offen offset:2048 sc1
v_mfma_f32_16x16x32_bf16 v[188:191], v[228:231], v[108:111], v[188:191]
v_add_f32 v201, v201, v203
v_add_f32 v205, v205, v207
s_waitcnt lgkmcnt(6)
v_mfma_f32_16x16x32_bf16 v[176:179], v[232:235], v[104:107], v[176:179]
ds_read_b128 v[228:231], v12 offset:33792
v_mfma_f32_16x16x32_bf16 v[192:195], v[232:235], v[108:111], v[192:195]
v_add_f32 v200, v200, v204
v_add_f32 v201, v201, v205
s_waitcnt lgkmcnt(6)
v_mfma_f32_16x16x32_bf16 v[180:183], v[236:239], v[104:107], v[180:183]
ds_read_b128 v[232:235], v12 offset:34816
v_mfma_f32_16x16x32_bf16 v[196:199], v[236:239], v[108:111], v[196:199]
v_mov_b32 v202, v200
v_mov_b32 v203, v201
s_waitcnt vmcnt(6) lgkmcnt(6)
v_mfma_f32_16x16x32_bf16 v[168:171], v[240:243], v[112:115], v[168:171]
ds_read_b128 v[236:239], v12 offset:35840
buffer_load_dwordx4 v[144:147], v1, s[28:31], s3 offen offset:3072 sc1
v_mfma_f32_16x16x32_bf16 v[184:187], v[240:243], v[116:119], v[184:187]
v_permlane16_swap_b32 v200, v202
v_permlane16_swap_b32 v201, v203
s_waitcnt lgkmcnt(6)
v_mfma_f32_16x16x32_bf16 v[172:175], v[244:247], v[112:115], v[172:175]
ds_read_b128 v[240:243], v12 offset:36864
buffer_load_dwordx4 v[148:151], v1, s[28:31], s43 offen offset:3072 sc1
v_mfma_f32_16x16x32_bf16 v[188:191], v[244:247], v[116:119], v[188:191]
v_add_f32 v200, v200, v202
v_add_f32 v201, v201, v203
s_waitcnt lgkmcnt(6)
v_mfma_f32_16x16x32_bf16 v[176:179], v[248:251], v[112:115], v[176:179]
ds_read_b128 v[244:247], v12 offset:37888
v_mfma_f32_16x16x32_bf16 v[192:195], v[248:251], v[116:119], v[192:195]
v_mov_b32 v202, v200
v_mov_b32 v203, v201
s_waitcnt lgkmcnt(6)
v_mfma_f32_16x16x32_bf16 v[180:183], v[252:255], v[112:115], v[180:183]
ds_read_b128 v[248:251], v12 offset:38912
v_mfma_f32_16x16x32_bf16 v[196:199], v[252:255], v[116:119], v[196:199]
v_permlane32_swap_b32 v200, v202
v_permlane32_swap_b32 v201, v203
s_waitcnt vmcnt(6) lgkmcnt(6)
v_mfma_f32_16x16x32_bf16 v[168:171], v[224:227], v[120:123], v[168:171]
ds_read_b128 v[252:255], v12 offset:39936
s_add_u32 s3, s3, 4096
buffer_load_dwordx4 v[152:155], v1, s[28:31], s3 offen offset:0 sc1
v_mfma_f32_16x16x32_bf16 v[184:187], v[224:227], v[124:127], v[184:187]
v_add_f32 v200, v200, v202
v_add_f32 v201, v201, v203
s_waitcnt lgkmcnt(6)
v_mfma_f32_16x16x32_bf16 v[172:175], v[228:231], v[120:123], v[172:175]
ds_read_b128 v[224:227], v12 offset:40960
s_add_u32 s43, s43, 4096
buffer_load_dwordx4 v[156:159], v1, s[28:31], s43 offen offset:0 sc1
v_mfma_f32_16x16x32_bf16 v[188:191], v[228:231], v[124:127], v[188:191]
v_mul_f32 v200, 0xbb124925, v200
v_mul_f32 v201, 0x3b124925, v201
s_waitcnt lgkmcnt(6)
v_mfma_f32_16x16x32_bf16 v[176:179], v[232:235], v[120:123], v[176:179]
ds_read_b128 v[228:231], v12 offset:41984
v_mfma_f32_16x16x32_bf16 v[192:195], v[232:235], v[124:127], v[192:195]
v_fma_f32 v201, -v200, v200, v201
v_max_f32 v201, 0, v201
s_waitcnt lgkmcnt(6)
v_mfma_f32_16x16x32_bf16 v[180:183], v[236:239], v[120:123], v[180:183]
ds_read_b128 v[232:235], v12 offset:43008
v_mfma_f32_16x16x32_bf16 v[196:199], v[236:239], v[124:127], v[196:199]
v_add_f32 v201, 0x3727c5ac, v201
v_rsq_f32 v202, v201
s_waitcnt vmcnt(6) lgkmcnt(6)
v_mfma_f32_16x16x32_bf16 v[168:171], v[240:243], v[128:131], v[168:171]
ds_read_b128 v[236:239], v12 offset:44032
buffer_load_dwordx4 v[160:163], v1, s[28:31], s3 offen offset:1024 sc1
v_mfma_f32_16x16x32_bf16 v[184:187], v[240:243], v[132:135], v[184:187]
v_mov_b32 v2, v200
v_add_f32 v208, v208, v210
s_waitcnt lgkmcnt(6)
v_mfma_f32_16x16x32_bf16 v[172:175], v[244:247], v[128:131], v[172:175]
ds_read_b128 v[240:243], v12 offset:45056
buffer_load_dwordx4 v[164:167], v1, s[28:31], s43 offen offset:1024 sc1
v_mfma_f32_16x16x32_bf16 v[188:191], v[244:247], v[132:135], v[188:191]
v_add_f32 v212, v212, v214
v_add_f32 v209, v209, v211
s_waitcnt lgkmcnt(6)
v_mfma_f32_16x16x32_bf16 v[176:179], v[248:251], v[128:131], v[176:179]
ds_read_b128 v[244:247], v12 offset:46080
v_mfma_f32_16x16x32_bf16 v[192:195], v[248:251], v[132:135], v[192:195]
v_add_f32 v213, v213, v215
v_add_f32 v208, v208, v212
s_waitcnt lgkmcnt(6)
v_mfma_f32_16x16x32_bf16 v[180:183], v[252:255], v[128:131], v[180:183]
ds_read_b128 v[248:251], v12 offset:47104
v_mfma_f32_16x16x32_bf16 v[196:199], v[252:255], v[132:135], v[196:199]
v_add_f32 v209, v209, v213
v_mov_b32 v210, v208
s_waitcnt vmcnt(6) lgkmcnt(6)
v_mfma_f32_16x16x32_bf16 v[168:171], v[224:227], v[136:139], v[168:171]
ds_read_b128 v[252:255], v12 offset:48128
v_mfma_f32_16x16x32_bf16 v[184:187], v[224:227], v[140:143], v[184:187]
v_mov_b32 v211, v209
v_permlane16_swap_b32 v208, v210
s_barrier
s_waitcnt lgkmcnt(6)
v_mfma_f32_16x16x32_bf16 v[172:175], v[228:231], v[136:139], v[172:175]
ds_read_b128 v[224:227], v12 offset:49152
v_mfma_f32_16x16x32_bf16 v[188:191], v[228:231], v[140:143], v[188:191]
v_permlane16_swap_b32 v209, v211
v_add_f32 v208, v208, v210
s_waitcnt lgkmcnt(6)
v_mfma_f32_16x16x32_bf16 v[176:179], v[232:235], v[136:139], v[176:179]
ds_read_b128 v[228:231], v12 offset:50176
v_mfma_f32_16x16x32_bf16 v[192:195], v[232:235], v[140:143], v[192:195]
v_add_f32 v209, v209, v211
v_mov_b32 v210, v208
s_waitcnt lgkmcnt(6)
v_mfma_f32_16x16x32_bf16 v[180:183], v[236:239], v[136:139], v[180:183]
ds_read_b128 v[232:235], v12 offset:51200
v_mfma_f32_16x16x32_bf16 v[196:199], v[236:239], v[140:143], v[196:199]
v_mov_b32 v211, v209
v_permlane32_swap_b32 v208, v210
s_waitcnt vmcnt(4) lgkmcnt(6)
v_mfma_f32_16x16x32_bf16 v[168:171], v[240:243], v[144:147], v[168:171]
ds_read_b128 v[236:239], v12 offset:52224
v_mfma_f32_16x16x32_bf16 v[184:187], v[240:243], v[148:151], v[184:187]
v_permlane32_swap_b32 v209, v211
v_add_f32 v208, v208, v210
s_waitcnt lgkmcnt(6)
v_mfma_f32_16x16x32_bf16 v[172:175], v[244:247], v[144:147], v[172:175]
ds_read_b128 v[240:243], v12 offset:53248
v_mfma_f32_16x16x32_bf16 v[188:191], v[244:247], v[148:151], v[188:191]
v_add_f32 v209, v209, v211
v_mul_f32 v208, 0xbb124925, v208
s_waitcnt lgkmcnt(6)
v_mfma_f32_16x16x32_bf16 v[176:179], v[248:251], v[144:147], v[176:179]
ds_read_b128 v[244:247], v12 offset:54272
v_mfma_f32_16x16x32_bf16 v[192:195], v[248:251], v[148:151], v[192:195]
v_mul_f32 v209, 0x3b124925, v209
v_fma_f32 v209, -v208, v208, v209
s_waitcnt lgkmcnt(6)
v_mfma_f32_16x16x32_bf16 v[180:183], v[252:255], v[144:147], v[180:183]
ds_read_b128 v[248:251], v12 offset:55296
v_mfma_f32_16x16x32_bf16 v[196:199], v[252:255], v[148:151], v[196:199]
v_max_f32 v209, 0, v209
v_add_f32 v209, 0x3727c5ac, v209
s_waitcnt vmcnt(2) lgkmcnt(6)
v_mfma_f32_16x16x32_bf16 v[168:171], v[224:227], v[152:155], v[168:171]
ds_read_b128 v[252:255], v12 offset:56320
v_mfma_f32_16x16x32_bf16 v[184:187], v[224:227], v[156:159], v[184:187]
v_rsq_f32 v210, v209
v_mov_b32 v3, v208
s_waitcnt lgkmcnt(6)
v_mfma_f32_16x16x32_bf16 v[172:175], v[228:231], v[152:155], v[172:175]
v_mfma_f32_16x16x32_bf16 v[188:191], v[228:231], v[156:159], v[188:191]
s_waitcnt lgkmcnt(5)
v_mfma_f32_16x16x32_bf16 v[176:179], v[232:235], v[152:155], v[176:179]
v_mfma_f32_16x16x32_bf16 v[192:195], v[232:235], v[156:159], v[192:195]
s_waitcnt lgkmcnt(4)
v_mfma_f32_16x16x32_bf16 v[180:183], v[236:239], v[152:155], v[180:183]
v_mfma_f32_16x16x32_bf16 v[196:199], v[236:239], v[156:159], v[196:199]
s_waitcnt vmcnt(0) lgkmcnt(3)
v_mfma_f32_16x16x32_bf16 v[168:171], v[240:243], v[160:163], v[168:171]
v_mfma_f32_16x16x32_bf16 v[184:187], v[240:243], v[164:167], v[184:187]
s_waitcnt lgkmcnt(2)
v_mfma_f32_16x16x32_bf16 v[172:175], v[244:247], v[160:163], v[172:175]
v_mfma_f32_16x16x32_bf16 v[188:191], v[244:247], v[164:167], v[188:191]
s_waitcnt lgkmcnt(1)
v_mfma_f32_16x16x32_bf16 v[176:179], v[248:251], v[160:163], v[176:179]
v_mfma_f32_16x16x32_bf16 v[192:195], v[248:251], v[164:167], v[192:195]
s_waitcnt lgkmcnt(0)
v_mfma_f32_16x16x32_bf16 v[180:183], v[252:255], v[160:163], v[180:183]
v_mfma_f32_16x16x32_bf16 v[196:199], v[252:255], v[164:167], v[196:199]
ds_write_b32 v8, v202
ds_write_b32 v8, v210 offset:64
v_add_u32 v12, 57344, v12
v_and_b32 v4, 48, v0
v_add_u32 v4, 158080, v4
ds_read_b128 v[240:243], v4 offset:0
ds_read_b128 v[244:247], v4 offset:64
ds_read_b128 v[248:251], v4 offset:128
ds_read_b128 v[252:255], v4 offset:192
ds_read_b128 v[224:227], v12 offset:0
ds_read_b128 v[228:231], v12 offset:1024
ds_read_b128 v[232:235], v12 offset:2048
v_mov_b32 v6, v3
s_waitcnt lgkmcnt(3)
v_pk_fma_f32 v[168:169], v[240:241], v[2:3], v[168:169] op_sel_hi:[1,0,1]
v_pk_fma_f32 v[170:171], v[242:243], v[2:3], v[170:171] op_sel_hi:[1,0,1]
v_pk_fma_f32 v[172:173], v[244:245], v[2:3], v[172:173] op_sel_hi:[1,0,1]
v_pk_fma_f32 v[174:175], v[246:247], v[2:3], v[174:175] op_sel_hi:[1,0,1]
v_pk_fma_f32 v[176:177], v[248:249], v[2:3], v[176:177] op_sel_hi:[1,0,1]
v_pk_fma_f32 v[178:179], v[250:251], v[2:3], v[178:179] op_sel_hi:[1,0,1]
v_pk_fma_f32 v[180:181], v[252:253], v[2:3], v[180:181] op_sel_hi:[1,0,1]
v_pk_fma_f32 v[182:183], v[254:255], v[2:3], v[182:183] op_sel_hi:[1,0,1]
v_pk_fma_f32 v[184:185], v[240:241], v[6:7], v[184:185] op_sel_hi:[1,0,1]
v_pk_fma_f32 v[186:187], v[242:243], v[6:7], v[186:187] op_sel_hi:[1,0,1]
v_pk_fma_f32 v[188:189], v[244:245], v[6:7], v[188:189] op_sel_hi:[1,0,1]
v_pk_fma_f32 v[190:191], v[246:247], v[6:7], v[190:191] op_sel_hi:[1,0,1]
v_pk_fma_f32 v[192:193], v[248:249], v[6:7], v[192:193] op_sel_hi:[1,0,1]
v_pk_fma_f32 v[194:195], v[250:251], v[6:7], v[194:195] op_sel_hi:[1,0,1]
v_pk_fma_f32 v[196:197], v[252:253], v[6:7], v[196:197] op_sel_hi:[1,0,1]
v_pk_fma_f32 v[198:199], v[254:255], v[6:7], v[198:199] op_sel_hi:[1,0,1]
v_cvt_pk_bf16_f32 v168, v168, v169
v_cvt_pk_bf16_f32 v169, v170, v171
v_cvt_pk_bf16_f32 v170, v172, v173
v_cvt_pk_bf16_f32 v171, v174, v175
v_pk_max_i16 v168, v168, 0
v_pk_max_i16 v169, v169, 0
v_pk_max_i16 v170, v170, 0
v_pk_max_i16 v171, v171, 0
v_cvt_pk_bf16_f32 v176, v176, v177
v_cvt_pk_bf16_f32 v177, v178, v179
v_cvt_pk_bf16_f32 v178, v180, v181
v_cvt_pk_bf16_f32 v179, v182, v183
v_pk_max_i16 v176, v176, 0
v_pk_max_i16 v177, v177, 0
v_pk_max_i16 v178, v178, 0
v_pk_max_i16 v179, v179, 0
v_cvt_pk_bf16_f32 v184, v184, v185
v_cvt_pk_bf16_f32 v185, v186, v187
v_cvt_pk_bf16_f32 v186, v188, v189
v_cvt_pk_bf16_f32 v187, v190, v191
v_pk_max_i16 v184, v184, 0
v_pk_max_i16 v185, v185, 0
v_pk_max_i16 v186, v186, 0
v_pk_max_i16 v187, v187, 0
v_cvt_pk_bf16_f32 v192, v192, v193
v_cvt_pk_bf16_f32 v193, v194, v195
v_cvt_pk_bf16_f32 v194, v196, v197
v_cvt_pk_bf16_f32 v195, v198, v199
v_pk_max_i16 v192, v192, 0
v_pk_max_i16 v193, v193, 0
v_pk_max_i16 v194, v194, 0
v_pk_max_i16 v195, v195, 0
buffer_store_dwordx4 v[168:171], v10, s[28:31], s50 offen offset:0 sc1
buffer_store_dwordx4 v[184:187], v10, s[28:31], s50 offen offset:256 sc1
buffer_store_dwordx4 v[176:179], v10, s[28:31], s50 offen offset:2048 sc1
buffer_store_dwordx4 v[192:195], v10, s[28:31], s50 offen offset:2304 sc1
ds_read_b128 v[244:247], v4 offset:256
ds_read_b128 v[248:251], v4 offset:320
ds_read_b128 v[252:255], v4 offset:384
s_waitcnt lgkmcnt(0)
s_waitcnt lgkmcnt(2)
v_mfma_f32_16x16x32_bf16 v[200:203], v[224:227], v[56:59], 0
ds_read_b128 v[236:239], v12 offset:3072
v_mfma_f32_16x16x32_bf16 v[212:215], v[224:227], v[60:63], 0
s_xor_b32 s52, s98, 1
s_mul_i32 s52, s52, 114688
s_waitcnt lgkmcnt(2)
v_mfma_f32_16x16x32_bf16 v[204:207], v[228:231], v[56:59], 0
ds_read_b128 v[224:227], v12 offset:4096
v_mfma_f32_16x16x32_bf16 v[216:219], v[228:231], v[60:63], 0
s_mul_i32 s53, s98, 114688
s_mul_i32 s54, s38, 28672
s_waitcnt lgkmcnt(2)
v_mfma_f32_16x16x32_bf16 v[208:211], v[232:235], v[56:59], 0
ds_read_b128 v[228:231], v12 offset:5120
v_mfma_f32_16x16x32_bf16 v[220:223], v[232:235], v[60:63], 0
s_add_u32 s54, s54, 33554432
s_add_u32 s52, s52, s54
s_waitcnt lgkmcnt(2)
v_mfma_f32_16x16x32_bf16 v[200:203], v[236:239], v[64:67], v[200:203]
ds_read_b128 v[232:235], v12 offset:6144
v_mfma_f32_16x16x32_bf16 v[212:215], v[236:239], v[68:71], v[212:215]
s_add_u32 s53, s53, s54
v_and_b32 v8, 3, v0
s_waitcnt lgkmcnt(2)
v_mfma_f32_16x16x32_bf16 v[204:207], v[224:227], v[64:67], v[204:207]
ds_read_b128 v[236:239], v12 offset:7168
v_mfma_f32_16x16x32_bf16 v[216:219], v[224:227], v[68:71], v[216:219]
v_lshlrev_b32 v8, 3, v8
v_bfe_u32 v5, v0, 2, 1
s_waitcnt lgkmcnt(2)
v_mfma_f32_16x16x32_bf16 v[208:211], v[228:231], v[64:67], v[208:211]
ds_read_b128 v[224:227], v12 offset:8192
v_mfma_f32_16x16x32_bf16 v[220:223], v[228:231], v[68:71], v[220:223]
v_lshl_add_u32 v8, v5, 7, v8
s_andn2_b32 s47, s98, 1
s_waitcnt lgkmcnt(2)
v_mfma_f32_16x16x32_bf16 v[200:203], v[232:235], v[72:75], v[200:203]
ds_read_b128 v[228:231], v12 offset:9216
v_mfma_f32_16x16x32_bf16 v[212:215], v[232:235], v[76:79], v[212:215]
s_lshl_b32 s47, s47, 7
s_lshl_b32 s46, s38, 5
s_waitcnt lgkmcnt(2)
v_mfma_f32_16x16x32_bf16 v[204:207], v[236:239], v[72:75], v[204:207]
ds_read_b128 v[232:235], v12 offset:10240
v_mfma_f32_16x16x32_bf16 v[216:219], v[236:239], v[76:79], v[216:219]
s_add_u32 s47, s47, s46
s_add_u32 s47, s47, 24576
s_waitcnt lgkmcnt(2)
v_mfma_f32_16x16x32_bf16 v[208:211], v[224:227], v[72:75], v[208:211]
ds_read_b128 v[236:239], v12 offset:11264
v_mfma_f32_16x16x32_bf16 v[220:223], v[224:227], v[76:79], v[220:223]
s_waitcnt lgkmcnt(2)
v_mfma_f32_16x16x32_bf16 v[200:203], v[228:231], v[80:83], v[200:203]
ds_read_b128 v[224:227], v12 offset:12288
v_mfma_f32_16x16x32_bf16 v[212:215], v[228:231], v[84:87], v[212:215]
s_waitcnt lgkmcnt(2)
v_mfma_f32_16x16x32_bf16 v[204:207], v[232:235], v[80:83], v[204:207]
ds_read_b128 v[228:231], v12 offset:13312
v_mfma_f32_16x16x32_bf16 v[216:219], v[232:235], v[84:87], v[216:219]
s_waitcnt lgkmcnt(2)
v_mfma_f32_16x16x32_bf16 v[208:211], v[236:239], v[80:83], v[208:211]
ds_read_b128 v[232:235], v12 offset:14336
v_mfma_f32_16x16x32_bf16 v[220:223], v[236:239], v[84:87], v[220:223]
s_waitcnt lgkmcnt(2)
v_mfma_f32_16x16x32_bf16 v[200:203], v[224:227], v[88:91], v[200:203]
ds_read_b128 v[236:239], v12 offset:15360
v_mfma_f32_16x16x32_bf16 v[212:215], v[224:227], v[92:95], v[212:215]
s_waitcnt lgkmcnt(2)
v_mfma_f32_16x16x32_bf16 v[204:207], v[228:231], v[88:91], v[204:207]
ds_read_b128 v[224:227], v12 offset:16384
v_mfma_f32_16x16x32_bf16 v[216:219], v[228:231], v[92:95], v[216:219]
v_mov_b32 v242, s44
v_mov_b32 v243, s45
v_mov_b32 v241, 0
s_mov_b64 exec, 1
s_cmp_eq_u32 s39, 0
s_cbranch_scc1 L_slow_130
s_waitcnt vmcnt(0)
buffer_store_dwordx2 v[242:243], v241, s[28:31], s55 offen
L_stored_131:
s_mov_b64 exec, -1
s_waitcnt lgkmcnt(2)
v_mfma_f32_16x16x32_bf16 v[208:211], v[232:235], v[88:91], v[208:211]
ds_read_b128 v[228:231], v12 offset:17408
v_mfma_f32_16x16x32_bf16 v[220:223], v[232:235], v[92:95], v[220:223]
s_waitcnt lgkmcnt(2)
v_mfma_f32_16x16x32_bf16 v[200:203], v[236:239], v[96:99], v[200:203]
ds_read_b128 v[232:235], v12 offset:18432
v_mfma_f32_16x16x32_bf16 v[212:215], v[236:239], v[100:103], v[212:215]
s_waitcnt lgkmcnt(2)
v_mfma_f32_16x16x32_bf16 v[204:207], v[224:227], v[96:99], v[204:207]
ds_read_b128 v[236:239], v12 offset:19456
v_mfma_f32_16x16x32_bf16 v[216:219], v[224:227], v[100:103], v[216:219]
s_waitcnt lgkmcnt(2)
v_mfma_f32_16x16x32_bf16 v[208:211], v[228:231], v[96:99], v[208:211]
ds_read_b128 v[224:227], v12 offset:20480
v_mfma_f32_16x16x32_bf16 v[220:223], v[228:231], v[100:103], v[220:223]
s_waitcnt lgkmcnt(2)
v_mfma_f32_16x16x32_bf16 v[200:203], v[232:235], v[104:107], v[200:203]
ds_read_b128 v[228:231], v12 offset:21504
v_mfma_f32_16x16x32_bf16 v[212:215], v[232:235], v[108:111], v[212:215]
s_waitcnt lgkmcnt(2)
v_mfma_f32_16x16x32_bf16 v[204:207], v[236:239], v[104:107], v[204:207]
ds_read_b128 v[232:235], v12 offset:22528
v_mfma_f32_16x16x32_bf16 v[216:219], v[236:239], v[108:111], v[216:219]
s_waitcnt lgkmcnt(2)
v_mfma_f32_16x16x32_bf16 v[208:211], v[224:227], v[104:107], v[208:211]
ds_read_b128 v[236:239], v12 offset:23552
v_mfma_f32_16x16x32_bf16 v[220:223], v[224:227], v[108:111], v[220:223]
s_waitcnt lgkmcnt(2)
v_mfma_f32_16x16x32_bf16 v[200:203], v[228:231], v[112:115], v[200:203]
ds_read_b128 v[224:227], v12 offset:24576
v_mfma_f32_16x16x32_bf16 v[212:215], v[228:231], v[116:119], v[212:215]
s_waitcnt lgkmcnt(2)
v_mfma_f32_16x16x32_bf16 v[204:207], v[232:235], v[112:115], v[204:207]
ds_read_b128 v[228:231], v12 offset:25600
v_mfma_f32_16x16x32_bf16 v[216:219], v[232:235], v[116:119], v[216:219]
s_waitcnt lgkmcnt(2)
v_mfma_f32_16x16x32_bf16 v[208:211], v[236:239], v[112:115], v[208:211]
ds_read_b128 v[232:235], v12 offset:26624
v_mfma_f32_16x16x32_bf16 v[220:223], v[236:239], v[116:119], v[220:223]
s_waitcnt lgkmcnt(2)
v_mfma_f32_16x16x32_bf16 v[200:203], v[224:227], v[120:123], v[200:203]
ds_read_b128 v[236:239], v12 offset:27648
v_mfma_f32_16x16x32_bf16 v[212:215], v[224:227], v[124:127], v[212:215]
s_waitcnt lgkmcnt(2)
v_mfma_f32_16x16x32_bf16 v[204:207], v[228:231], v[120:123], v[204:207]
ds_read_b128 v[224:227], v12 offset:28672
v_mfma_f32_16x16x32_bf16 v[216:219], v[228:231], v[124:127], v[216:219]
s_waitcnt lgkmcnt(2)
v_mfma_f32_16x16x32_bf16 v[208:211], v[232:235], v[120:123], v[208:211]
ds_read_b128 v[228:231], v12 offset:29696
v_mfma_f32_16x16x32_bf16 v[220:223], v[232:235], v[124:127], v[220:223]
s_waitcnt lgkmcnt(2)
v_mfma_f32_16x16x32_bf16 v[200:203], v[236:239], v[128:131], v[200:203]
ds_read_b128 v[232:235], v12 offset:30720
v_mfma_f32_16x16x32_bf16 v[212:215], v[236:239], v[132:135], v[212:215]
s_mov_b64 exec, 0xff
buffer_load_dwordx2 v[240:241], v8, s[28:31], s47 offen sc1
s_mov_b64 exec, -1
s_waitcnt lgkmcnt(2)
v_mfma_f32_16x16x32_bf16 v[204:207], v[224:227], v[128:131], v[204:207]
ds_read_b128 v[236:239], v12 offset:31744
v_mfma_f32_16x16x32_bf16 v[216:219], v[224:227], v[132:135], v[216:219]
s_waitcnt lgkmcnt(2)
v_mfma_f32_16x16x32_bf16 v[208:211], v[228:231], v[128:131], v[208:211]
ds_read_b128 v[224:227], v12 offset:32768
v_mfma_f32_16x16x32_bf16 v[220:223], v[228:231], v[132:135], v[220:223]
s_waitcnt lgkmcnt(2)
v_mfma_f32_16x16x32_bf16 v[200:203], v[232:235], v[136:139], v[200:203]
ds_read_b128 v[228:231], v12 offset:33792
v_mfma_f32_16x16x32_bf16 v[212:215], v[232:235], v[140:143], v[212:215]
s_waitcnt lgkmcnt(2)
v_mfma_f32_16x16x32_bf16 v[204:207], v[236:239], v[136:139], v[204:207]
ds_read_b128 v[232:235], v12 offset:34816
v_mfma_f32_16x16x32_bf16 v[216:219], v[236:239], v[140:143], v[216:219]
s_waitcnt lgkmcnt(2)
v_mfma_f32_16x16x32_bf16 v[208:211], v[224:227], v[136:139], v[208:211]
ds_read_b128 v[236:239], v12 offset:35840
v_mfma_f32_16x16x32_bf16 v[220:223], v[224:227], v[140:143], v[220:223]
s_waitcnt lgkmcnt(2)
v_mfma_f32_16x16x32_bf16 v[200:203], v[228:231], v[144:147], v[200:203]
ds_read_b128 v[224:227], v12 offset:36864
v_mfma_f32_16x16x32_bf16 v[212:215], v[228:231], v[148:151], v[212:215]
s_waitcnt lgkmcnt(2)
v_mfma_f32_16x16x32_bf16 v[204:207], v[232:235], v[144:147], v[204:207]
ds_read_b128 v[228:231], v12 offset:37888
v_mfma_f32_16x16x32_bf16 v[216:219], v[232:235], v[148:151], v[216:219]
s_waitcnt lgkmcnt(2)
v_mfma_f32_16x16x32_bf16 v[208:211], v[236:239], v[144:147], v[208:211]
ds_read_b128 v[232:235], v12 offset:38912
v_mfma_f32_16x16x32_bf16 v[220:223], v[236:239], v[148:151], v[220:223]
s_waitcnt lgkmcnt(2)
v_mfma_f32_16x16x32_bf16 v[200:203], v[224:227], v[152:155], v[200:203]
ds_read_b128 v[236:239], v12 offset:39936
v_mfma_f32_16x16x32_bf16 v[212:215], v[224:227], v[156:159], v[212:215]
s_waitcnt lgkmcnt(2)
v_mfma_f32_16x16x32_bf16 v[204:207], v[228:231], v[152:155], v[204:207]
ds_read_b128 v[224:227], v12 offset:40960
v_mfma_f32_16x16x32_bf16 v[216:219], v[228:231], v[156:159], v[216:219]
s_waitcnt vmcnt(0)
s_mov_b64 exec, 0xff
v_cmp_ne_u64 vcc, s[44:45], v[240:241]
s_cbranch_vccnz L_chk_132
L_chkok_133:
s_mov_b64 exec, -1
s_waitcnt lgkmcnt(2)
v_mfma_f32_16x16x32_bf16 v[208:211], v[232:235], v[152:155], v[208:211]
ds_read_b128 v[228:231], v12 offset:41984
s_add_u32 s57, s52, 0
buffer_load_dwordx4 v[120:123], v1, s[28:31], s57 offen offset:0 sc1
v_mfma_f32_16x16x32_bf16 v[220:223], v[232:235], v[156:159], v[220:223]
s_add_u32 s57, s52, 0
buffer_load_dwordx4 v[124:127], v1, s[28:31], s57 offen offset:1024 sc1
s_waitcnt lgkmcnt(2)
v_mfma_f32_16x16x32_bf16 v[200:203], v[236:239], v[160:163], v[200:203]
s_add_u32 s57, s52, 0
buffer_load_dwordx4 v[128:131], v1, s[28:31], s57 offen offset:2048 sc1
v_mfma_f32_16x16x32_bf16 v[212:215], v[236:239], v[164:167], v[212:215]
s_add_u32 s57, s52, 0
buffer_load_dwordx4 v[132:135], v1, s[28:31], s57 offen offset:3072 sc1
s_waitcnt lgkmcnt(1)
v_mfma_f32_16x16x32_bf16 v[204:207], v[224:227], v[160:163], v[204:207]
s_add_u32 s57, s52, 4096
buffer_load_dwordx4 v[136:139], v1, s[28:31], s57 offen offset:3072 sc1
v_mfma_f32_16x16x32_bf16 v[216:219], v[224:227], v[164:167], v[216:219]
s_add_u32 s57, s52, 8192
buffer_load_dwordx4 v[140:143], v1, s[28:31], s57 offen offset:0 sc1
s_waitcnt lgkmcnt(0)
v_mfma_f32_16x16x32_bf16 v[208:211], v[228:231], v[160:163], v[208:211]
s_add_u32 s57, s52, 8192
buffer_load_dwordx4 v[144:147], v1, s[28:31], s57 offen offset:1024 sc1
v_mfma_f32_16x16x32_bf16 v[220:223], v[228:231], v[164:167], v[220:223]
s_add_u32 s57, s52, 8192
buffer_load_dwordx4 v[148:151], v1, s[28:31], s57 offen offset:2048 sc1
s_waitcnt lgkmcnt(0)
v_pk_fma_f32 v[200:201], v[244:245], v[2:3], v[200:201] op_sel_hi:[1,0,1]
v_pk_fma_f32 v[202:203], v[246:247], v[2:3], v[202:203] op_sel_hi:[1,0,1]
v_pk_fma_f32 v[204:205], v[248:249], v[2:3], v[204:205] op_sel_hi:[1,0,1]
v_pk_fma_f32 v[206:207], v[250:251], v[2:3], v[206:207] op_sel_hi:[1,0,1]
v_pk_fma_f32 v[208:209], v[252:253], v[2:3], v[208:209] op_sel_hi:[1,0,1]
v_pk_fma_f32 v[210:211], v[254:255], v[2:3], v[210:211] op_sel_hi:[1,0,1]
v_cvt_pk_bf16_f32 v200, v200, v201
v_cvt_pk_bf16_f32 v201, v202, v203
v_cvt_pk_bf16_f32 v202, v204, v205
v_cvt_pk_bf16_f32 v203, v206, v207
v_cvt_pk_bf16_f32 v204, v208, v209
v_cvt_pk_bf16_f32 v205, v210, v211
v_pk_max_i16 v200, v200, 0
v_pk_max_i16 v201, v201, 0
v_pk_max_i16 v202, v202, 0
v_pk_max_i16 v203, v203, 0
v_pk_max_i16 v204, v204, 0
v_pk_max_i16 v205, v205, 0
v_pk_fma_f32 v[212:213], v[244:245], v[6:7], v[212:213] op_sel_hi:[1,0,1]
v_pk_fma_f32 v[214:215], v[246:247], v[6:7], v[214:215] op_sel_hi:[1,0,1]
v_pk_fma_f32 v[216:217], v[248:249], v[6:7], v[216:217] op_sel_hi:[1,0,1]
v_pk_fma_f32 v[218:219], v[250:251], v[6:7], v[218:219] op_sel_hi:[1,0,1]
v_pk_fma_f32 v[220:221], v[252:253], v[6:7], v[220:221] op_sel_hi:[1,0,1]
v_pk_fma_f32 v[222:223], v[254:255], v[6:7], v[222:223] op_sel_hi:[1,0,1]
v_cvt_pk_bf16_f32 v212, v212, v213
v_cvt_pk_bf16_f32 v213, v214, v215
v_cvt_pk_bf16_f32 v214, v216, v217
v_cvt_pk_bf16_f32 v215, v218, v219
v_cvt_pk_bf16_f32 v216, v220, v221
v_cvt_pk_bf16_f32 v217, v222, v223
v_pk_max_i16 v212, v212, 0
v_pk_max_i16 v213, v213, 0
v_pk_max_i16 v214, v214, 0
v_pk_max_i16 v215, v215, 0
v_pk_max_i16 v216, v216, 0
v_pk_max_i16 v217, v217, 0
buffer_store_dwordx4 v[200:203], v10, s[28:31], s51 offen offset:0 sc1
buffer_store_dwordx2 v[204:205], v11, s[28:31], s51 offen offset:2048 sc1
buffer_store_dwordx4 v[212:215], v10, s[28:31], s51 offen offset:256 sc1
buffer_store_dwordx2 v[216:217], v11, s[28:31], s51 offen offset:2304 sc1
s_add_u32 s56, s55, 16384
s_mov_b32 s96, s51
s_barrier
ds_read_b32 v13, v9
s_add_u32 s57, s52, 12288
buffer_load_dwordx4 v[152:155], v1, s[28:31], s57 offen offset:2048 sc1
s_add_u32 s57, s52, 12288
buffer_load_dwordx4 v[156:159], v1, s[28:31], s57 offen offset:3072 sc1
v_and_b32 v7, 31, v0
v_lshrrev_b32 v4, 5, v0
s_mul_i32 s3, s41, 7
s_lshl_b32 s48, s99, 2
s_add_u32 s3, s3, s48
v_mul_u32_u24 v5, 896, v7
v_lshl_add_u32 v5, v4, 3, v5
s_lshl_b32 s3, s3, 4
s_mul_i32 s48, s98, 28672
s_add_u32 s3, s3, s48
s_add_u32 s3, s3, 0
v_lshlrev_b32 v7, 4, v7
s_mul_i32 s48, s38, 12288
s_add_u32 s48, s48, 107520
v_add_u32 v8, s48, v1
s_sub_u32 s50, s99, 1
s_mov_b32 s51, s50
v_and_b32 v9, 3, v0
v_lshlrev_b32 v9, 3, v9
v_bfe_u32 v3, v0, 2, 1
v_lshl_add_u32 v9, v3, 7, v9
s_andn2_b32 s47, s98, 1
s_lshl_b32 s47, s47, 7
s_lshl_b32 s48, s38, 5
s_add_u32 s47, s47, s48
s_waitcnt vmcnt(13)
v_mfma_f32_32x32x16_bf16 v[88:103], a[0:3], v[120:123], 0
s_add_u32 s57, s52, 16384
buffer_load_dwordx4 v[160:163], v1, s[28:31], s57 offen offset:0 sc1
v_mfma_f32_32x32x16_bf16 v[104:119], a[4:7], v[120:123], 0
s_waitcnt vmcnt(13)
v_mfma_f32_32x32x16_bf16 v[88:103], a[8:11], v[124:127], v[88:103]
s_add_u32 s57, s52, 16384
buffer_load_dwordx4 v[164:167], v1, s[28:31], s57 offen offset:1024 sc1
v_mfma_f32_32x32x16_bf16 v[104:119], a[12:15], v[124:127], v[104:119]
s_waitcnt vmcnt(13)
v_mfma_f32_32x32x16_bf16 v[88:103], a[16:19], v[128:131], v[88:103]
s_add_u32 s57, s52, 20480
buffer_load_dwordx4 v[168:171], v1, s[28:31], s57 offen offset:1024 sc1
v_mfma_f32_32x32x16_bf16 v[104:119], a[20:23], v[128:131], v[104:119]
s_waitcnt vmcnt(13)
v_mfma_f32_32x32x16_bf16 v[88:103], a[24:27], v[132:135], v[88:103]
s_add_u32 s57, s52, 20480
buffer_load_dwordx4 v[172:175], v1, s[28:31], s57 offen offset:2048 sc1
v_mfma_f32_32x32x16_bf16 v[104:119], a[28:31], v[132:135], v[104:119]
s_waitcnt vmcnt(13)
v_mov_b32 v2, s44
v_mov_b32 v3, s45
v_mov_b32 v4, 0
s_mov_b64 exec, 1
s_cmp_eq_u32 s39, 0
s_cbranch_scc1 L_slow_134
s_waitcnt vmcnt(6)
buffer_store_dwordx2 v[2:3], v4, s[28:31], s56 offen
L_stored_135:
s_mov_b64 exec, -1
v_mfma_f32_32x32x16_bf16 v[88:103], a[56:59], v[136:139], v[88:103]
s_add_u32 s57, s52, 20480
buffer_load_dwordx4 v[176:179], v1, s[28:31], s57 offen offset:3072 sc1
v_mfma_f32_32x32x16_bf16 v[104:119], a[60:63], v[136:139], v[104:119]
v_mfma_f32_32x32x16_bf16 v[88:103], a[64:67], v[140:143], v[88:103]
s_add_u32 s57, s52, 24576
buffer_load_dwordx4 v[180:183], v1, s[28:31], s57 offen offset:0 sc1
v_mfma_f32_32x32x16_bf16 v[104:119], a[68:71], v[140:143], v[104:119]
v_mfma_f32_32x32x16_bf16 v[88:103], a[72:75], v[144:147], v[88:103]
s_add_u32 s57, s53, 0
buffer_load_dwordx4 v[120:123], v1, s[28:31], s57 offen offset:0 sc1
v_mfma_f32_32x32x16_bf16 v[104:119], a[76:79], v[144:147], v[104:119]
v_mfma_f32_32x32x16_bf16 v[88:103], a[80:83], v[148:151], v[88:103]
s_add_u32 s57, s53, 0
buffer_load_dwordx4 v[124:127], v1, s[28:31], s57 offen offset:1024 sc1
v_mfma_f32_32x32x16_bf16 v[104:119], a[84:87], v[148:151], v[104:119]
s_waitcnt vmcnt(10)
v_mfma_f32_32x32x16_bf16 v[88:103], a[112:115], v[152:155], v[88:103]
s_add_u32 s57, s53, 0
buffer_load_dwordx4 v[128:131], v1, s[28:31], s57 offen offset:2048 sc1
v_mfma_f32_32x32x16_bf16 v[104:119], a[116:119], v[152:155], v[104:119]
s_waitcnt vmcnt(10)
v_mfma_f32_32x32x16_bf16 v[88:103], a[120:123], v[156:159], v[88:103]
s_add_u32 s57, s53, 0
buffer_load_dwordx4 v[132:135], v1, s[28:31], s57 offen offset:3072 sc1
v_mfma_f32_32x32x16_bf16 v[104:119], a[124:127], v[156:159], v[104:119]
s_waitcnt vmcnt(10)
v_mfma_f32_32x32x16_bf16 v[88:103], a[128:131], v[160:163], v[88:103]
s_add_u32 s57, s53, 4096
buffer_load_dwordx4 v[136:139], v1, s[28:31], s57 offen offset:3072 sc1
v_mfma_f32_32x32x16_bf16 v[104:119], a[132:135], v[160:163], v[104:119]
s_waitcnt vmcnt(10)
v_mfma_f32_32x32x16_bf16 v[88:103], a[136:139], v[164:167], v[88:103]
s_add_u32 s57, s53, 8192
buffer_load_dwordx4 v[140:143], v1, s[28:31], s57 offen offset:0 sc1
v_mfma_f32_32x32x16_bf16 v[104:119], a[140:143], v[164:167], v[104:119]
s_waitcnt vmcnt(10)
v_mfma_f32_32x32x16_bf16 v[88:103], a[168:171], v[168:171], v[88:103]
s_add_u32 s57, s53, 8192
buffer_load_dwordx4 v[144:147], v1, s[28:31], s57 offen offset:1024 sc1
v_mfma_f32_32x32x16_bf16 v[104:119], a[172:175], v[168:171], v[104:119]
s_waitcnt vmcnt(10)
v_mfma_f32_32x32x16_bf16 v[88:103], a[176:179], v[172:175], v[88:103]
s_add_u32 s57, s53, 8192
buffer_load_dwordx4 v[148:151], v1, s[28:31], s57 offen offset:2048 sc1
v_mfma_f32_32x32x16_bf16 v[104:119], a[180:183], v[172:175], v[104:119]
s_waitcnt vmcnt(9)
v_mfma_f32_32x32x16_bf16 v[88:103], a[184:187], v[176:179], v[88:103]
s_add_u32 s57, s53, 12288
buffer_load_dwordx4 v[152:155], v1, s[28:31], s57 offen offset:2048 sc1
v_mfma_f32_32x32x16_bf16 v[104:119], a[188:191], v[176:179], v[104:119]
s_waitcnt vmcnt(9)
v_mfma_f32_32x32x16_bf16 v[88:103], a[192:195], v[180:183], v[88:103]
s_add_u32 s57, s53, 12288
buffer_load_dwordx4 v[156:159], v1, s[28:31], s57 offen offset:3072 sc1
v_mfma_f32_32x32x16_bf16 v[104:119], a[196:199], v[180:183], v[104:119]
s_waitcnt vmcnt(9)
v_mfma_f32_32x32x16_bf16 v[56:71], a[0:3], v[120:123], 0
s_add_u32 s57, s53, 16384
buffer_load_dwordx4 v[160:163], v1, s[28:31], s57 offen offset:0 sc1
s_add_u32 s47, s47, 40960
s_mov_b64 exec, 0xff
buffer_load_dwordx2 v[10:11], v9, s[28:31], s47 offen sc1
s_mov_b64 exec, -1
v_mfma_f32_32x32x16_bf16 v[72:87], a[4:7], v[120:123], 0
s_waitcnt vmcnt(10)
v_mfma_f32_32x32x16_bf16 v[56:71], a[8:11], v[124:127], v[56:71]
s_add_u32 s57, s53, 16384
buffer_load_dwordx4 v[164:167], v1, s[28:31], s57 offen offset:1024 sc1
v_mfma_f32_32x32x16_bf16 v[72:87], a[12:15], v[124:127], v[72:87]
s_waitcnt vmcnt(10)
v_mfma_f32_32x32x16_bf16 v[56:71], a[16:19], v[128:131], v[56:71]
s_add_u32 s57, s53, 20480
buffer_load_dwordx4 v[168:171], v1, s[28:31], s57 offen offset:1024 sc1
v_mfma_f32_32x32x16_bf16 v[72:87], a[20:23], v[128:131], v[72:87]
s_waitcnt vmcnt(10)
v_mfma_f32_32x32x16_bf16 v[56:71], a[24:27], v[132:135], v[56:71]
s_add_u32 s57, s53, 20480
buffer_load_dwordx4 v[172:175], v1, s[28:31], s57 offen offset:2048 sc1
v_mfma_f32_32x32x16_bf16 v[72:87], a[28:31], v[132:135], v[72:87]
s_waitcnt vmcnt(10)
v_mfma_f32_32x32x16_bf16 v[56:71], a[56:59], v[136:139], v[56:71]
s_add_u32 s57, s53, 20480
buffer_load_dwordx4 v[176:179], v1, s[28:31], s57 offen offset:3072 sc1
v_mfma_f32_32x32x16_bf16 v[72:87], a[60:63], v[136:139], v[72:87]
s_waitcnt vmcnt(10)
v_mfma_f32_32x32x16_bf16 v[56:71], a[64:67], v[140:143], v[56:71]
s_add_u32 s57, s53, 24576
buffer_load_dwordx4 v[180:183], v1, s[28:31], s57 offen offset:0 sc1
v_mfma_f32_32x32x16_bf16 v[72:87], a[68:71], v[140:143], v[72:87]
s_waitcnt vmcnt(10)
v_mfma_f32_32x32x16_bf16 v[56:71], a[72:75], v[144:147], v[56:71]
s_waitcnt vmcnt(5)
s_mov_b64 exec, 0xff
v_cmp_ne_u64 vcc, s[44:45], v[10:11]
s_cbranch_vccnz L_chk_136
L_chkok_137:
s_mov_b64 exec, -1
s_add_u32 s57, s52, 4096
buffer_load_dwordx4 v[120:123], v1, s[28:31], s57 offen offset:0 sc1
v_mfma_f32_32x32x16_bf16 v[72:87], a[76:79], v[144:147], v[72:87]
v_mfma_f32_32x32x16_bf16 v[56:71], a[80:83], v[148:151], v[56:71]
s_add_u32 s57, s52, 4096
buffer_load_dwordx4 v[124:127], v1, s[28:31], s57 offen offset:1024 sc1
v_mfma_f32_32x32x16_bf16 v[72:87], a[84:87], v[148:151], v[72:87]
v_mfma_f32_32x32x16_bf16 v[56:71], a[112:115], v[152:155], v[56:71]
s_add_u32 s57, s52, 4096
buffer_load_dwordx4 v[128:131], v1, s[28:31], s57 offen offset:2048 sc1
v_mfma_f32_32x32x16_bf16 v[72:87], a[116:119], v[152:155], v[72:87]
v_mfma_f32_32x32x16_bf16 v[56:71], a[120:123], v[156:159], v[56:71]
s_add_u32 s57, s52, 8192
buffer_load_dwordx4 v[132:135], v1, s[28:31], s57 offen offset:3072 sc1
v_mfma_f32_32x32x16_bf16 v[72:87], a[124:127], v[156:159], v[72:87]
v_mfma_f32_32x32x16_bf16 v[56:71], a[128:131], v[160:163], v[56:71]
s_add_u32 s57, s52, 12288
buffer_load_dwordx4 v[136:139], v1, s[28:31], s57 offen offset:0 sc1
v_mfma_f32_32x32x16_bf16 v[72:87], a[132:135], v[160:163], v[72:87]
s_waitcnt vmcnt(9)
v_mfma_f32_32x32x16_bf16 v[56:71], a[136:139], v[164:167], v[56:71]
s_add_u32 s57, s52, 12288
buffer_load_dwordx4 v[140:143], v1, s[28:31], s57 offen offset:1024 sc1
v_mfma_f32_32x32x16_bf16 v[72:87], a[140:143], v[164:167], v[72:87]
s_waitcnt vmcnt(9)
v_mfma_f32_32x32x16_bf16 v[56:71], a[168:171], v[168:171], v[56:71]
s_add_u32 s57, s52, 16384
buffer_load_dwordx4 v[144:147], v1, s[28:31], s57 offen offset:2048 sc1
v_mfma_f32_32x32x16_bf16 v[72:87], a[172:175], v[168:171], v[72:87]
s_waitcnt vmcnt(9)
v_mfma_f32_32x32x16_bf16 v[56:71], a[176:179], v[172:175], v[56:71]
s_add_u32 s57, s52, 16384
buffer_load_dwordx4 v[148:151], v1, s[28:31], s57 offen offset:3072 sc1
v_mfma_f32_32x32x16_bf16 v[72:87], a[180:183], v[172:175], v[72:87]
s_waitcnt vmcnt(9)
v_mfma_f32_32x32x16_bf16 v[56:71], a[184:187], v[176:179], v[56:71]
s_add_u32 s57, s52, 20480
buffer_load_dwordx4 v[152:155], v1, s[28:31], s57 offen offset:0 sc1
v_mfma_f32_32x32x16_bf16 v[72:87], a[188:191], v[176:179], v[72:87]
s_waitcnt vmcnt(9)
v_mfma_f32_32x32x16_bf16 v[56:71], a[192:195], v[180:183], v[56:71]
s_add_u32 s57, s52, 24576
buffer_load_dwordx4 v[156:159], v1, s[28:31], s57 offen offset:1024 sc1
v_mfma_f32_32x32x16_bf16 v[72:87], a[196:199], v[180:183], v[72:87]
s_waitcnt vmcnt(9)
v_mfma_f32_32x32x16_bf16 v[88:103], a[32:35], v[120:123], v[88:103]
s_add_u32 s57, s52, 24576
buffer_load_dwordx4 v[160:163], v1, s[28:31], s57 offen offset:2048 sc1
v_mfma_f32_32x32x16_bf16 v[104:119], a[36:39], v[120:123], v[104:119]
s_waitcnt vmcnt(9)
v_mfma_f32_32x32x16_bf16 v[88:103], a[40:43], v[124:127], v[88:103]
s_add_u32 s57, s52, 24576
buffer_load_dwordx4 v[164:167], v1, s[28:31], s57 offen offset:3072 sc1
v_mfma_f32_32x32x16_bf16 v[104:119], a[44:47], v[124:127], v[104:119]
s_waitcnt vmcnt(9)
v_mfma_f32_32x32x16_bf16 v[88:103], a[48:51], v[128:131], v[88:103]
s_add_u32 s57, s53, 4096
buffer_load_dwordx4 v[168:171], v1, s[28:31], s57 offen offset:0 sc1
v_mfma_f32_32x32x16_bf16 v[104:119], a[52:55], v[128:131], v[104:119]
s_waitcnt vmcnt(9)
v_mfma_f32_32x32x16_bf16 v[88:103], a[88:91], v[132:135], v[88:103]
s_add_u32 s57, s53, 4096
buffer_load_dwordx4 v[172:175], v1, s[28:31], s57 offen offset:1024 sc1
v_mfma_f32_32x32x16_bf16 v[104:119], a[92:95], v[132:135], v[104:119]
s_waitcnt vmcnt(9)
v_mfma_f32_32x32x16_bf16 v[88:103], a[96:99], v[136:139], v[88:103]
s_add_u32 s57, s53, 4096
buffer_load_dwordx4 v[176:179], v1, s[28:31], s57 offen offset:2048 sc1
v_mfma_f32_32x32x16_bf16 v[104:119], a[100:103], v[136:139], v[104:119]
s_waitcnt vmcnt(9)
v_mfma_f32_32x32x16_bf16 v[88:103], a[104:107], v[140:143], v[88:103]
s_add_u32 s57, s53, 8192
buffer_load_dwordx4 v[180:183], v1, s[28:31], s57 offen offset:3072 sc1
v_mfma_f32_32x32x16_bf16 v[104:119], a[108:111], v[140:143], v[104:119]
s_waitcnt vmcnt(9)
v_mfma_f32_32x32x16_bf16 v[88:103], a[144:147], v[144:147], v[88:103]
s_add_u32 s57, s53, 12288
buffer_load_dwordx4 v[120:123], v1, s[28:31], s57 offen offset:0 sc1
v_mfma_f32_32x32x16_bf16 v[104:119], a[148:151], v[144:147], v[104:119]
s_waitcnt vmcnt(9)
v_mfma_f32_32x32x16_bf16 v[88:103], a[152:155], v[148:151], v[88:103]
s_add_u32 s57, s53, 12288
buffer_load_dwordx4 v[124:127], v1, s[28:31], s57 offen offset:1024 sc1
v_mfma_f32_32x32x16_bf16 v[104:119], a[156:159], v[148:151], v[104:119]
s_waitcnt vmcnt(9)
v_mfma_f32_32x32x16_bf16 v[88:103], a[160:163], v[152:155], v[88:103]
s_add_u32 s57, s53, 16384
buffer_load_dwordx4 v[128:131], v1, s[28:31], s57 offen offset:2048 sc1
v_mfma_f32_32x32x16_bf16 v[104:119], a[164:167], v[152:155], v[104:119]
s_waitcnt vmcnt(9)
v_mfma_f32_32x32x16_bf16 v[88:103], a[200:203], v[156:159], v[88:103]
s_add_u32 s57, s53, 16384
buffer_load_dwordx4 v[132:135], v1, s[28:31], s57 offen offset:3072 sc1
v_mfma_f32_32x32x16_bf16 v[104:119], a[204:207], v[156:159], v[104:119]
s_waitcnt vmcnt(9)
v_mfma_f32_32x32x16_bf16 v[88:103], a[208:211], v[160:163], v[88:103]
s_add_u32 s57, s53, 20480
buffer_load_dwordx4 v[136:139], v1, s[28:31], s57 offen offset:0 sc1
v_mfma_f32_32x32x16_bf16 v[104:119], a[212:215], v[160:163], v[104:119]
s_waitcnt vmcnt(9)
v_mfma_f32_32x32x16_bf16 v[88:103], a[216:219], v[164:167], v[88:103]
s_add_u32 s57, s53, 24576
buffer_load_dwordx4 v[140:143], v1, s[28:31], s57 offen offset:1024 sc1
v_mfma_f32_32x32x16_bf16 v[104:119], a[220:223], v[164:167], v[104:119]
s_waitcnt vmcnt(9)
s_xor_b32 s46, s38, 2
s_mul_i32 s46, s46, 12288
s_add_u32 s46, s46, 111616
v_add_u32 v2, s46, v1
v_mfma_f32_32x32x16_bf16 v[56:71], a[32:35], v[168:171], v[56:71]
s_add_u32 s57, s53, 24576
buffer_load_dwordx4 v[144:147], v1, s[28:31], s57 offen offset:2048 sc1
s_nop 0
ds_write_b128 v2, v[88:91] offset:0
ds_write_b128 v2, v[92:95] offset:1024
v_mfma_f32_32x32x16_bf16 v[72:87], a[36:39], v[168:171], v[72:87]
ds_write_b128 v2, v[96:99] offset:2048
ds_write_b128 v2, v[100:103] offset:3072
s_waitcnt vmcnt(9)
s_xor_b32 s46, s38, 3
s_mul_i32 s46, s46, 12288
s_add_u32 s46, s46, 115712
v_add_u32 v2, s46, v1
v_mfma_f32_32x32x16_bf16 v[56:71], a[40:43], v[172:175], v[56:71]
s_add_u32 s57, s53, 24576
buffer_load_dwordx4 v[148:151], v1, s[28:31], s57 offen offset:3072 sc1
ds_write_b128 v2, v[104:107] offset:0
ds_write_b128 v2, v[108:111] offset:1024
v_mfma_f32_32x32x16_bf16 v[72:87], a[44:47], v[172:175], v[72:87]
ds_write_b128 v2, v[112:115] offset:2048
ds_write_b128 v2, v[116:119] offset:3072
s_waitcnt vmcnt(9)
v_mfma_f32_32x32x16_bf16 v[56:71], a[48:51], v[176:179], v[56:71]
s_waitcnt lgkmcnt(0)
s_barrier
ds_read_b128 v[184:187], v8 offset:4096
ds_read_b128 v[188:191], v8 offset:5120
ds_read_b128 v[192:195], v8 offset:6144
v_mfma_f32_32x32x16_bf16 v[72:87], a[52:55], v[176:179], v[72:87]
ds_read_b128 v[196:199], v8 offset:7168
ds_read_b128 v[200:203], v8 offset:8192
ds_read_b128 v[204:207], v8 offset:9216
ds_read_b128 v[208:211], v8 offset:10240
ds_read_b128 v[212:215], v8 offset:11264
s_waitcnt vmcnt(8)
v_mfma_f32_32x32x16_bf16 v[56:71], a[88:91], v[180:183], v[56:71]
v_mfma_f32_32x32x16_bf16 v[72:87], a[92:95], v[180:183], v[72:87]
s_waitcnt vmcnt(7)
v_mfma_f32_32x32x16_bf16 v[56:71], a[96:99], v[120:123], v[56:71]
s_waitcnt lgkmcnt(0)
v_add_f32 v184, v184, v200
v_add_f32 v185, v185, v201
v_add_f32 v186, v186, v202
v_add_f32 v187, v187, v203
v_mfma_f32_32x32x16_bf16 v[72:87], a[100:103], v[120:123], v[72:87]
v_add_f32 v188, v188, v204
v_add_f32 v189, v189, v205
v_add_f32 v190, v190, v206
v_add_f32 v191, v191, v207
s_waitcnt vmcnt(6)
v_mfma_f32_32x32x16_bf16 v[56:71], a[104:107], v[124:127], v[56:71]
v_add_f32 v192, v192, v208
v_add_f32 v193, v193, v209
v_add_f32 v194, v194, v210
v_add_f32 v195, v195, v211
v_mfma_f32_32x32x16_bf16 v[72:87], a[108:111], v[124:127], v[72:87]
v_add_f32 v196, v196, v212
v_add_f32 v197, v197, v213
v_add_f32 v198, v198, v214
v_add_f32 v199, v199, v215
s_waitcnt vmcnt(5)
v_mfma_f32_32x32x16_bf16 v[56:71], a[144:147], v[128:131], v[56:71]
v_mfma_f32_32x32x16_bf16 v[72:87], a[148:151], v[128:131], v[72:87]
s_waitcnt vmcnt(4)
v_mfma_f32_32x32x16_bf16 v[56:71], a[152:155], v[132:135], v[56:71]
v_mfma_f32_32x32x16_bf16 v[72:87], a[156:159], v[132:135], v[72:87]
s_waitcnt vmcnt(3)
v_mfma_f32_32x32x16_bf16 v[56:71], a[160:163], v[136:139], v[56:71]
v_mfma_f32_32x32x16_bf16 v[72:87], a[164:167], v[136:139], v[72:87]
s_waitcnt vmcnt(2)
v_mfma_f32_32x32x16_bf16 v[56:71], a[200:203], v[140:143], v[56:71]
v_mfma_f32_32x32x16_bf16 v[72:87], a[204:207], v[140:143], v[72:87]
s_waitcnt vmcnt(1)
v_mfma_f32_32x32x16_bf16 v[56:71], a[208:211], v[144:147], v[56:71]
v_mfma_f32_32x32x16_bf16 v[72:87], a[212:215], v[144:147], v[72:87]
s_waitcnt vmcnt(0)
s_xor_b32 s46, s38, 1
s_mul_i32 s46, s46, 12288
s_add_u32 s46, s46, 107520
v_add_u32 v2, s46, v1
v_mfma_f32_32x32x16_bf16 v[72:87], a[220:223], v[148:151], v[72:87]
v_mfma_f32_32x32x16_bf16 v[56:71], a[216:219], v[148:151], v[56:71]
s_nop 10
ds_write_b128 v2, v[72:75] offset:0
ds_write_b128 v2, v[76:79] offset:1024
ds_write_b128 v2, v[80:83] offset:2048
ds_write_b128 v2, v[84:87] offset:3072
v_pk_add_f32 v[56:57], v[56:57], v[184:185]
v_pk_add_f32 v[58:59], v[58:59], v[186:187]
v_pk_add_f32 v[60:61], v[60:61], v[188:189]
v_pk_add_f32 v[62:63], v[62:63], v[190:191]
v_pk_add_f32 v[64:65], v[64:65], v[192:193]
v_pk_add_f32 v[66:67], v[66:67], v[194:195]
v_pk_add_f32 v[68:69], v[68:69], v[196:197]
v_pk_add_f32 v[70:71], v[70:71], v[198:199]
s_waitcnt lgkmcnt(0)
s_barrier
ds_read_b128 v[184:187], v8 offset:0
ds_read_b128 v[188:191], v8 offset:1024
ds_read_b128 v[192:195], v8 offset:2048
ds_read_b128 v[196:199], v8 offset:3072
v_pk_fma_f32 v[56:57], v[56:57], v[12:13], v[16:17] op_sel:[0,1,0] op_sel_hi:[1,1,1]
v_pk_fma_f32 v[58:59], v[58:59], v[12:13], v[18:19] op_sel:[0,1,0] op_sel_hi:[1,1,1]
v_pk_fma_f32 v[60:61], v[60:61], v[12:13], v[20:21] op_sel:[0,1,0] op_sel_hi:[1,1,1]
v_pk_fma_f32 v[62:63], v[62:63], v[12:13], v[22:23] op_sel:[0,1,0] op_sel_hi:[1,1,1]
v_pk_fma_f32 v[64:65], v[64:65], v[12:13], v[24:25] op_sel:[0,1,0] op_sel_hi:[1,1,1]
v_pk_fma_f32 v[66:67], v[66:67], v[12:13], v[26:27] op_sel:[0,1,0] op_sel_hi:[1,1,1]
v_pk_fma_f32 v[68:69], v[68:69], v[12:13], v[28:29] op_sel:[0,1,0] op_sel_hi:[1,1,1]
v_pk_fma_f32 v[70:71], v[70:71], v[12:13], v[30:31] op_sel:[0,1,0] op_sel_hi:[1,1,1]
s_waitcnt lgkmcnt(3)
v_pk_fma_f32 v[56:57], v[184:185], v[12:13], v[56:57] op_sel:[0,1,0] op_sel_hi:[1,1,1]
v_pk_fma_f32 v[58:59], v[186:187], v[12:13], v[58:59] op_sel:[0,1,0] op_sel_hi:[1,1,1]
v_cvt_pk_bf16_f32 v88, v56, v57
v_cvt_pk_bf16_f32 v89, v58, v59
s_waitcnt lgkmcnt(2)
v_pk_fma_f32 v[60:61], v[188:189], v[12:13], v[60:61] op_sel:[0,1,0] op_sel_hi:[1,1,1]
v_pk_fma_f32 v[62:63], v[190:191], v[12:13], v[62:63] op_sel:[0,1,0] op_sel_hi:[1,1,1]
v_cvt_pk_bf16_f32 v90, v60, v61
v_cvt_pk_bf16_f32 v91, v62, v63
s_waitcnt lgkmcnt(1)
v_pk_fma_f32 v[64:65], v[192:193], v[12:13], v[64:65] op_sel:[0,1,0] op_sel_hi:[1,1,1]
v_pk_fma_f32 v[66:67], v[194:195], v[12:13], v[66:67] op_sel:[0,1,0] op_sel_hi:[1,1,1]
v_cvt_pk_bf16_f32 v92, v64, v65
v_cvt_pk_bf16_f32 v93, v66, v67
s_waitcnt lgkmcnt(0)
v_pk_fma_f32 v[68:69], v[196:197], v[12:13], v[68:69] op_sel:[0,1,0] op_sel_hi:[1,1,1]
v_pk_fma_f32 v[70:71], v[198:199], v[12:13], v[70:71] op_sel:[0,1,0] op_sel_hi:[1,1,1]
v_cvt_pk_bf16_f32 v94, v68, v69
v_cvt_pk_bf16_f32 v95, v70, v71
buffer_store_dwordx2 v[88:89], v5, s[24:27], s3 offen offset:0
buffer_store_dwordx2 v[90:91], v5, s[24:27], s3 offen offset:16
buffer_store_dwordx2 v[92:93], v5, s[24:27], s3 offen offset:32
s_mov_b64 exec, s[50:51]
buffer_store_dwordx2 v[94:95], v5, s[24:27], s3 offen offset:48
s_mov_b64 exec, -1
s_or_b32 s46, s2, s38
s_cmp_lg_u32 s46, 0
s_cbranch_scc1 L_noepoch_138
v_mov_b32 v6, s44
v_mov_b32 v7, s45
v_lshlrev_b32 v2, 7, v0
s_sub_u32 s44, s44, 1
s_subb_u32 s45, s45, 0
s_mov_b32 s46, 884736
s_mov_b64 exec, -1
L_poll_139:
buffer_load_dwordx2 v[4:5], v2, s[28:31], s46 offen sc1
s_sub_u32 s59, s59, 1
s_cbranch_scc1 L_fin
s_waitcnt vmcnt(0)
v_cmp_ne_u64 vcc, s[44:45], v[4:5]
s_cbranch_vccnz L_poll_139
s_mov_b64 exec, -1
s_mov_b32 s46, 892928
s_mov_b64 exec, -1
L_poll_141:
buffer_load_dwordx2 v[4:5], v2, s[28:31], s46 offen sc1
s_sub_u32 s59, s59, 1
s_cbranch_scc1 L_fin
s_waitcnt vmcnt(0)
v_cmp_ne_u64 vcc, s[44:45], v[4:5]
s_cbranch_vccnz L_poll_141
s_mov_b64 exec, -1
s_mov_b32 s46, 901120
s_mov_b64 exec, -1
L_poll_143:
buffer_load_dwordx2 v[4:5], v2, s[28:31], s46 offen sc1
s_sub_u32 s59, s59, 1
s_cbranch_scc1 L_fin
s_waitcnt vmcnt(0)
v_cmp_ne_u64 vcc, s[44:45], v[4:5]
s_cbranch_vccnz L_poll_143
s_mov_b64 exec, -1
s_mov_b32 s46, 909312
s_mov_b64 exec, -1
L_poll_145:
buffer_load_dwordx2 v[4:5], v2, s[28:31], s46 offen sc1
s_sub_u32 s59, s59, 1
s_cbranch_scc1 L_fin
s_waitcnt vmcnt(0)
v_cmp_ne_u64 vcc, s[44:45], v[4:5]
s_cbranch_vccnz L_poll_145
s_mov_b64 exec, -1
s_mov_b64 exec, 1
v_mov_b32 v5, 0
buffer_store_dwordx2 v[6:7], v5, s[28:31], 0 offen offset:0
L_noepoch_138:
L_fin:
L_end:
s_endpgm
L_chk_24:
buffer_load_dwordx2 v[4:5], v6, s[28:31], s53 offen sc1
s_sub_u32 s59, s59, 1
s_cbranch_scc1 L_fin
s_waitcnt vmcnt(0)
v_cmp_ne_u64 vcc, s[44:45], v[4:5]
s_cbranch_vccnz L_chk_24
s_branch L_chkok_25
L_chk_36:
buffer_load_dwordx2 v[8:9], v6, s[28:31], s51 offen sc1
s_sub_u32 s59, s59, 1
s_cbranch_scc1 L_fin
s_waitcnt vmcnt(0)
v_cmp_ne_u64 vcc, s[44:45], v[8:9]
s_cbranch_vccnz L_chk_36
s_branch L_chkok_37
L_chk_43:
buffer_load_dwordx2 v[4:5], v2, s[28:31], s48 offen sc1
s_sub_u32 s59, s59, 1
s_cbranch_scc1 L_fin
s_waitcnt vmcnt(0)
v_cmp_ne_u64 vcc, s[44:45], v[4:5]
s_cbranch_vccnz L_chk_43
s_branch L_chkok_44
L_nosegb_50:
s_mul_i32 s56, s42, 28672
s_mul_i32 s57, s37, 1792
s_add_u32 s56, s56, s57
s_add_u32 s56, s56, 2883584
v_mul_u32_u24 v14, 128, v0
s_mov_b32 exec_lo, 0x3fff
s_mov_b32 exec_hi, 0x0
buffer_load_dword v14, v14, s[28:31], s56 offen
s_mov_b64 exec, -1
s_mul_i32 s56, s42, 4096
s_mul_i32 s57, s37, 256
s_add_u32 s56, s56, s57
s_add_u32 s56, s56, 327680
v_mul_u32_u24 v14, 128, v0
s_mov_b32 exec_lo, 0x3
s_mov_b32 exec_hi, 0x0
buffer_load_dword v14, v14, s[28:31], s56 offen
s_mov_b64 exec, -1
s_mov_b64 exec, 0xffff
buffer_load_dwordx4 v[8:11], v12, s[28:31], s50 offen sc1
s_mov_b64 exec, -1
s_mul_i32 s100, s41, 57344
s_mul_i32 s48, s38, 14336
s_add_u32 s100, s100, s48
s_add_u32 s100, s100, 24117248
s_lshl_b32 s48, s99, 10
s_add_u32 s101, s100, 1024
s_add_u32 s100, s100, s48
s_sub_u32 s101, s101, s48
s_add_u32 s57, s100, 0
s_bitcmp1_b32 s57, 10
s_cselect_b32 exec_lo, s61, -1
s_mov_b32 exec_hi, exec_lo
buffer_load_dwordx4 a[224:227], v1, s[28:31], s57 offen
s_mov_b64 exec, -1
s_add_u32 s57, s101, 0
s_bitcmp1_b32 s57, 10
s_cselect_b32 exec_lo, s61, -1
s_mov_b32 exec_hi, exec_lo
buffer_load_dwordx4 a[228:231], v1, s[28:31], s57 offen
s_mov_b64 exec, -1
s_add_u32 s57, s100, 2048
s_bitcmp1_b32 s57, 10
s_cselect_b32 exec_lo, s61, -1
s_mov_b32 exec_hi, exec_lo
buffer_load_dwordx4 a[232:235], v1, s[28:31], s57 offen
s_mov_b64 exec, -1
s_add_u32 s57, s101, 2048
s_bitcmp1_b32 s57, 10
s_cselect_b32 exec_lo, s61, -1
s_mov_b32 exec_hi, exec_lo
buffer_load_dwordx4 a[236:239], v1, s[28:31], s57 offen
s_mov_b64 exec, -1
s_add_u32 s57, s100, 4096
s_bitcmp1_b32 s57, 10
s_cselect_b32 exec_lo, s61, -1
s_mov_b32 exec_hi, exec_lo
buffer_load_dwordx4 a[240:243], v1, s[28:31], s57 offen
s_mov_b64 exec, -1
s_add_u32 s57, s101, 4096
s_bitcmp1_b32 s57, 10
s_cselect_b32 exec_lo, s61, -1
s_mov_b32 exec_hi, exec_lo
buffer_load_dwordx4 a[244:247], v1, s[28:31], s57 offen
s_mov_b64 exec, -1
s_add_u32 s57, s100, 6144
s_bitcmp1_b32 s57, 10
s_cselect_b32 exec_lo, s61, -1
s_mov_b32 exec_hi, exec_lo
buffer_load_dwordx4 a[248:251], v1, s[28:31], s57 offen
s_mov_b64 exec, -1
s_add_u32 s57, s101, 6144
s_bitcmp1_b32 s57, 10
s_cselect_b32 exec_lo, s61, -1
s_mov_b32 exec_hi, exec_lo
buffer_load_dwordx4 a[252:255], v1, s[28:31], s57 offen
s_mov_b64 exec, -1
s_add_u32 s57, s100, 8192
s_bitcmp1_b32 s57, 10
s_cselect_b32 exec_lo, s61, -1
s_mov_b32 exec_hi, exec_lo
buffer_load_dwordx4 v[32:35], v1, s[28:31], s57 offen
s_mov_b64 exec, -1
s_add_u32 s57, s101, 8192
s_bitcmp1_b32 s57, 10
s_cselect_b32 exec_lo, s61, -1
s_mov_b32 exec_hi, exec_lo
buffer_load_dwordx4 v[36:39], v1, s[28:31], s57 offen
s_mov_b64 exec, -1
s_add_u32 s57, s100, 10240
s_bitcmp1_b32 s57, 10
s_cselect_b32 exec_lo, s61, -1
s_mov_b32 exec_hi, exec_lo
buffer_load_dwordx4 v[40:43], v1, s[28:31], s57 offen
s_mov_b64 exec, -1
s_add_u32 s57, s101, 10240
s_bitcmp1_b32 s57, 10
s_cselect_b32 exec_lo, s61, -1
s_mov_b32 exec_hi, exec_lo
buffer_load_dwordx4 v[44:47], v1, s[28:31], s57 offen
s_mov_b64 exec, -1
s_add_u32 s57, s100, 12288
s_bitcmp1_b32 s57, 10
s_cselect_b32 exec_lo, s61, -1
s_mov_b32 exec_hi, exec_lo
buffer_load_dwordx4 v[48:51], v1, s[28:31], s57 offen
s_mov_b64 exec, -1
s_add_u32 s57, s101, 12288
s_bitcmp1_b32 s57, 10
s_cselect_b32 exec_lo, s61, -1
s_mov_b32 exec_hi, exec_lo
buffer_load_dwordx4 v[52:55], v1, s[28:31], s57 offen
s_mov_b64 exec, -1
s_mul_i32 s100, s41, 229376
s_mul_i32 s48, s38, 57344
s_add_u32 s100, s100, s48
s_add_u32 s100, s100, 22282240
s_lshl_b32 s48, s99, 10
s_add_u32 s101, s100, 1024
s_add_u32 s100, s100, s48
s_sub_u32 s101, s101, s48
s_add_u32 s57, s100, 0
s_bitcmp1_b32 s57, 10
s_cselect_b32 exec_lo, s61, -1
s_mov_b32 exec_hi, exec_lo
buffer_load_dwordx4 a[0:3], v1, s[28:31], s57 offen
s_mov_b64 exec, -1
s_add_u32 s57, s101, 0
s_bitcmp1_b32 s57, 10
s_cselect_b32 exec_lo, s61, -1
s_mov_b32 exec_hi, exec_lo
buffer_load_dwordx4 a[4:7], v1, s[28:31], s57 offen
s_mov_b64 exec, -1
s_add_u32 s57, s100, 2048
s_bitcmp1_b32 s57, 10
s_cselect_b32 exec_lo, s61, -1
s_mov_b32 exec_hi, exec_lo
buffer_load_dwordx4 a[8:11], v1, s[28:31], s57 offen
s_mov_b64 exec, -1
s_add_u32 s57, s101, 2048
s_bitcmp1_b32 s57, 10
s_cselect_b32 exec_lo, s61, -1
s_mov_b32 exec_hi, exec_lo
buffer_load_dwordx4 a[12:15], v1, s[28:31], s57 offen
s_mov_b64 exec, -1
s_add_u32 s57, s100, 4096
s_bitcmp1_b32 s57, 10
s_cselect_b32 exec_lo, s61, -1
s_mov_b32 exec_hi, exec_lo
buffer_load_dwordx4 a[16:19], v1, s[28:31], s57 offen
s_mov_b64 exec, -1
s_add_u32 s57, s101, 4096
s_bitcmp1_b32 s57, 10
s_cselect_b32 exec_lo, s61, -1
s_mov_b32 exec_hi, exec_lo
buffer_load_dwordx4 a[20:23], v1, s[28:31], s57 offen
s_mov_b64 exec, -1
s_add_u32 s57, s100, 6144
s_bitcmp1_b32 s57, 10
s_cselect_b32 exec_lo, s61, -1
s_mov_b32 exec_hi, exec_lo
buffer_load_dwordx4 a[24:27], v1, s[28:31], s57 offen
s_mov_b64 exec, -1
s_add_u32 s57, s101, 6144
s_bitcmp1_b32 s57, 10
s_cselect_b32 exec_lo, s61, -1
s_mov_b32 exec_hi, exec_lo
buffer_load_dwordx4 a[28:31], v1, s[28:31], s57 offen
s_mov_b64 exec, -1
s_add_u32 s57, s100, 14336
s_bitcmp1_b32 s57, 10
s_cselect_b32 exec_lo, s61, -1
s_mov_b32 exec_hi, exec_lo
buffer_load_dwordx4 a[56:59], v1, s[28:31], s57 offen
s_mov_b64 exec, -1
s_add_u32 s57, s101, 14336
s_bitcmp1_b32 s57, 10
s_cselect_b32 exec_lo, s61, -1
s_mov_b32 exec_hi, exec_lo
buffer_load_dwordx4 a[60:63], v1, s[28:31], s57 offen
s_mov_b64 exec, -1
s_add_u32 s57, s100, 16384
s_bitcmp1_b32 s57, 10
s_cselect_b32 exec_lo, s61, -1
s_mov_b32 exec_hi, exec_lo
buffer_load_dwordx4 a[64:67], v1, s[28:31], s57 offen
s_mov_b64 exec, -1
s_add_u32 s57, s101, 16384
s_bitcmp1_b32 s57, 10
s_cselect_b32 exec_lo, s61, -1
s_mov_b32 exec_hi, exec_lo
buffer_load_dwordx4 a[68:71], v1, s[28:31], s57 offen
s_mov_b64 exec, -1
s_add_u32 s57, s100, 18432
s_bitcmp1_b32 s57, 10
s_cselect_b32 exec_lo, s61, -1
s_mov_b32 exec_hi, exec_lo
buffer_load_dwordx4 a[72:75], v1, s[28:31], s57 offen
s_mov_b64 exec, -1
s_add_u32 s57, s101, 18432
s_bitcmp1_b32 s57, 10
s_cselect_b32 exec_lo, s61, -1
s_mov_b32 exec_hi, exec_lo
buffer_load_dwordx4 a[76:79], v1, s[28:31], s57 offen
s_mov_b64 exec, -1
s_add_u32 s57, s100, 20480
s_bitcmp1_b32 s57, 10
s_cselect_b32 exec_lo, s61, -1
s_mov_b32 exec_hi, exec_lo
buffer_load_dwordx4 a[80:83], v1, s[28:31], s57 offen
s_mov_b64 exec, -1
s_add_u32 s57, s101, 20480
s_bitcmp1_b32 s57, 10
s_cselect_b32 exec_lo, s61, -1
s_mov_b32 exec_hi, exec_lo
buffer_load_dwordx4 a[84:87], v1, s[28:31], s57 offen
s_mov_b64 exec, -1
s_add_u32 s57, s100, 28672
s_bitcmp1_b32 s57, 10
s_cselect_b32 exec_lo, s61, -1
s_mov_b32 exec_hi, exec_lo
buffer_load_dwordx4 a[112:115], v1, s[28:31], s57 offen
s_mov_b64 exec, -1
s_add_u32 s57, s101, 28672
s_bitcmp1_b32 s57, 10
s_cselect_b32 exec_lo, s61, -1
s_mov_b32 exec_hi, exec_lo
buffer_load_dwordx4 a[116:119], v1, s[28:31], s57 offen
s_mov_b64 exec, -1
s_add_u32 s57, s100, 30720
s_bitcmp1_b32 s57, 10
s_cselect_b32 exec_lo, s61, -1
s_mov_b32 exec_hi, exec_lo
buffer_load_dwordx4 a[120:123], v1, s[28:31], s57 offen
s_mov_b64 exec, -1
s_add_u32 s57, s101, 30720
s_bitcmp1_b32 s57, 10
s_cselect_b32 exec_lo, s61, -1
s_mov_b32 exec_hi, exec_lo
buffer_load_dwordx4 a[124:127], v1, s[28:31], s57 offen
s_mov_b64 exec, -1
v_mov_b32 v240, v64
v_mov_b32 v241, v65
v_mov_b32 v242, v66
v_mov_b32 v243, v67
v_mov_b32 v244, v68
v_mov_b32 v245, v69
v_mov_b32 v246, v70
v_mov_b32 v247, v71
v_mov_b32 v248, v72
v_mov_b32 v249, v73
v_mov_b32 v250, v74
v_mov_b32 v251, v75
v_mov_b32 v252, v76
v_mov_b32 v253, v77
v_mov_b32 v254, v78
v_mov_b32 v255, v79
s_branch L_segbdone_51
L_redo_53:
s_waitcnt lgkmcnt(0)
v_mov_b32 v234, v232
v_mfma_f32_32x32x16_bf16 v[96:111], v[144:147], v[56:59], 0
v_mfma_f32_32x32x16_bf16 v[96:111], v[148:151], v[60:63], v[96:111]
v_mfma_f32_32x32x16_bf16 v[112:127], v[152:155], v[56:59], 0
v_mfma_f32_32x32x16_bf16 v[112:127], v[156:159], v[60:63], v[112:127]
s_cmp_eq_u32 s54, 0
s_cbranch_scc1 L_nomask_100061
s_nop 7
v_cndmask_b32 v96, v96, v233, s[64:65]
v_cndmask_b32 v97, v97, v233, s[66:67]
v_cndmask_b32 v98, v98, v233, s[68:69]
v_cndmask_b32 v99, v99, v233, s[70:71]
v_cndmask_b32 v100, v100, v233, s[72:73]
v_cndmask_b32 v101, v101, v233, s[74:75]
v_cndmask_b32 v102, v102, v233, s[76:77]
v_cndmask_b32 v103, v103, v233, s[78:79]
v_cndmask_b32 v104, v104, v233, s[80:81]
v_cndmask_b32 v105, v105, v233, s[82:83]
v_cndmask_b32 v106, v106, v233, s[84:85]
v_cndmask_b32 v107, v107, v233, s[86:87]
v_cndmask_b32 v108, v108, v233, s[88:89]
v_cndmask_b32 v109, v109, v233, s[90:91]
v_cndmask_b32 v110, v110, v233, s[92:93]
v_cndmask_b32 v111, v111, v233, s[94:95]
L_nomask_100061:
s_nop 7
v_max3_f32 v232, v96, v97, v232
v_max3_f32 v232, v98, v99, v232
v_max3_f32 v232, v100, v101, v232
v_max3_f32 v232, v102, v103, v232
v_max3_f32 v232, v104, v105, v232
v_max3_f32 v232, v106, v107, v232
v_max3_f32 v232, v108, v109, v232
v_max3_f32 v232, v110, v111, v232
s_cmp_eq_u32 s53, 1
s_cbranch_scc1 L_p1x_100060
v_mfma_f32_32x32x16_bf16 v[96:111], v[160:163], v[56:59], 0
v_max3_f32 v232, v112, v113, v232
v_max3_f32 v232, v114, v115, v232
v_max3_f32 v232, v116, v117, v232
v_max3_f32 v232, v118, v119, v232
v_mfma_f32_32x32x16_bf16 v[96:111], v[164:167], v[60:63], v[96:111]
v_max3_f32 v232, v120, v121, v232
v_max3_f32 v232, v122, v123, v232
v_max3_f32 v232, v124, v125, v232
v_max3_f32 v232, v126, v127, v232
s_cmp_eq_u32 s53, 2
s_cbranch_scc1 L_p1x_100060
v_mfma_f32_32x32x16_bf16 v[112:127], v[168:171], v[56:59], 0
s_nop 4
v_max3_f32 v232, v96, v97, v232
v_max3_f32 v232, v98, v99, v232
v_max3_f32 v232, v100, v101, v232
v_max3_f32 v232, v102, v103, v232
v_mfma_f32_32x32x16_bf16 v[112:127], v[172:175], v[60:63], v[112:127]
v_max3_f32 v232, v104, v105, v232
v_max3_f32 v232, v106, v107, v232
v_max3_f32 v232, v108, v109, v232
v_max3_f32 v232, v110, v111, v232
s_cmp_eq_u32 s53, 3
s_cbranch_scc1 L_p1x_100060
v_mfma_f32_32x32x16_bf16 v[96:111], v[176:179], v[56:59], 0
s_nop 4
v_max3_f32 v232, v112, v113, v232
v_max3_f32 v232, v114, v115, v232
v_max3_f32 v232, v116, v117, v232
v_max3_f32 v232, v118, v119, v232
v_mfma_f32_32x32x16_bf16 v[96:111], v[180:183], v[60:63], v[96:111]
v_max3_f32 v232, v120, v121, v232
v_max3_f32 v232, v122, v123, v232
v_max3_f32 v232, v124, v125, v232
v_max3_f32 v232, v126, v127, v232
s_cmp_eq_u32 s53, 4
s_cbranch_scc1 L_p1x_100060
v_mfma_f32_32x32x16_bf16 v[112:127], v[184:187], v[56:59], 0
s_nop 4
v_max3_f32 v232, v96, v97, v232
v_max3_f32 v232, v98, v99, v232
v_max3_f32 v232, v100, v101, v232
v_max3_f32 v232, v102, v103, v232
v_mfma_f32_32x32x16_bf16 v[112:127], v[188:191], v[60:63], v[112:127]
v_max3_f32 v232, v104, v105, v232
v_max3_f32 v232, v106, v107, v232
v_max3_f32 v232, v108, v109, v232
v_max3_f32 v232, v110, v111, v232
s_cmp_eq_u32 s53, 5
s_cbranch_scc1 L_p1x_100060
v_mfma_f32_32x32x16_bf16 v[96:111], v[192:195], v[56:59], 0
s_nop 4
v_max3_f32 v232, v112, v113, v232
v_max3_f32 v232, v114, v115, v232
v_max3_f32 v232, v116, v117, v232
v_max3_f32 v232, v118, v119, v232
v_mfma_f32_32x32x16_bf16 v[96:111], v[196:199], v[60:63], v[96:111]
v_max3_f32 v232, v120, v121, v232
v_max3_f32 v232, v122, v123, v232
v_max3_f32 v232, v124, v125, v232
v_max3_f32 v232, v126, v127, v232
s_cmp_eq_u32 s53, 6
s_cbranch_scc1 L_p1x_100060
v_mfma_f32_32x32x16_bf16 v[112:127], v[200:203], v[56:59], 0
s_nop 4
v_max3_f32 v232, v96, v97, v232
v_max3_f32 v232, v98, v99, v232
v_max3_f32 v232, v100, v101, v232
v_max3_f32 v232, v102, v103, v232
v_mfma_f32_32x32x16_bf16 v[112:127], v[204:207], v[60:63], v[112:127]
v_max3_f32 v232, v104, v105, v232
v_max3_f32 v232, v106, v107, v232
v_max3_f32 v232, v108, v109, v232
v_max3_f32 v232, v110, v111, v232
s_cmp_eq_u32 s53, 7
s_cbranch_scc1 L_p1x_100060
s_nop 5
v_max3_f32 v232, v112, v113, v232
v_max3_f32 v232, v114, v115, v232
v_max3_f32 v232, v116, v117, v232
v_max3_f32 v232, v118, v119, v232
v_max3_f32 v232, v120, v121, v232
v_max3_f32 v232, v122, v123, v232
v_max3_f32 v232, v124, v125, v232
v_max3_f32 v232, v126, v127, v232
L_p1x_100060:
v_mov_b32 v235, v232
s_nop 1
v_permlane32_swap_b32 v232, v235
v_max_f32 v232, v232, v235
v_sub_f32 v234, v234, v232
v_exp_f32 v234, v234
v_pk_mul_f32 v[80:81], v[232:233], -1.0 op_sel_hi:[0,0]
v_pk_mul_f32 v[82:83], v[232:233], -1.0 op_sel_hi:[0,0]
v_pk_mul_f32 v[84:85], v[232:233], -1.0 op_sel_hi:[0,0]
v_pk_mul_f32 v[86:87], v[232:233], -1.0 op_sel_hi:[0,0]
v_pk_mul_f32 v[88:89], v[232:233], -1.0 op_sel_hi:[0,0]
v_pk_mul_f32 v[90:91], v[232:233], -1.0 op_sel_hi:[0,0]
v_pk_mul_f32 v[92:93], v[232:233], -1.0 op_sel_hi:[0,0]
v_pk_mul_f32 v[94:95], v[232:233], -1.0 op_sel_hi:[0,0]
v_mul_f32 v64, v64, v234
v_mul_f32 v65, v65, v234
v_mul_f32 v66, v66, v234
v_mul_f32 v67, v67, v234
v_mul_f32 v68, v68, v234
v_mul_f32 v69, v69, v234
v_mul_f32 v70, v70, v234
v_mul_f32 v71, v71, v234
v_mul_f32 v72, v72, v234
v_mul_f32 v73, v73, v234
v_mul_f32 v74, v74, v234
v_mul_f32 v75, v75, v234
v_mul_f32 v76, v76, v234
v_mul_f32 v77, v77, v234
v_mul_f32 v78, v78, v234
v_mul_f32 v79, v79, v234
v_mfma_f32_32x32x16_bf16 v[96:111], v[144:147], v[56:59], v[80:95]
v_mfma_f32_32x32x16_bf16 v[96:111], v[148:151], v[60:63], v[96:111]
v_mfma_f32_32x32x16_bf16 v[112:127], v[152:155], v[56:59], v[80:95]
v_mfma_f32_32x32x16_bf16 v[112:127], v[156:159], v[60:63], v[112:127]
ds_read_b128 v[208:211], v236 offset:2048
ds_read_b128 v[212:215], v236 offset:3072
ds_read_b128 v[216:219], v236 offset:6144
ds_read_b128 v[220:223], v236 offset:7168
s_cmp_eq_u32 s54, 0
s_cbranch_scc1 L_nomask_100063
s_nop 3
v_cndmask_b32 v96, v96, v233, s[64:65]
v_cndmask_b32 v97, v97, v233, s[66:67]
v_cndmask_b32 v98, v98, v233, s[68:69]
v_cndmask_b32 v99, v99, v233, s[70:71]
v_cndmask_b32 v100, v100, v233, s[72:73]
v_cndmask_b32 v101, v101, v233, s[74:75]
v_cndmask_b32 v102, v102, v233, s[76:77]
v_cndmask_b32 v103, v103, v233, s[78:79]
v_cndmask_b32 v104, v104, v233, s[80:81]
v_cndmask_b32 v105, v105, v233, s[82:83]
v_cndmask_b32 v106, v106, v233, s[84:85]
v_cndmask_b32 v107, v107, v233, s[86:87]
v_cndmask_b32 v108, v108, v233, s[88:89]
v_cndmask_b32 v109, v109, v233, s[90:91]
v_cndmask_b32 v110, v110, v233, s[92:93]
v_cndmask_b32 v111, v111, v233, s[94:95]
L_nomask_100063:
s_nop 3
v_exp_f32 v96, v96
v_exp_f32 v97, v97
v_exp_f32 v98, v98
v_exp_f32 v99, v99
v_exp_f32 v100, v100
v_exp_f32 v101, v101
v_exp_f32 v102, v102
v_exp_f32 v103, v103
v_cvt_pk_bf16_f32 v128, v96, v97
v_cvt_pk_bf16_f32 v129, v98, v99
v_exp_f32 v104, v104
v_exp_f32 v105, v105
v_exp_f32 v106, v106
v_exp_f32 v107, v107
v_cvt_pk_bf16_f32 v130, v100, v101
v_cvt_pk_bf16_f32 v131, v102, v103
v_exp_f32 v108, v108
v_exp_f32 v109, v109
v_exp_f32 v110, v110
v_exp_f32 v111, v111
v_cvt_pk_bf16_f32 v132, v104, v105
v_cvt_pk_bf16_f32 v133, v106, v107
v_cvt_pk_bf16_f32 v134, v108, v109
v_cvt_pk_bf16_f32 v135, v110, v111
v_mfma_f32_32x32x16_bf16 v[96:111], v[160:163], v[56:59], v[80:95]
v_exp_f32 v112, v112
v_exp_f32 v113, v113
v_exp_f32 v114, v114
v_exp_f32 v115, v115
v_mfma_f32_32x32x16_bf16 v[96:111], v[164:167], v[60:63], v[96:111]
v_exp_f32 v116, v116
v_exp_f32 v117, v117
v_exp_f32 v118, v118
v_exp_f32 v119, v119
v_cvt_pk_bf16_f32 v136, v112, v113
v_cvt_pk_bf16_f32 v137, v114, v115
s_waitcnt lgkmcnt(2)
v_mfma_f32_32x32x16_bf16 v[240:255], v[208:211], v[128:131], v[64:79]
v_exp_f32 v120, v120
v_exp_f32 v121, v121
v_exp_f32 v122, v122
v_exp_f32 v123, v123
v_cvt_pk_bf16_f32 v138, v116, v117
v_cvt_pk_bf16_f32 v139, v118, v119
v_mfma_f32_32x32x16_bf16 v[240:255], v[212:215], v[132:135], v[240:255]
ds_read_b128 v[224:227], v236 offset:10240
ds_read_b128 v[228:231], v236 offset:11264
v_exp_f32 v124, v124
v_exp_f32 v125, v125
v_exp_f32 v126, v126
v_exp_f32 v127, v127
v_cvt_pk_bf16_f32 v140, v120, v121
v_cvt_pk_bf16_f32 v141, v122, v123
v_cvt_pk_bf16_f32 v142, v124, v125
v_cvt_pk_bf16_f32 v143, v126, v127
v_mfma_f32_32x32x16_bf16 v[112:127], v[168:171], v[56:59], v[80:95]
v_exp_f32 v96, v96
v_exp_f32 v97, v97
v_exp_f32 v98, v98
v_exp_f32 v99, v99
v_mfma_f32_32x32x16_bf16 v[112:127], v[172:175], v[60:63], v[112:127]
v_exp_f32 v100, v100
v_exp_f32 v101, v101
v_exp_f32 v102, v102
v_exp_f32 v103, v103
v_cvt_pk_bf16_f32 v128, v96, v97
v_cvt_pk_bf16_f32 v129, v98, v99
s_waitcnt lgkmcnt(2)
v_mfma_f32_32x32x16_bf16 v[240:255], v[216:219], v[136:139], v[240:255]
v_exp_f32 v104, v104
v_exp_f32 v105, v105
v_exp_f32 v106, v106
v_exp_f32 v107, v107
v_cvt_pk_bf16_f32 v130, v100, v101
v_cvt_pk_bf16_f32 v131, v102, v103
v_mfma_f32_32x32x16_bf16 v[240:255], v[220:223], v[140:143], v[240:255]
ds_read_b128 v[208:211], v236 offset:14336
ds_read_b128 v[212:215], v236 offset:15360
v_exp_f32 v108, v108
v_exp_f32 v109, v109
v_exp_f32 v110, v110
v_exp_f32 v111, v111
v_cvt_pk_bf16_f32 v132, v104, v105
v_cvt_pk_bf16_f32 v133, v106, v107
v_cvt_pk_bf16_f32 v134, v108, v109
v_cvt_pk_bf16_f32 v135, v110, v111
v_mfma_f32_32x32x16_bf16 v[96:111], v[176:179], v[56:59], v[80:95]
v_exp_f32 v112, v112
v_exp_f32 v113, v113
v_exp_f32 v114, v114
v_exp_f32 v115, v115
v_mfma_f32_32x32x16_bf16 v[96:111], v[180:183], v[60:63], v[96:111]
v_exp_f32 v116, v116
v_exp_f32 v117, v117
v_exp_f32 v118, v118
v_exp_f32 v119, v119
v_cvt_pk_bf16_f32 v136, v112, v113
v_cvt_pk_bf16_f32 v137, v114, v115
s_waitcnt lgkmcnt(2)
v_mfma_f32_32x32x16_bf16 v[240:255], v[224:227], v[128:131], v[240:255]
v_exp_f32 v120, v120
v_exp_f32 v121, v121
v_exp_f32 v122, v122
v_exp_f32 v123, v123
v_cvt_pk_bf16_f32 v138, v116, v117
v_cvt_pk_bf16_f32 v139, v118, v119
v_mfma_f32_32x32x16_bf16 v[240:255], v[228:231], v[132:135], v[240:255]
ds_read_b128 v[216:219], v236 offset:18432
ds_read_b128 v[220:223], v236 offset:19456
v_exp_f32 v124, v124
v_exp_f32 v125, v125
v_exp_f32 v126, v126
v_exp_f32 v127, v127
v_cvt_pk_bf16_f32 v140, v120, v121
v_cvt_pk_bf16_f32 v141, v122, v123
v_cvt_pk_bf16_f32 v142, v124, v125
v_cvt_pk_bf16_f32 v143, v126, v127
s_cmp_eq_u32 s53, 4
s_cbranch_scc1 L_p2s_100064
v_mfma_f32_32x32x16_bf16 v[112:127], v[184:187], v[56:59], v[80:95]
v_exp_f32 v96, v96
v_exp_f32 v97, v97
v_exp_f32 v98, v98
v_exp_f32 v99, v99
v_mfma_f32_32x32x16_bf16 v[112:127], v[188:191], v[60:63], v[112:127]
v_exp_f32 v100, v100
v_exp_f32 v101, v101
v_exp_f32 v102, v102
v_exp_f32 v103, v103
v_cvt_pk_bf16_f32 v128, v96, v97
v_cvt_pk_bf16_f32 v129, v98, v99
s_waitcnt lgkmcnt(2)
v_mfma_f32_32x32x16_bf16 v[240:255], v[208:211], v[136:139], v[240:255]
v_exp_f32 v104, v104
v_exp_f32 v105, v105
v_exp_f32 v106, v106
v_exp_f32 v107, v107
v_cvt_pk_bf16_f32 v130, v100, v101
v_cvt_pk_bf16_f32 v131, v102, v103
v_mfma_f32_32x32x16_bf16 v[240:255], v[212:215], v[140:143], v[240:255]
ds_read_b128 v[224:227], v236 offset:22528
ds_read_b128 v[228:231], v236 offset:23552
v_exp_f32 v108, v108
v_exp_f32 v109, v109
v_exp_f32 v110, v110
v_exp_f32 v111, v111
v_cvt_pk_bf16_f32 v132, v104, v105
v_cvt_pk_bf16_f32 v133, v106, v107
v_cvt_pk_bf16_f32 v134, v108, v109
v_cvt_pk_bf16_f32 v135, v110, v111
s_cmp_eq_u32 s53, 5
s_cbranch_scc1 L_p2s_100065
v_mfma_f32_32x32x16_bf16 v[96:111], v[192:195], v[56:59], v[80:95]
v_exp_f32 v112, v112
v_exp_f32 v113, v113
v_exp_f32 v114, v114
v_exp_f32 v115, v115
v_mfma_f32_32x32x16_bf16 v[96:111], v[196:199], v[60:63], v[96:111]
v_exp_f32 v116, v116
v_exp_f32 v117, v117
v_exp_f32 v118, v118
v_exp_f32 v119, v119
v_cvt_pk_bf16_f32 v136, v112, v113
v_cvt_pk_bf16_f32 v137, v114, v115
s_waitcnt lgkmcnt(2)
v_mfma_f32_32x32x16_bf16 v[240:255], v[216:219], v[128:131], v[240:255]
v_exp_f32 v120, v120
v_exp_f32 v121, v121
v_exp_f32 v122, v122
v_exp_f32 v123, v123
v_cvt_pk_bf16_f32 v138, v116, v117
v_cvt_pk_bf16_f32 v139, v118, v119
v_mfma_f32_32x32x16_bf16 v[240:255], v[220:223], v[132:135], v[240:255]
ds_read_b128 v[208:211], v236 offset:26624
ds_read_b128 v[212:215], v236 offset:27648
v_exp_f32 v124, v124
v_exp_f32 v125, v125
v_exp_f32 v126, v126
v_exp_f32 v127, v127
v_cvt_pk_bf16_f32 v140, v120, v121
v_cvt_pk_bf16_f32 v141, v122, v123
v_cvt_pk_bf16_f32 v142, v124, v125
v_cvt_pk_bf16_f32 v143, v126, v127
s_cmp_eq_u32 s53, 6
s_cbranch_scc1 L_p2s_100066
v_mfma_f32_32x32x16_bf16 v[112:127], v[200:203], v[56:59], v[80:95]
v_exp_f32 v96, v96
v_exp_f32 v97, v97
v_exp_f32 v98, v98
v_exp_f32 v99, v99
v_mfma_f32_32x32x16_bf16 v[112:127], v[204:207], v[60:63], v[112:127]
v_exp_f32 v100, v100
v_exp_f32 v101, v101
v_exp_f32 v102, v102
v_exp_f32 v103, v103
v_cvt_pk_bf16_f32 v128, v96, v97
v_cvt_pk_bf16_f32 v129, v98, v99
s_waitcnt lgkmcnt(2)
v_mfma_f32_32x32x16_bf16 v[240:255], v[224:227], v[136:139], v[240:255]
v_exp_f32 v104, v104
v_exp_f32 v105, v105
v_exp_f32 v106, v106
v_exp_f32 v107, v107
v_cvt_pk_bf16_f32 v130, v100, v101
v_cvt_pk_bf16_f32 v131, v102, v103
v_mfma_f32_32x32x16_bf16 v[240:255], v[228:231], v[140:143], v[240:255]
ds_read_b128 v[216:219], v236 offset:30720
ds_read_b128 v[220:223], v236 offset:31744
v_exp_f32 v108, v108
v_exp_f32 v109, v109
v_exp_f32 v110, v110
v_exp_f32 v111, v111
v_cvt_pk_bf16_f32 v132, v104, v105
v_cvt_pk_bf16_f32 v133, v106, v107
v_cvt_pk_bf16_f32 v134, v108, v109
v_cvt_pk_bf16_f32 v135, v110, v111
s_cmp_eq_u32 s53, 7
s_cbranch_scc1 L_p2s_100067
s_waitcnt lgkmcnt(2)
v_mfma_f32_32x32x16_bf16 v[240:255], v[208:211], v[128:131], v[240:255]
v_exp_f32 v112, v112
v_exp_f32 v113, v113
v_exp_f32 v114, v114
v_exp_f32 v115, v115
v_exp_f32 v116, v116
v_exp_f32 v117, v117
v_exp_f32 v118, v118
v_exp_f32 v119, v119
v_cvt_pk_bf16_f32 v136, v112, v113
v_cvt_pk_bf16_f32 v137, v114, v115
v_mfma_f32_32x32x16_bf16 v[240:255], v[212:215], v[132:135], v[240:255]
v_exp_f32 v120, v120
v_exp_f32 v121, v121
v_exp_f32 v122, v122
v_exp_f32 v123, v123
v_cvt_pk_bf16_f32 v138, v116, v117
v_cvt_pk_bf16_f32 v139, v118, v119
v_exp_f32 v124, v124
v_exp_f32 v125, v125
v_exp_f32 v126, v126
v_exp_f32 v127, v127
v_cvt_pk_bf16_f32 v140, v120, v121
v_cvt_pk_bf16_f32 v141, v122, v123
v_cvt_pk_bf16_f32 v142, v124, v125
v_cvt_pk_bf16_f32 v143, v126, v127
s_waitcnt lgkmcnt(0)
v_mfma_f32_32x32x16_bf16 v[240:255], v[216:219], v[136:139], v[240:255]
v_mfma_f32_32x32x16_bf16 v[240:255], v[220:223], v[140:143], v[240:255]
s_branch L_p2x_100062
L_p2s_100064:
s_waitcnt lgkmcnt(0)
v_mfma_f32_32x32x16_bf16 v[240:255], v[208:211], v[136:139], v[240:255]
v_mfma_f32_32x32x16_bf16 v[240:255], v[212:215], v[140:143], v[240:255]
s_branch L_p2x_100062
L_p2s_100065:
s_waitcnt lgkmcnt(0)
v_mfma_f32_32x32x16_bf16 v[240:255], v[216:219], v[128:131], v[240:255]
v_mfma_f32_32x32x16_bf16 v[240:255], v[220:223], v[132:135], v[240:255]
s_branch L_p2x_100062
L_p2s_100066:
s_waitcnt lgkmcnt(0)
v_mfma_f32_32x32x16_bf16 v[240:255], v[224:227], v[136:139], v[240:255]
v_mfma_f32_32x32x16_bf16 v[240:255], v[228:231], v[140:143], v[240:255]
s_branch L_p2x_100062
L_p2s_100067:
s_waitcnt lgkmcnt(0)
v_mfma_f32_32x32x16_bf16 v[240:255], v[208:211], v[128:131], v[240:255]
v_mfma_f32_32x32x16_bf16 v[240:255], v[212:215], v[132:135], v[240:255]
L_p2x_100062:
s_branch L_segbdone_51
L_chk_60:
buffer_load_dwordx4 v[8:11], v12, s[28:31], s50 offen sc1
s_sub_u32 s59, s59, 1
s_cbranch_scc1 L_fin
s_waitcnt vmcnt(0)
v_cmp_ne_u64 vcc, s[44:45], v[8:9]
s_cbranch_vccnz L_chk_60
s_branch L_chkok_61
L_slow_62:
buffer_store_dwordx2 v[240:241], v7, s[28:31], s46 offen offset:0 sc1
buffer_store_dwordx2 v[242:243], v7, s[28:31], s46 offen offset:512 sc1
buffer_store_dwordx2 v[244:245], v7, s[28:31], s46 offen offset:1024 sc1
s_mov_b32 exec_hi, 0
buffer_store_dwordx2 v[246:247], v7, s[28:31], s46 offen offset:1536 sc1
s_mov_b32 exec_hi, -1
s_branch L_stored_63
L_slow_64:
s_waitcnt vmcnt(0)
buffer_store_dwordx2 v[2:3], v4, s[28:31], s47 offen sc1
s_branch L_stored_65
L_slow_69:
buffer_store_dwordx2 v[88:89], v5, s[28:31], s3 offen offset:0 sc1
buffer_store_dwordx2 v[90:91], v5, s[28:31], s3 offen offset:256 sc1
buffer_store_dwordx2 v[92:93], v5, s[28:31], s3 offen offset:512 sc1
s_mov_b64 exec, s[50:51]
buffer_store_dwordx2 v[94:95], v5, s[28:31], s3 offen offset:768 sc1
s_mov_b64 exec, -1
s_branch L_stored_70
L_slow_71:
s_mov_b32 exec_hi, 0
buffer_store_dwordx2 v[98:99], v7, s[28:31], s43 offen sc1
s_mov_b32 exec_hi, -1
s_branch L_stored_72
L_slow_73:
s_waitcnt vmcnt(0)
buffer_store_dwordx2 v[2:3], v4, s[28:31], s55 offen sc1
s_branch L_stored_74
L_slow_78:
s_waitcnt vmcnt(13)
buffer_store_dwordx2 v[242:243], v241, s[28:31], s55 offen sc1
s_branch L_stored_79
L_chk_80:
buffer_load_dwordx2 v[240:241], v8, s[28:31], s47 offen sc1
s_sub_u32 s59, s59, 1
s_cbranch_scc1 L_fin
s_waitcnt vmcnt(0)
v_cmp_ne_u64 vcc, s[44:45], v[240:241]
s_cbranch_vccnz L_chk_80
s_branch L_chkok_81
L_slow_82:
s_waitcnt vmcnt(10)
buffer_store_dwordx2 v[2:3], v4, s[28:31], s56 offen sc1
s_branch L_stored_83
L_chk_84:
buffer_load_dwordx2 v[10:11], v9, s[28:31], s47 offen sc1
s_sub_u32 s59, s59, 1
s_cbranch_scc1 L_fin
s_waitcnt vmcnt(0)
v_cmp_ne_u64 vcc, s[44:45], v[10:11]
s_cbranch_vccnz L_chk_84
s_branch L_chkok_85
L_slow_86:
buffer_store_dwordx2 v[88:89], v5, s[28:31], s3 offen offset:0 sc1
buffer_store_dwordx2 v[90:91], v5, s[28:31], s3 offen offset:512 sc1
buffer_store_dwordx2 v[92:93], v5, s[28:31], s3 offen offset:1024 sc1
s_mov_b64 exec, s[50:51]
buffer_store_dwordx2 v[94:95], v5, s[28:31], s3 offen offset:1536 sc1
s_mov_b64 exec, -1
s_branch L_stored_87
L_slow_88:
s_mov_b32 exec_hi, 0
buffer_store_dwordx2 v[98:99], v7, s[28:31], s43 offen sc1
s_mov_b32 exec_hi, -1
s_branch L_stored_89
L_slow_90:
s_waitcnt vmcnt(0)
buffer_store_dwordx2 v[2:3], v4, s[28:31], s55 offen sc1
s_branch L_stored_91
L_chk_99:
buffer_load_dwordx2 v[4:5], v2, s[28:31], s48 offen sc1
s_sub_u32 s59, s59, 1
s_cbranch_scc1 L_fin
s_waitcnt vmcnt(0)
v_cmp_ne_u64 vcc, s[44:45], v[4:5]
s_cbranch_vccnz L_chk_99
s_branch L_chkok_100
L_nosegb_106:
s_and_b32 s56, s36, 1
s_lshl_b32 s56, s56, 2
s_add_u32 s56, s56, s38
s_mul_i32 s56, s56, 6272
s_mul_i32 s57, s37, 100352
s_add_u32 s56, s56, s57
s_add_u32 s56, s56, 24691712
v_mul_u32_u24 v14, 128, v0
s_mov_b32 exec_lo, 0xffffffff
s_mov_b32 exec_hi, 0x1ffff
buffer_load_dword v14, v14, s[28:31], s56 offen
s_mov_b64 exec, -1
v_mov_b32 v240, v64
v_mov_b32 v241, v65
v_mov_b32 v242, v66
v_mov_b32 v243, v67
v_mov_b32 v244, v68
v_mov_b32 v245, v69
v_mov_b32 v246, v70
v_mov_b32 v247, v71
v_mov_b32 v248, v72
v_mov_b32 v249, v73
v_mov_b32 v250, v74
v_mov_b32 v251, v75
v_mov_b32 v252, v76
v_mov_b32 v253, v77
v_mov_b32 v254, v78
v_mov_b32 v255, v79
s_branch L_segbdone_107
L_redo_109:
s_waitcnt lgkmcnt(0)
v_mov_b32 v234, v232
v_mfma_f32_32x32x16_bf16 v[96:111], v[144:147], v[56:59], 0
v_mfma_f32_32x32x16_bf16 v[96:111], v[148:151], v[60:63], v[96:111]
v_mfma_f32_32x32x16_bf16 v[112:127], v[152:155], v[56:59], 0
v_mfma_f32_32x32x16_bf16 v[112:127], v[156:159], v[60:63], v[112:127]
s_cmp_eq_u32 s54, 0
s_cbranch_scc1 L_nomask_200117
s_nop 7
v_cndmask_b32 v96, v96, v233, s[64:65]
v_cndmask_b32 v97, v97, v233, s[66:67]
v_cndmask_b32 v98, v98, v233, s[68:69]
v_cndmask_b32 v99, v99, v233, s[70:71]
v_cndmask_b32 v100, v100, v233, s[72:73]
v_cndmask_b32 v101, v101, v233, s[74:75]
v_cndmask_b32 v102, v102, v233, s[76:77]
v_cndmask_b32 v103, v103, v233, s[78:79]
v_cndmask_b32 v104, v104, v233, s[80:81]
v_cndmask_b32 v105, v105, v233, s[82:83]
v_cndmask_b32 v106, v106, v233, s[84:85]
v_cndmask_b32 v107, v107, v233, s[86:87]
v_cndmask_b32 v108, v108, v233, s[88:89]
v_cndmask_b32 v109, v109, v233, s[90:91]
v_cndmask_b32 v110, v110, v233, s[92:93]
v_cndmask_b32 v111, v111, v233, s[94:95]
L_nomask_200117:
s_nop 7
v_max3_f32 v232, v96, v97, v232
v_max3_f32 v232, v98, v99, v232
v_max3_f32 v232, v100, v101, v232
v_max3_f32 v232, v102, v103, v232
v_max3_f32 v232, v104, v105, v232
v_max3_f32 v232, v106, v107, v232
v_max3_f32 v232, v108, v109, v232
v_max3_f32 v232, v110, v111, v232
s_cmp_eq_u32 s53, 1
s_cbranch_scc1 L_p1x_200116
v_mfma_f32_32x32x16_bf16 v[96:111], v[160:163], v[56:59], 0
v_max3_f32 v232, v112, v113, v232
v_max3_f32 v232, v114, v115, v232
v_max3_f32 v232, v116, v117, v232
v_max3_f32 v232, v118, v119, v232
v_mfma_f32_32x32x16_bf16 v[96:111], v[164:167], v[60:63], v[96:111]
v_max3_f32 v232, v120, v121, v232
v_max3_f32 v232, v122, v123, v232
v_max3_f32 v232, v124, v125, v232
v_max3_f32 v232, v126, v127, v232
s_cmp_eq_u32 s53, 2
s_cbranch_scc1 L_p1x_200116
v_mfma_f32_32x32x16_bf16 v[112:127], v[168:171], v[56:59], 0
s_nop 4
v_max3_f32 v232, v96, v97, v232
v_max3_f32 v232, v98, v99, v232
v_max3_f32 v232, v100, v101, v232
v_max3_f32 v232, v102, v103, v232
v_mfma_f32_32x32x16_bf16 v[112:127], v[172:175], v[60:63], v[112:127]
v_max3_f32 v232, v104, v105, v232
v_max3_f32 v232, v106, v107, v232
v_max3_f32 v232, v108, v109, v232
v_max3_f32 v232, v110, v111, v232
s_cmp_eq_u32 s53, 3
s_cbranch_scc1 L_p1x_200116
v_mfma_f32_32x32x16_bf16 v[96:111], v[176:179], v[56:59], 0
s_nop 4
v_max3_f32 v232, v112, v113, v232
v_max3_f32 v232, v114, v115, v232
v_max3_f32 v232, v116, v117, v232
v_max3_f32 v232, v118, v119, v232
v_mfma_f32_32x32x16_bf16 v[96:111], v[180:183], v[60:63], v[96:111]
v_max3_f32 v232, v120, v121, v232
v_max3_f32 v232, v122, v123, v232
v_max3_f32 v232, v124, v125, v232
v_max3_f32 v232, v126, v127, v232
s_cmp_eq_u32 s53, 4
s_cbranch_scc1 L_p1x_200116
v_mfma_f32_32x32x16_bf16 v[112:127], v[184:187], v[56:59], 0
s_nop 4
v_max3_f32 v232, v96, v97, v232
v_max3_f32 v232, v98, v99, v232
v_max3_f32 v232, v100, v101, v232
v_max3_f32 v232, v102, v103, v232
v_mfma_f32_32x32x16_bf16 v[112:127], v[188:191], v[60:63], v[112:127]
v_max3_f32 v232, v104, v105, v232
v_max3_f32 v232, v106, v107, v232
v_max3_f32 v232, v108, v109, v232
v_max3_f32 v232, v110, v111, v232
s_cmp_eq_u32 s53, 5
s_cbranch_scc1 L_p1x_200116
v_mfma_f32_32x32x16_bf16 v[96:111], v[192:195], v[56:59], 0
s_nop 4
v_max3_f32 v232, v112, v113, v232
v_max3_f32 v232, v114, v115, v232
v_max3_f32 v232, v116, v117, v232
v_max3_f32 v232, v118, v119, v232
v_mfma_f32_32x32x16_bf16 v[96:111], v[196:199], v[60:63], v[96:111]
v_max3_f32 v232, v120, v121, v232
v_max3_f32 v232, v122, v123, v232
v_max3_f32 v232, v124, v125, v232
v_max3_f32 v232, v126, v127, v232
s_cmp_eq_u32 s53, 6
s_cbranch_scc1 L_p1x_200116
v_mfma_f32_32x32x16_bf16 v[112:127], v[200:203], v[56:59], 0
s_nop 4
v_max3_f32 v232, v96, v97, v232
v_max3_f32 v232, v98, v99, v232
v_max3_f32 v232, v100, v101, v232
v_max3_f32 v232, v102, v103, v232
v_mfma_f32_32x32x16_bf16 v[112:127], v[204:207], v[60:63], v[112:127]
v_max3_f32 v232, v104, v105, v232
v_max3_f32 v232, v106, v107, v232
v_max3_f32 v232, v108, v109, v232
v_max3_f32 v232, v110, v111, v232
s_cmp_eq_u32 s53, 7
s_cbranch_scc1 L_p1x_200116
s_nop 5
v_max3_f32 v232, v112, v113, v232
v_max3_f32 v232, v114, v115, v232
v_max3_f32 v232, v116, v117, v232
v_max3_f32 v232, v118, v119, v232
v_max3_f32 v232, v120, v121, v232
v_max3_f32 v232, v122, v123, v232
v_max3_f32 v232, v124, v125, v232
v_max3_f32 v232, v126, v127, v232
L_p1x_200116:
v_mov_b32 v235, v232
s_nop 1
v_permlane32_swap_b32 v232, v235
v_max_f32 v232, v232, v235
v_sub_f32 v234, v234, v232
v_exp_f32 v234, v234
v_pk_mul_f32 v[80:81], v[232:233], -1.0 op_sel_hi:[0,0]
v_pk_mul_f32 v[82:83], v[232:233], -1.0 op_sel_hi:[0,0]
v_pk_mul_f32 v[84:85], v[232:233], -1.0 op_sel_hi:[0,0]
v_pk_mul_f32 v[86:87], v[232:233], -1.0 op_sel_hi:[0,0]
v_pk_mul_f32 v[88:89], v[232:233], -1.0 op_sel_hi:[0,0]
v_pk_mul_f32 v[90:91], v[232:233], -1.0 op_sel_hi:[0,0]
v_pk_mul_f32 v[92:93], v[232:233], -1.0 op_sel_hi:[0,0]
v_pk_mul_f32 v[94:95], v[232:233], -1.0 op_sel_hi:[0,0]
v_mul_f32 v64, v64, v234
v_mul_f32 v65, v65, v234
v_mul_f32 v66, v66, v234
v_mul_f32 v67, v67, v234
v_mul_f32 v68, v68, v234
v_mul_f32 v69, v69, v234
v_mul_f32 v70, v70, v234
v_mul_f32 v71, v71, v234
v_mul_f32 v72, v72, v234
v_mul_f32 v73, v73, v234
v_mul_f32 v74, v74, v234
v_mul_f32 v75, v75, v234
v_mul_f32 v76, v76, v234
v_mul_f32 v77, v77, v234
v_mul_f32 v78, v78, v234
v_mul_f32 v79, v79, v234
v_mfma_f32_32x32x16_bf16 v[96:111], v[144:147], v[56:59], v[80:95]
v_mfma_f32_32x32x16_bf16 v[96:111], v[148:151], v[60:63], v[96:111]
v_mfma_f32_32x32x16_bf16 v[112:127], v[152:155], v[56:59], v[80:95]
v_mfma_f32_32x32x16_bf16 v[112:127], v[156:159], v[60:63], v[112:127]
ds_read_b128 v[208:211], v236 offset:2048
ds_read_b128 v[212:215], v236 offset:3072
ds_read_b128 v[216:219], v236 offset:6144
ds_read_b128 v[220:223], v236 offset:7168
s_cmp_eq_u32 s54, 0
s_cbranch_scc1 L_nomask_200119
s_nop 3
v_cndmask_b32 v96, v96, v233, s[64:65]
v_cndmask_b32 v97, v97, v233, s[66:67]
v_cndmask_b32 v98, v98, v233, s[68:69]
v_cndmask_b32 v99, v99, v233, s[70:71]
v_cndmask_b32 v100, v100, v233, s[72:73]
v_cndmask_b32 v101, v101, v233, s[74:75]
v_cndmask_b32 v102, v102, v233, s[76:77]
v_cndmask_b32 v103, v103, v233, s[78:79]
v_cndmask_b32 v104, v104, v233, s[80:81]
v_cndmask_b32 v105, v105, v233, s[82:83]
v_cndmask_b32 v106, v106, v233, s[84:85]
v_cndmask_b32 v107, v107, v233, s[86:87]
v_cndmask_b32 v108, v108, v233, s[88:89]
v_cndmask_b32 v109, v109, v233, s[90:91]
v_cndmask_b32 v110, v110, v233, s[92:93]
v_cndmask_b32 v111, v111, v233, s[94:95]
L_nomask_200119:
s_nop 3
v_exp_f32 v96, v96
v_exp_f32 v97, v97
v_exp_f32 v98, v98
v_exp_f32 v99, v99
v_exp_f32 v100, v100
v_exp_f32 v101, v101
v_exp_f32 v102, v102
v_exp_f32 v103, v103
v_cvt_pk_bf16_f32 v128, v96, v97
v_cvt_pk_bf16_f32 v129, v98, v99
v_exp_f32 v104, v104
v_exp_f32 v105, v105
v_exp_f32 v106, v106
v_exp_f32 v107, v107
v_cvt_pk_bf16_f32 v130, v100, v101
v_cvt_pk_bf16_f32 v131, v102, v103
v_exp_f32 v108, v108
v_exp_f32 v109, v109
v_exp_f32 v110, v110
v_exp_f32 v111, v111
v_cvt_pk_bf16_f32 v132, v104, v105
v_cvt_pk_bf16_f32 v133, v106, v107
v_cvt_pk_bf16_f32 v134, v108, v109
v_cvt_pk_bf16_f32 v135, v110, v111
v_mfma_f32_32x32x16_bf16 v[96:111], v[160:163], v[56:59], v[80:95]
v_exp_f32 v112, v112
v_exp_f32 v113, v113
v_exp_f32 v114, v114
v_exp_f32 v115, v115
v_mfma_f32_32x32x16_bf16 v[96:111], v[164:167], v[60:63], v[96:111]
v_exp_f32 v116, v116
v_exp_f32 v117, v117
v_exp_f32 v118, v118
v_exp_f32 v119, v119
v_cvt_pk_bf16_f32 v136, v112, v113
v_cvt_pk_bf16_f32 v137, v114, v115
s_waitcnt lgkmcnt(2)
v_mfma_f32_32x32x16_bf16 v[240:255], v[208:211], v[128:131], v[64:79]
v_exp_f32 v120, v120
v_exp_f32 v121, v121
v_exp_f32 v122, v122
v_exp_f32 v123, v123
v_cvt_pk_bf16_f32 v138, v116, v117
v_cvt_pk_bf16_f32 v139, v118, v119
v_mfma_f32_32x32x16_bf16 v[240:255], v[212:215], v[132:135], v[240:255]
ds_read_b128 v[224:227], v236 offset:10240
ds_read_b128 v[228:231], v236 offset:11264
v_exp_f32 v124, v124
v_exp_f32 v125, v125
v_exp_f32 v126, v126
v_exp_f32 v127, v127
v_cvt_pk_bf16_f32 v140, v120, v121
v_cvt_pk_bf16_f32 v141, v122, v123
v_cvt_pk_bf16_f32 v142, v124, v125
v_cvt_pk_bf16_f32 v143, v126, v127
v_mfma_f32_32x32x16_bf16 v[112:127], v[168:171], v[56:59], v[80:95]
v_exp_f32 v96, v96
v_exp_f32 v97, v97
v_exp_f32 v98, v98
v_exp_f32 v99, v99
v_mfma_f32_32x32x16_bf16 v[112:127], v[172:175], v[60:63], v[112:127]
v_exp_f32 v100, v100
v_exp_f32 v101, v101
v_exp_f32 v102, v102
v_exp_f32 v103, v103
v_cvt_pk_bf16_f32 v128, v96, v97
v_cvt_pk_bf16_f32 v129, v98, v99
s_waitcnt lgkmcnt(2)
v_mfma_f32_32x32x16_bf16 v[240:255], v[216:219], v[136:139], v[240:255]
v_exp_f32 v104, v104
v_exp_f32 v105, v105
v_exp_f32 v106, v106
v_exp_f32 v107, v107
v_cvt_pk_bf16_f32 v130, v100, v101
v_cvt_pk_bf16_f32 v131, v102, v103
v_mfma_f32_32x32x16_bf16 v[240:255], v[220:223], v[140:143], v[240:255]
ds_read_b128 v[208:211], v236 offset:14336
ds_read_b128 v[212:215], v236 offset:15360
v_exp_f32 v108, v108
v_exp_f32 v109, v109
v_exp_f32 v110, v110
v_exp_f32 v111, v111
v_cvt_pk_bf16_f32 v132, v104, v105
v_cvt_pk_bf16_f32 v133, v106, v107
v_cvt_pk_bf16_f32 v134, v108, v109
v_cvt_pk_bf16_f32 v135, v110, v111
v_mfma_f32_32x32x16_bf16 v[96:111], v[176:179], v[56:59], v[80:95]
v_exp_f32 v112, v112
v_exp_f32 v113, v113
v_exp_f32 v114, v114
v_exp_f32 v115, v115
v_mfma_f32_32x32x16_bf16 v[96:111], v[180:183], v[60:63], v[96:111]
v_exp_f32 v116, v116
v_exp_f32 v117, v117
v_exp_f32 v118, v118
v_exp_f32 v119, v119
v_cvt_pk_bf16_f32 v136, v112, v113
v_cvt_pk_bf16_f32 v137, v114, v115
s_waitcnt lgkmcnt(2)
v_mfma_f32_32x32x16_bf16 v[240:255], v[224:227], v[128:131], v[240:255]
v_exp_f32 v120, v120
v_exp_f32 v121, v121
v_exp_f32 v122, v122
v_exp_f32 v123, v123
v_cvt_pk_bf16_f32 v138, v116, v117
v_cvt_pk_bf16_f32 v139, v118, v119
v_mfma_f32_32x32x16_bf16 v[240:255], v[228:231], v[132:135], v[240:255]
ds_read_b128 v[216:219], v236 offset:18432
ds_read_b128 v[220:223], v236 offset:19456
v_exp_f32 v124, v124
v_exp_f32 v125, v125
v_exp_f32 v126, v126
v_exp_f32 v127, v127
v_cvt_pk_bf16_f32 v140, v120, v121
v_cvt_pk_bf16_f32 v141, v122, v123
v_cvt_pk_bf16_f32 v142, v124, v125
v_cvt_pk_bf16_f32 v143, v126, v127
s_cmp_eq_u32 s53, 4
s_cbranch_scc1 L_p2s_200120
v_mfma_f32_32x32x16_bf16 v[112:127], v[184:187], v[56:59], v[80:95]
v_exp_f32 v96, v96
v_exp_f32 v97, v97
v_exp_f32 v98, v98
v_exp_f32 v99, v99
v_mfma_f32_32x32x16_bf16 v[112:127], v[188:191], v[60:63], v[112:127]
v_exp_f32 v100, v100
v_exp_f32 v101, v101
v_exp_f32 v102, v102
v_exp_f32 v103, v103
v_cvt_pk_bf16_f32 v128, v96, v97
v_cvt_pk_bf16_f32 v129, v98, v99
s_waitcnt lgkmcnt(2)
v_mfma_f32_32x32x16_bf16 v[240:255], v[208:211], v[136:139], v[240:255]
v_exp_f32 v104, v104
v_exp_f32 v105, v105
v_exp_f32 v106, v106
v_exp_f32 v107, v107
v_cvt_pk_bf16_f32 v130, v100, v101
v_cvt_pk_bf16_f32 v131, v102, v103
v_mfma_f32_32x32x16_bf16 v[240:255], v[212:215], v[140:143], v[240:255]
ds_read_b128 v[224:227], v236 offset:22528
ds_read_b128 v[228:231], v236 offset:23552
v_exp_f32 v108, v108
v_exp_f32 v109, v109
v_exp_f32 v110, v110
v_exp_f32 v111, v111
v_cvt_pk_bf16_f32 v132, v104, v105
v_cvt_pk_bf16_f32 v133, v106, v107
v_cvt_pk_bf16_f32 v134, v108, v109
v_cvt_pk_bf16_f32 v135, v110, v111
s_cmp_eq_u32 s53, 5
s_cbranch_scc1 L_p2s_200121
v_mfma_f32_32x32x16_bf16 v[96:111], v[192:195], v[56:59], v[80:95]
v_exp_f32 v112, v112
v_exp_f32 v113, v113
v_exp_f32 v114, v114
v_exp_f32 v115, v115
v_mfma_f32_32x32x16_bf16 v[96:111], v[196:199], v[60:63], v[96:111]
v_exp_f32 v116, v116
v_exp_f32 v117, v117
v_exp_f32 v118, v118
v_exp_f32 v119, v119
v_cvt_pk_bf16_f32 v136, v112, v113
v_cvt_pk_bf16_f32 v137, v114, v115
s_waitcnt lgkmcnt(2)
v_mfma_f32_32x32x16_bf16 v[240:255], v[216:219], v[128:131], v[240:255]
v_exp_f32 v120, v120
v_exp_f32 v121, v121
v_exp_f32 v122, v122
v_exp_f32 v123, v123
v_cvt_pk_bf16_f32 v138, v116, v117
v_cvt_pk_bf16_f32 v139, v118, v119
v_mfma_f32_32x32x16_bf16 v[240:255], v[220:223], v[132:135], v[240:255]
ds_read_b128 v[208:211], v236 offset:26624
ds_read_b128 v[212:215], v236 offset:27648
v_exp_f32 v124, v124
v_exp_f32 v125, v125
v_exp_f32 v126, v126
v_exp_f32 v127, v127
v_cvt_pk_bf16_f32 v140, v120, v121
v_cvt_pk_bf16_f32 v141, v122, v123
v_cvt_pk_bf16_f32 v142, v124, v125
v_cvt_pk_bf16_f32 v143, v126, v127
s_cmp_eq_u32 s53, 6
s_cbranch_scc1 L_p2s_200122
v_mfma_f32_32x32x16_bf16 v[112:127], v[200:203], v[56:59], v[80:95]
v_exp_f32 v96, v96
v_exp_f32 v97, v97
v_exp_f32 v98, v98
v_exp_f32 v99, v99
v_mfma_f32_32x32x16_bf16 v[112:127], v[204:207], v[60:63], v[112:127]
v_exp_f32 v100, v100
v_exp_f32 v101, v101
v_exp_f32 v102, v102
v_exp_f32 v103, v103
v_cvt_pk_bf16_f32 v128, v96, v97
v_cvt_pk_bf16_f32 v129, v98, v99
s_waitcnt lgkmcnt(2)
v_mfma_f32_32x32x16_bf16 v[240:255], v[224:227], v[136:139], v[240:255]
v_exp_f32 v104, v104
v_exp_f32 v105, v105
v_exp_f32 v106, v106
v_exp_f32 v107, v107
v_cvt_pk_bf16_f32 v130, v100, v101
v_cvt_pk_bf16_f32 v131, v102, v103
v_mfma_f32_32x32x16_bf16 v[240:255], v[228:231], v[140:143], v[240:255]
ds_read_b128 v[216:219], v236 offset:30720
ds_read_b128 v[220:223], v236 offset:31744
v_exp_f32 v108, v108
v_exp_f32 v109, v109
v_exp_f32 v110, v110
v_exp_f32 v111, v111
v_cvt_pk_bf16_f32 v132, v104, v105
v_cvt_pk_bf16_f32 v133, v106, v107
v_cvt_pk_bf16_f32 v134, v108, v109
v_cvt_pk_bf16_f32 v135, v110, v111
s_cmp_eq_u32 s53, 7
s_cbranch_scc1 L_p2s_200123
s_waitcnt lgkmcnt(2)
v_mfma_f32_32x32x16_bf16 v[240:255], v[208:211], v[128:131], v[240:255]
v_exp_f32 v112, v112
v_exp_f32 v113, v113
v_exp_f32 v114, v114
v_exp_f32 v115, v115
v_exp_f32 v116, v116
v_exp_f32 v117, v117
v_exp_f32 v118, v118
v_exp_f32 v119, v119
v_cvt_pk_bf16_f32 v136, v112, v113
v_cvt_pk_bf16_f32 v137, v114, v115
v_mfma_f32_32x32x16_bf16 v[240:255], v[212:215], v[132:135], v[240:255]
v_exp_f32 v120, v120
v_exp_f32 v121, v121
v_exp_f32 v122, v122
v_exp_f32 v123, v123
v_cvt_pk_bf16_f32 v138, v116, v117
v_cvt_pk_bf16_f32 v139, v118, v119
v_exp_f32 v124, v124
v_exp_f32 v125, v125
v_exp_f32 v126, v126
v_exp_f32 v127, v127
v_cvt_pk_bf16_f32 v140, v120, v121
v_cvt_pk_bf16_f32 v141, v122, v123
v_cvt_pk_bf16_f32 v142, v124, v125
v_cvt_pk_bf16_f32 v143, v126, v127
s_waitcnt lgkmcnt(0)
v_mfma_f32_32x32x16_bf16 v[240:255], v[216:219], v[136:139], v[240:255]
v_mfma_f32_32x32x16_bf16 v[240:255], v[220:223], v[140:143], v[240:255]
s_branch L_p2x_200118
L_p2s_200120:
s_waitcnt lgkmcnt(0)
v_mfma_f32_32x32x16_bf16 v[240:255], v[208:211], v[136:139], v[240:255]
v_mfma_f32_32x32x16_bf16 v[240:255], v[212:215], v[140:143], v[240:255]
s_branch L_p2x_200118
L_p2s_200121:
s_waitcnt lgkmcnt(0)
v_mfma_f32_32x32x16_bf16 v[240:255], v[216:219], v[128:131], v[240:255]
v_mfma_f32_32x32x16_bf16 v[240:255], v[220:223], v[132:135], v[240:255]
s_branch L_p2x_200118
L_p2s_200122:
s_waitcnt lgkmcnt(0)
v_mfma_f32_32x32x16_bf16 v[240:255], v[224:227], v[136:139], v[240:255]
v_mfma_f32_32x32x16_bf16 v[240:255], v[228:231], v[140:143], v[240:255]
s_branch L_p2x_200118
L_p2s_200123:
s_waitcnt lgkmcnt(0)
v_mfma_f32_32x32x16_bf16 v[240:255], v[208:211], v[128:131], v[240:255]
v_mfma_f32_32x32x16_bf16 v[240:255], v[212:215], v[132:135], v[240:255]
L_p2x_200118:
s_branch L_segbdone_107
L_slow_116:
buffer_store_dwordx2 v[240:241], v7, s[28:31], s46 offen offset:0 sc1
buffer_store_dwordx2 v[242:243], v7, s[28:31], s46 offen offset:512 sc1
buffer_store_dwordx2 v[244:245], v7, s[28:31], s46 offen offset:1024 sc1
s_mov_b32 exec_hi, 0
buffer_store_dwordx2 v[246:247], v7, s[28:31], s46 offen offset:1536 sc1
s_mov_b32 exec_hi, -1
s_branch L_stored_117
L_slow_118:
s_waitcnt vmcnt(0)
buffer_store_dwordx2 v[2:3], v4, s[28:31], s47 offen sc1
s_branch L_stored_119
L_slow_122:
buffer_store_dwordx2 v[88:89], v5, s[28:31], s3 offen offset:0 sc1
buffer_store_dwordx2 v[90:91], v5, s[28:31], s3 offen offset:256 sc1
buffer_store_dwordx2 v[92:93], v5, s[28:31], s3 offen offset:512 sc1
s_mov_b64 exec, s[50:51]
buffer_store_dwordx2 v[94:95], v5, s[28:31], s3 offen offset:768 sc1
s_mov_b64 exec, -1
s_branch L_stored_123
L_slow_124:
s_mov_b32 exec_hi, 0
buffer_store_dwordx2 v[98:99], v7, s[28:31], s43 offen sc1
s_mov_b32 exec_hi, -1
s_branch L_stored_125
L_slow_126:
s_waitcnt vmcnt(0)
buffer_store_dwordx2 v[2:3], v4, s[28:31], s55 offen sc1
s_branch L_stored_127
L_slow_130:
s_waitcnt vmcnt(0)
buffer_store_dwordx2 v[242:243], v241, s[28:31], s55 offen sc1
s_branch L_stored_131
L_chk_132:
buffer_load_dwordx2 v[240:241], v8, s[28:31], s47 offen sc1
s_sub_u32 s59, s59, 1
s_cbranch_scc1 L_fin
s_waitcnt vmcnt(0)
v_cmp_ne_u64 vcc, s[44:45], v[240:241]
s_cbranch_vccnz L_chk_132
s_branch L_chkok_133
L_slow_134:
s_waitcnt vmcnt(6)
buffer_store_dwordx2 v[2:3], v4, s[28:31], s56 offen sc1
s_branch L_stored_135
L_chk_136:
buffer_load_dwordx2 v[10:11], v9, s[28:31], s47 offen sc1
s_sub_u32 s59, s59, 1
s_cbranch_scc1 L_fin
s_waitcnt vmcnt(0)
v_cmp_ne_u64 vcc, s[44:45], v[10:11]
s_cbranch_vccnz L_chk_136
s_branch L_chkok_137
L_code_end:
.section .rodata,"a"
.p2align 6
.amdhsa_kernel interleave_layers__sliding_block__dense_activation_relu__prompt_kernel
  .amdhsa_next_free_vgpr 512
  .amdhsa_next_free_sgpr 102
  .amdhsa_accum_offset 256
  .amdhsa_group_segment_fixed_size 0
  .amdhsa_kernarg_size 72
  .amdhsa_user_sgpr_count 2
  .amdhsa_user_sgpr_kernarg_segment_ptr 1
  .amdhsa_system_sgpr_workgroup_id_x 1
.end_amdhsa_kernel
```
